```python
import torch

def _softmax(x, axis=-1):
    return torch.softmax(x, dim=axis)
def _gelu(x):
    return torch.nn.functional.gelu(x, approximate="tanh")
def _silu(x):
    return torch.nn.functional.silu(x)
def _sigmoid(x):
    return torch.sigmoid(x)
def _layernorm(x, axis=-1, eps=1e-5):
    m = x.mean(dim=axis, keepdim=True)
    v = x.var(dim=axis, keepdim=True, unbiased=False)
    return (x - m) / torch.sqrt(v + eps)
def _scatter_add(tgt, idx, src, axis=0):
    return tgt.clone().index_add_(axis, idx, src)
def _segment_sum(src, seg, n):
    out = torch.zeros((n,) + src.shape[1:], dtype=src.dtype)
    return out.index_add_(0, seg, src)
def _pad(x, pw):
    flat = tuple(v for pair in reversed(pw) for v in pair)
    return torch.nn.functional.pad(x, flat)

kernel_name = 'sequential_preLN__sliding_local_dilated__glu_gated_glu__prompt'

def setup_inputs():

    _w = (lambda a: (lambda t: t.to(torch.bfloat16) if t.is_floating_point() else t)(torch.as_tensor(a)))
    def _A_setup():
        B, S, D = 1, 2048, 576
        return {
            "x": _w((lambda *s: torch.randn(*s, dtype=torch.bfloat16) * 0.05)(B, S, D)),
            "wqkv": _w((lambda *s: torch.randn(*s, dtype=torch.bfloat16) * 0.05)(D, 3 * D)),
            "wo": _w((lambda *s: torch.randn(*s, dtype=torch.bfloat16) * 0.05)(D, D)),
        }
    _A_in = _A_setup()

    def _B_setup():
        B, S, D, F = 1, 2048, 576, 4608
        return {
            "x": _w((lambda *s: torch.randn(*s, dtype=torch.bfloat16) * 0.05)(B, S, D)),
            "w_gate": _w((lambda *s: torch.randn(*s, dtype=torch.bfloat16) * 0.05)(D, F)),
            "w_up": _w((lambda *s: torch.randn(*s, dtype=torch.bfloat16) * 0.05)(D, F)),
            "w_down": _w((lambda *s: torch.randn(*s, dtype=torch.bfloat16) * 0.05)(F, D)),
        }
    _B_in = _B_setup()

    return {
        "A_x": _A_in["x"],
        "A_wqkv": _A_in["wqkv"],
        "A_wo": _A_in["wo"],
        "B_x": _B_in["x"],
        "B_w_gate": _B_in["w_gate"],
        "B_w_up": _B_in["w_up"],
        "B_w_down": _B_in["w_down"],
    }

def reference(A_x, A_wqkv, A_wo, B_x, B_w_gate, B_w_up, B_w_down):
    def _A_ref(x, wqkv, wo):
        B, S, D = x.shape
        H = 32; Dh = D // H
        W, dil = 8, 2
        qkv = (lambda x, *d: x.permute(*d))((x @ wqkv).reshape(B, S, 3, H, Dh), 2, 0, 3, 1, 4)
        q, k, v = qkv[0], qkv[1], qkv[2]
        scale = Dh ** -0.5
        pos = torch.arange(S)
        off = torch.arange(W) * dil
        idx = pos[:, None] - off[None, :]
        mask = idx >= 0
        idx_c = torch.where(mask, idx, 0).reshape(-1)
        kg = k[:, :, idx_c, :].reshape(B, H, S, W, Dh)
        vg = v[:, :, idx_c, :].reshape(B, H, S, W, Dh)
        logits = torch.einsum("bhsd,bhswd->bhsw", q, kg) * scale
        logits = torch.where(mask[None, None, :, :], logits, -1e9)
        attn = _softmax(logits, axis=-1)
        o = torch.einsum("bhsw,bhswd->bhsd", attn, vg)
        return (lambda x, *d: x.permute(*d))(o, 0, 2, 1, 3).reshape(B, S, D) @ wo

    def _B_ref(x, w_gate, w_up, w_down):
        g = torch.einsum("bsd,df->bsf", x, w_gate)
        u = torch.einsum("bsd,df->bsf", x, w_up)
        h = _sigmoid(g) * u
        return torch.einsum("bsf,fd->bsd", h, w_down)

    x = A_x
    h = x + _A_ref(_layernorm(x, axis=-1), A_wqkv, A_wo)
    h2 = h + _B_ref(_layernorm(h, axis=-1), B_w_gate, B_w_up, B_w_down)
    return h2
```

```asm
; @launch kernel=k1_kernel grid=(416,1,1) block=(256,1,1) lds=80896
; @launch kernel=k2_kernel grid=(256,1,1) block=(256,1,1) lds=61440
; @launch kernel=fk_kernel grid=(256,1,1) block=(256,1,1) lds=163840
.amdgcn_target "amdgcn-amd-amdhsa--gfx950"
.text
.globl k1_kernel
.p2align 8
.type k1_kernel,@function
k1_kernel:
    s_load_dwordx4 s[8:11], s[0:1], 0
    s_load_dwordx2 s[4:5], s[0:1], 72
    s_cmp_ge_u32 s2, 409
    s_cbranch_scc1 L_k1_kernel_end
    v_and_b32 v250, 63, v0
    s_bfe_u32 s43, s2, 0x50003
    s_getpc_b64 s[46:47]
L_k1_kernele_pc:
    s_add_u32 s46, s46, L_k1_kernele_pc-L_k1_kernele_pc
    s_addc_u32 s47, s47, 0
    s_mul_i32 s48, s43, ((L_k2_kernel_end-L_k1_kernele_pc+4095)/4096)*128
    v_lshlrev_b32 v251, 7, v250
    v_min_u32 v251, ((L_k2_kernel_end-L_k1_kernele_pc+4095)/4096-1)*128, v251
    v_add_u32 v251, s48, v251
    v_min_u32 v251, L_k2_kernel_end-L_k1_kernele_pc-4, v251
    global_load_dword v252, v251, s[46:47]
    s_cmp_ge_u32 s2, 256
    s_cbranch_scc1 L_k1_kernel_side
    s_and_b32 s28, s2, 7
    s_lshl_b32 s28, s28, 2
    s_bfe_u32 s29, s2, 0x20003
    s_add_u32 s28, s28, s29
    s_bfe_u32 s29, s2, 0x30005
    v_and_b32 v180, 63, v0
    v_lshrrev_b32 v181, 6, v0
    s_nop 0
    v_readfirstlane_b32 s30, v181
    v_lshrrev_b32 v182, 4, v180
    v_and_b32 v183, 15, v180
    s_lshl_b32 s31, s28, 6
    v_lshrrev_b32 v184, 5, v180
    v_lshl_add_u32 v185, v181, 1, v184
    v_bfe_u32 v186, v180, 1, 4
    v_xor_b32 v186, v186, v185
    v_and_b32 v187, 1, v180
    v_lshl_add_u32 v186, v186, 1, v187
    v_min_u32 v186, 26, v186
    v_mul_u32_u24 v187, 57, v186
    v_lshrrev_b32 v187, 9, v187
    v_mul_u32_u24 v177, 1008, v187
    v_lshl_add_u32 v177, v186, 4, v177
    v_and_b32 v186, 1, v181
    v_lshl_add_u32 v184, v186, 1, v184
    v_lshrrev_b32 v186, 1, v181
    v_lshl_add_u32 v184, v186, 3, v184
    v_mul_u32_u24 v184, 3456, v184
    v_add_u32 v177, v177, v184
    s_mul_i32 s32, s29, 144
    v_add_u32 v177, s32, v177
    s_and_b32 s33, s30, 1
    s_lshl_b32 s33, s33, 10
    s_lshr_b32 s34, s30, 1
    s_lshl_b32 s34, s34, 12
    s_add_u32 s33, s33, s34
    v_lshrrev_b32 v184, 3, v180
    v_and_b32 v185, 7, v180
    v_xor_b32 v185, v185, v184
    v_lshlrev_b32 v185, 4, v185
    s_lshl_b32 s34, s30, 3
    s_add_u32 s34, s34, s31
    v_add_u32 v186, s34, v184
    v_mul_u32_u24 v186, 1152, v186
    v_add_u32 v174, v186, v185
    v_add_u32 v175, 36864, v174
    s_and_b32 s34, s30, 1
    s_lshl_b32 s34, s34, 3
    s_add_u32 s34, s34, s31
    s_sub_u32 s34, s34, 16
    v_add_u32 v186, s34, v184
    s_movk_i32 s35, 1152
    v_mul_lo_u32 v186, v186, s35
    v_add_u32 v176, v186, v185
    s_lshl_b32 s34, s30, 10
    s_and_b32 s35, s30, 1
    s_lshl_b32 s35, s35, 10
    s_waitcnt lgkmcnt(0)
    s_mov_b32 s12, s8
    s_mov_b32 s13, s9
    s_mov_b32 s14, 2359296
    s_mov_b32 s15, 0x20000
    s_mov_b32 s16, s10
    s_mov_b32 s17, s11
    s_mov_b32 s18, 1990656
    s_mov_b32 s19, 0x20000
    s_add_u32 m0, s33, 0
    s_mov_b32 s40, 0
    buffer_load_dwordx4 v177, s[16:19], s40 offen lds
    s_add_u32 m0, s33, 2048
    s_mov_b32 s40, 13824
    buffer_load_dwordx4 v177, s[16:19], s40 offen lds
    s_add_u32 m0, s33, 8192
    s_mov_b32 s40, 55296
    buffer_load_dwordx4 v177, s[16:19], s40 offen lds
    s_add_u32 m0, s33, 10240
    s_mov_b32 s40, 69120
    buffer_load_dwordx4 v177, s[16:19], s40 offen lds
    s_mov_b32 s41, 0
    s_add_u32 m0, s34, 49152
    s_nop 0
    buffer_load_dwordx4 v174, s[12:15], s41 offen lds
    s_add_u32 m0, s34, 53248
    s_nop 0
    buffer_load_dwordx4 v175, s[12:15], s41 offen lds
    s_add_u32 m0, s35, 57344
    s_nop 0
    buffer_load_dwordx4 v176, s[12:15], s41 offen lds
    v_lshlrev_b32 v186, 7, v180
    s_cmp_eq_u32 s30, 0
    s_cbranch_scc0 L_k1_kernel_tx
    s_mul_i32 s42, s2, 7808
    buffer_load_dword v236, v186, s[16:19], s42 offen
    s_branch L_k1_kernel_td
L_k1_kernel_tx:
    s_mul_i32 s42, s29, 3
    s_add_u32 s42, s42, s30
    s_sub_u32 s42, s42, 1
    s_mul_i32 s42, s42, 3072
    s_mul_i32 s43, s28, 73728
    s_add_u32 s42, s42, s43
    v_min_u32 v186, 2944, v186
    buffer_load_dword v236, v186, s[12:15], s42 offen
L_k1_kernel_td:
    s_add_u32 m0, s33, 16384
    s_mov_b32 s40, 110592
    buffer_load_dwordx4 v177, s[16:19], s40 offen lds
    s_add_u32 m0, s33, 18432
    s_mov_b32 s40, 124416
    buffer_load_dwordx4 v177, s[16:19], s40 offen lds
    s_add_u32 m0, s33, 24576
    s_mov_b32 s40, 165888
    buffer_load_dwordx4 v177, s[16:19], s40 offen lds
    s_add_u32 m0, s33, 26624
    s_mov_b32 s40, 179712
    buffer_load_dwordx4 v177, s[16:19], s40 offen lds
    s_add_u32 m0, s33, 32768
    s_mov_b32 s40, 221184
    buffer_load_dwordx4 v177, s[16:19], s40 offen lds
    s_add_u32 m0, s33, 34816
    s_mov_b32 s40, 235008
    buffer_load_dwordx4 v177, s[16:19], s40 offen lds
    s_add_u32 m0, s33, 40960
    s_mov_b32 s40, 276480
    buffer_load_dwordx4 v177, s[16:19], s40 offen lds
    s_add_u32 m0, s33, 43008
    s_mov_b32 s40, 290304
    buffer_load_dwordx4 v177, s[16:19], s40 offen lds
    s_mov_b32 s41, 128
    s_add_u32 m0, s34, 59392
    s_nop 0
    buffer_load_dwordx4 v174, s[12:15], s41 offen lds
    s_add_u32 m0, s34, 63488
    s_nop 0
    buffer_load_dwordx4 v175, s[12:15], s41 offen lds
    s_add_u32 m0, s35, 67584
    s_nop 0
    buffer_load_dwordx4 v176, s[12:15], s41 offen lds
    v_and_b32 v184, 7, v183
    v_xor_b32 v184, v184, v182
    v_lshlrev_b32 v184, 4, v184
    v_lshl_add_u32 v184, v183, 7, v184
    v_add_u32 v184, 49152, v184
    v_add_u32 v185, 0, v181
    v_and_b32 v185, 3, v185
    v_lshl_add_u32 v160, v185, 11, v184
    v_xor_b32 v161, 64, v160
    v_add_u32 v185, 1, v181
    v_and_b32 v185, 3, v185
    v_lshl_add_u32 v162, v185, 11, v184
    v_xor_b32 v163, 64, v162
    v_add_u32 v185, 2, v181
    v_and_b32 v185, 3, v185
    v_lshl_add_u32 v164, v185, 11, v184
    v_xor_b32 v165, 64, v164
    v_add_u32 v185, 3, v181
    v_and_b32 v185, 3, v185
    v_lshl_add_u32 v166, v185, 11, v184
    v_xor_b32 v167, 64, v166
    v_add_u32 v168, 8192, v184
    v_xor_b32 v169, 64, v168
    v_bfe_u32 v184, v180, 2, 2
    v_and_b32 v185, 1, v182
    v_lshl_add_u32 v185, v185, 2, v184
    v_lshl_add_u32 v184, v182, 3, v184
    v_lshlrev_b32 v184, 9, v184
    v_and_b32 v186, 3, v180
    v_lshl_add_u32 v184, v186, 3, v184
    v_add_u32 v186, 0, v181
    v_xor_b32 v186, v186, v185
    v_lshl_add_u32 v170, v186, 5, v184
    v_add_u32 v186, 4, v181
    v_xor_b32 v186, v186, v185
    v_lshl_add_u32 v171, v186, 5, v184
    v_add_u32 v186, 8, v181
    v_xor_b32 v186, v186, v185
    v_lshl_add_u32 v172, v186, 5, v184
    v_add_u32 v186, 12, v181
    v_xor_b32 v186, v186, v185
    v_lshl_add_u32 v173, v186, 5, v184
    v_mov_b32 v196, 0x3f803f80
    v_cmp_eq_u32 s[44:45], 0, v183
    s_mov_b32 s41, 256
    s_add_u32 m0, s34, 69632
    s_nop 0
    buffer_load_dwordx4 v174, s[12:15], s41 offen lds
    s_add_u32 m0, s34, 73728
    s_nop 0
    buffer_load_dwordx4 v175, s[12:15], s41 offen lds
    s_add_u32 m0, s35, 77824
    s_nop 0
    buffer_load_dwordx4 v176, s[12:15], s41 offen lds
    v_lshlrev_b32 v185, 4, v181
    v_lshl_add_u32 v185, v182, 2, v185
    v_add_u32 v185, 0, v185
    v_mul_u32_u24 v186, 3641, v185
    v_lshrrev_b32 v186, 16, v186
    v_mul_u32_u24 v186, 12, v186
    v_lshl_add_u32 v216, v185, 1, v186
    v_lshlrev_b32 v185, 4, v181
    v_lshl_add_u32 v185, v182, 2, v185
    v_add_u32 v185, 2, v185
    v_mul_u32_u24 v186, 3641, v185
    v_lshrrev_b32 v186, 16, v186
    v_mul_u32_u24 v186, 12, v186
    v_lshl_add_u32 v217, v185, 1, v186
    v_lshlrev_b32 v185, 4, v181
    v_lshl_add_u32 v185, v182, 2, v185
    v_add_u32 v185, 64, v185
    v_mul_u32_u24 v186, 3641, v185
    v_lshrrev_b32 v186, 16, v186
    v_mul_u32_u24 v186, 12, v186
    v_lshl_add_u32 v218, v185, 1, v186
    v_lshlrev_b32 v185, 4, v181
    v_lshl_add_u32 v185, v182, 2, v185
    v_add_u32 v185, 66, v185
    v_mul_u32_u24 v186, 3641, v185
    v_lshrrev_b32 v186, 16, v186
    v_mul_u32_u24 v186, 12, v186
    v_lshl_add_u32 v219, v185, 1, v186
    v_lshlrev_b32 v185, 4, v181
    v_lshl_add_u32 v185, v182, 2, v185
    v_add_u32 v185, 128, v185
    v_mul_u32_u24 v186, 3641, v185
    v_lshrrev_b32 v186, 16, v186
    v_mul_u32_u24 v186, 12, v186
    v_lshl_add_u32 v220, v185, 1, v186
    v_lshlrev_b32 v185, 4, v181
    v_lshl_add_u32 v185, v182, 2, v185
    v_add_u32 v185, 130, v185
    v_mul_u32_u24 v186, 3641, v185
    v_lshrrev_b32 v186, 16, v186
    v_mul_u32_u24 v186, 12, v186
    v_lshl_add_u32 v221, v185, 1, v186
    v_lshlrev_b32 v185, 4, v181
    v_lshl_add_u32 v185, v182, 2, v185
    v_add_u32 v185, 192, v185
    v_mul_u32_u24 v186, 3641, v185
    v_lshrrev_b32 v186, 16, v186
    v_mul_u32_u24 v186, 12, v186
    v_lshl_add_u32 v222, v185, 1, v186
    v_min_u32 v222, 576, v222
    v_lshlrev_b32 v185, 4, v181
    v_lshl_add_u32 v185, v182, 2, v185
    v_add_u32 v185, 194, v185
    v_mul_u32_u24 v186, 3641, v185
    v_lshrrev_b32 v186, 16, v186
    v_mul_u32_u24 v186, 12, v186
    v_lshl_add_u32 v223, v185, 1, v186
    v_min_u32 v223, 576, v223
    v_add_u32 v185, 0, v181
    v_and_b32 v185, 3, v185
    v_lshl_add_u32 v185, v185, 4, v183
    v_add_u32 v186, 16, v185
    v_mul_u32_u24 v224, 592, v186
    v_lshlrev_b32 v185, 3, v185
    v_add_u32 v230, 79872, v185
    v_add_u32 v185, 1, v181
    v_and_b32 v185, 3, v185
    v_lshl_add_u32 v185, v185, 4, v183
    v_add_u32 v186, 16, v185
    v_mul_u32_u24 v225, 592, v186
    v_lshlrev_b32 v185, 3, v185
    v_add_u32 v231, 79872, v185
    v_add_u32 v185, 2, v181
    v_and_b32 v185, 3, v185
    v_lshl_add_u32 v185, v185, 4, v183
    v_add_u32 v186, 16, v185
    v_mul_u32_u24 v226, 592, v186
    v_lshlrev_b32 v185, 3, v185
    v_add_u32 v232, 79872, v185
    v_add_u32 v185, 3, v181
    v_and_b32 v185, 3, v185
    v_lshl_add_u32 v185, v185, 4, v183
    v_add_u32 v186, 16, v185
    v_mul_u32_u24 v227, 592, v186
    v_lshlrev_b32 v185, 3, v185
    v_add_u32 v233, 79872, v185
    v_mul_u32_u24 v228, 592, v183
    v_mov_b32 v152, 0x3f803f80
    v_mov_b32 v153, 0x3f803f80
    v_mov_b32 v154, 0x3f803f80
    v_mov_b32 v155, 0x3f803f80
    v_mov_b32 v0, 0
    v_mov_b32 v1, 0
    v_mov_b32 v2, 0
    v_mov_b32 v3, 0
    v_mov_b32 v4, 0
    v_mov_b32 v5, 0
    v_mov_b32 v6, 0
    v_mov_b32 v7, 0
    v_mov_b32 v8, 0
    v_mov_b32 v9, 0
    v_mov_b32 v10, 0
    v_mov_b32 v11, 0
    v_mov_b32 v12, 0
    v_mov_b32 v13, 0
    v_mov_b32 v14, 0
    v_mov_b32 v15, 0
    v_mov_b32 v16, 0
    v_mov_b32 v17, 0
    v_mov_b32 v18, 0
    v_mov_b32 v19, 0
    v_mov_b32 v20, 0
    v_mov_b32 v21, 0
    v_mov_b32 v22, 0
    v_mov_b32 v23, 0
    v_mov_b32 v24, 0
    v_mov_b32 v25, 0
    v_mov_b32 v26, 0
    v_mov_b32 v27, 0
    v_mov_b32 v28, 0
    v_mov_b32 v29, 0
    v_mov_b32 v30, 0
    v_mov_b32 v31, 0
    v_mov_b32 v32, 0
    v_mov_b32 v33, 0
    v_mov_b32 v34, 0
    v_mov_b32 v35, 0
    v_mov_b32 v36, 0
    v_mov_b32 v37, 0
    v_mov_b32 v38, 0
    v_mov_b32 v39, 0
    v_mov_b32 v40, 0
    v_mov_b32 v41, 0
    v_mov_b32 v42, 0
    v_mov_b32 v43, 0
    v_mov_b32 v44, 0
    v_mov_b32 v45, 0
    v_mov_b32 v46, 0
    v_mov_b32 v47, 0
    v_mov_b32 v48, 0
    v_mov_b32 v49, 0
    v_mov_b32 v50, 0
    v_mov_b32 v51, 0
    v_mov_b32 v52, 0
    v_mov_b32 v53, 0
    v_mov_b32 v54, 0
    v_mov_b32 v55, 0
    v_mov_b32 v56, 0
    v_mov_b32 v57, 0
    v_mov_b32 v58, 0
    v_mov_b32 v59, 0
    v_mov_b32 v60, 0
    v_mov_b32 v61, 0
    v_mov_b32 v62, 0
    v_mov_b32 v63, 0
    v_mov_b32 v64, 0
    v_mov_b32 v65, 0
    v_mov_b32 v66, 0
    v_mov_b32 v67, 0
    v_mov_b32 v68, 0
    v_mov_b32 v69, 0
    v_mov_b32 v70, 0
    v_mov_b32 v71, 0
    v_mov_b32 v72, 0
    v_mov_b32 v73, 0
    v_mov_b32 v74, 0
    v_mov_b32 v75, 0
    v_mov_b32 v76, 0
    v_mov_b32 v77, 0
    v_mov_b32 v78, 0
    v_mov_b32 v79, 0
    v_mov_b32 v198, 0
    v_mov_b32 v199, 0
    v_mov_b32 v200, 0
    v_mov_b32 v201, 0
    v_mov_b32 v202, 0
    v_mov_b32 v203, 0
    v_mov_b32 v204, 0
    v_mov_b32 v205, 0
    v_mov_b32 v206, 0
    v_mov_b32 v207, 0
    v_mov_b32 v208, 0
    v_mov_b32 v209, 0
    v_mov_b32 v210, 0
    v_mov_b32 v211, 0
    v_mov_b32 v212, 0
    v_mov_b32 v213, 0
    s_mov_b32 s36, 0
    s_mov_b32 s37, 0
    s_mov_b32 s38, 0
    s_waitcnt vmcnt(15)
    s_barrier
    ds_read_b128 v[80:83], v160 offset:0
    ds_read_b128 v[84:87], v162 offset:0
    ds_read_b128 v[88:91], v164 offset:0
    ds_read_b128 v[92:95], v166 offset:0
    ds_read_b128 v[96:99], v168 offset:0
    ds_read_b64_tr_b16 v[120:121], v170 offset:0
    ds_read_b64_tr_b16 v[122:123], v170 offset:2048
    ds_read_b64_tr_b16 v[124:125], v171 offset:0
    ds_read_b64_tr_b16 v[126:127], v171 offset:2048
    ds_read_b64_tr_b16 v[128:129], v172 offset:0
    ds_read_b64_tr_b16 v[130:131], v172 offset:2048
    ds_read_b64_tr_b16 v[132:133], v173 offset:0
    ds_read_b64_tr_b16 v[134:135], v173 offset:2048
L_k1_kernel_kloop:
    s_cmp_eq_u32 s38, 2
    s_cselect_b32 s14, 0, 2359296
    s_waitcnt vmcnt(7) lgkmcnt(0)
    s_barrier
    v_mfma_f32_16x16x32_bf16 v[0:3], v[120:123], v[80:83], v[0:3]
    v_cndmask_b32 v96, v96, v196, s[44:45]
    v_cndmask_b32 v97, v97, v196, s[44:45]
    v_mfma_f32_16x16x32_bf16 v[20:23], v[124:127], v[80:83], v[20:23]
    v_cndmask_b32 v98, v98, v196, s[44:45]
    v_cndmask_b32 v99, v99, v196, s[44:45]
    v_mfma_f32_16x16x32_bf16 v[40:43], v[128:131], v[80:83], v[40:43]
    ds_read_b128 v[100:103], v161 offset:0
    ds_read_b128 v[104:107], v163 offset:0
    v_mfma_f32_16x16x32_bf16 v[60:63], v[132:135], v[80:83], v[60:63]
    ds_read_b128 v[108:111], v165 offset:0
    ds_read_b128 v[112:115], v167 offset:0
    v_mfma_f32_16x16x32_bf16 v[4:7], v[120:123], v[84:87], v[4:7]
    ds_read_b128 v[116:119], v169 offset:0
    ds_read_b64_tr_b16 v[136:137], v170 offset:16384
    v_mfma_f32_16x16x32_bf16 v[24:27], v[124:127], v[84:87], v[24:27]
    ds_read_b64_tr_b16 v[138:139], v170 offset:18432
    ds_read_b64_tr_b16 v[140:141], v171 offset:16384
    v_mfma_f32_16x16x32_bf16 v[44:47], v[128:131], v[84:87], v[44:47]
    ds_read_b64_tr_b16 v[142:143], v171 offset:18432
    ds_read_b64_tr_b16 v[144:145], v172 offset:16384
    v_mfma_f32_16x16x32_bf16 v[64:67], v[132:135], v[84:87], v[64:67]
    ds_read_b64_tr_b16 v[146:147], v172 offset:18432
    ds_read_b64_tr_b16 v[148:149], v173 offset:16384
    v_mfma_f32_16x16x32_bf16 v[8:11], v[120:123], v[88:91], v[8:11]
    ds_read_b64_tr_b16 v[150:151], v173 offset:18432
    s_add_u32 m0, s33, 0
    v_mfma_f32_16x16x32_bf16 v[28:31], v[124:127], v[88:91], v[28:31]
    s_add_u32 s40, s36, 331776
    buffer_load_dwordx4 v177, s[16:19], s40 offen lds
    v_mfma_f32_16x16x32_bf16 v[48:51], v[128:131], v[88:91], v[48:51]
    s_add_u32 m0, s33, 2048
    s_add_u32 s40, s36, 345600
    v_mfma_f32_16x16x32_bf16 v[68:71], v[132:135], v[88:91], v[68:71]
    buffer_load_dwordx4 v177, s[16:19], s40 offen lds
    s_add_u32 m0, s33, 8192
    v_mfma_f32_16x16x32_bf16 v[12:15], v[120:123], v[92:95], v[12:15]
    s_add_u32 s40, s36, 387072
    buffer_load_dwordx4 v177, s[16:19], s40 offen lds
    v_mfma_f32_16x16x32_bf16 v[32:35], v[124:127], v[92:95], v[32:35]
    s_add_u32 m0, s33, 10240
    s_add_u32 s40, s36, 400896
    v_mfma_f32_16x16x32_bf16 v[52:55], v[128:131], v[92:95], v[52:55]
    buffer_load_dwordx4 v177, s[16:19], s40 offen lds
    v_mfma_f32_16x16x32_bf16 v[72:75], v[132:135], v[92:95], v[72:75]
    v_mfma_f32_16x16x32_bf16 v[198:201], v[152:155], v[80:83], v[198:201]
    v_mfma_f32_16x16x32_bf16 v[202:205], v[80:83], v[80:83], v[202:205]
    v_mfma_f32_16x16x32_bf16 v[16:19], v[120:123], v[96:99], v[16:19]
    v_mfma_f32_16x16x32_bf16 v[36:39], v[124:127], v[96:99], v[36:39]
    v_mfma_f32_16x16x32_bf16 v[56:59], v[128:131], v[96:99], v[56:59]
    v_mfma_f32_16x16x32_bf16 v[76:79], v[132:135], v[96:99], v[76:79]
    v_mfma_f32_16x16x32_bf16 v[206:209], v[152:155], v[96:99], v[206:209]
    v_mfma_f32_16x16x32_bf16 v[210:213], v[96:99], v[96:99], v[210:213]
    s_waitcnt vmcnt(7) lgkmcnt(0)
    s_barrier
    v_mfma_f32_16x16x32_bf16 v[0:3], v[136:139], v[100:103], v[0:3]
    v_cndmask_b32 v116, v116, v196, s[44:45]
    v_cndmask_b32 v117, v117, v196, s[44:45]
    v_mfma_f32_16x16x32_bf16 v[20:23], v[140:143], v[100:103], v[20:23]
    v_cndmask_b32 v118, v118, v196, s[44:45]
    v_cndmask_b32 v119, v119, v196, s[44:45]
    v_mfma_f32_16x16x32_bf16 v[40:43], v[144:147], v[100:103], v[40:43]
    ds_read_b128 v[80:83], v160 offset:10240
    ds_read_b128 v[84:87], v162 offset:10240
    v_mfma_f32_16x16x32_bf16 v[60:63], v[148:151], v[100:103], v[60:63]
    ds_read_b128 v[88:91], v164 offset:10240
    ds_read_b128 v[92:95], v166 offset:10240
    v_mfma_f32_16x16x32_bf16 v[4:7], v[136:139], v[104:107], v[4:7]
    ds_read_b128 v[96:99], v168 offset:10240
    ds_read_b64_tr_b16 v[120:121], v170 offset:32768
    v_mfma_f32_16x16x32_bf16 v[24:27], v[140:143], v[104:107], v[24:27]
    ds_read_b64_tr_b16 v[122:123], v170 offset:34816
    ds_read_b64_tr_b16 v[124:125], v171 offset:32768
    v_mfma_f32_16x16x32_bf16 v[44:47], v[144:147], v[104:107], v[44:47]
    ds_read_b64_tr_b16 v[126:127], v171 offset:34816
    ds_read_b64_tr_b16 v[128:129], v172 offset:32768
    v_mfma_f32_16x16x32_bf16 v[64:67], v[148:151], v[104:107], v[64:67]
    ds_read_b64_tr_b16 v[130:131], v172 offset:34816
    ds_read_b64_tr_b16 v[132:133], v173 offset:32768
    v_mfma_f32_16x16x32_bf16 v[8:11], v[136:139], v[108:111], v[8:11]
    ds_read_b64_tr_b16 v[134:135], v173 offset:34816
    s_add_u32 m0, s33, 16384
    v_mfma_f32_16x16x32_bf16 v[28:31], v[140:143], v[108:111], v[28:31]
    s_add_u32 s40, s36, 442368
    buffer_load_dwordx4 v177, s[16:19], s40 offen lds
    v_mfma_f32_16x16x32_bf16 v[48:51], v[144:147], v[108:111], v[48:51]
    s_add_u32 m0, s33, 18432
    s_add_u32 s40, s36, 456192
    v_mfma_f32_16x16x32_bf16 v[68:71], v[148:151], v[108:111], v[68:71]
    buffer_load_dwordx4 v177, s[16:19], s40 offen lds
    s_add_u32 m0, s33, 24576
    v_mfma_f32_16x16x32_bf16 v[12:15], v[136:139], v[112:115], v[12:15]
    s_add_u32 s40, s36, 497664
    buffer_load_dwordx4 v177, s[16:19], s40 offen lds
    v_mfma_f32_16x16x32_bf16 v[32:35], v[140:143], v[112:115], v[32:35]
    s_add_u32 m0, s33, 26624
    s_add_u32 s40, s36, 511488
    v_mfma_f32_16x16x32_bf16 v[52:55], v[144:147], v[112:115], v[52:55]
    buffer_load_dwordx4 v177, s[16:19], s40 offen lds
    s_add_u32 s41, s37, 384
    v_mfma_f32_16x16x32_bf16 v[72:75], v[148:151], v[112:115], v[72:75]
    s_add_u32 m0, s34, 49152
    s_nop 0
    buffer_load_dwordx4 v174, s[12:15], s41 offen lds
    v_mfma_f32_16x16x32_bf16 v[198:201], v[152:155], v[100:103], v[198:201]
    s_add_u32 m0, s34, 53248
    s_nop 0
    buffer_load_dwordx4 v175, s[12:15], s41 offen lds
    v_mfma_f32_16x16x32_bf16 v[202:205], v[100:103], v[100:103], v[202:205]
    s_add_u32 m0, s35, 57344
    s_nop 0
    buffer_load_dwordx4 v176, s[12:15], s41 offen lds
    v_mfma_f32_16x16x32_bf16 v[16:19], v[136:139], v[116:119], v[16:19]
    v_mfma_f32_16x16x32_bf16 v[36:39], v[140:143], v[116:119], v[36:39]
    v_mfma_f32_16x16x32_bf16 v[56:59], v[144:147], v[116:119], v[56:59]
    v_mfma_f32_16x16x32_bf16 v[76:79], v[148:151], v[116:119], v[76:79]
    v_mfma_f32_16x16x32_bf16 v[206:209], v[152:155], v[116:119], v[206:209]
    v_mfma_f32_16x16x32_bf16 v[210:213], v[116:119], v[116:119], v[210:213]
    s_waitcnt vmcnt(7) lgkmcnt(0)
    s_barrier
    v_mfma_f32_16x16x32_bf16 v[0:3], v[120:123], v[80:83], v[0:3]
    v_cndmask_b32 v96, v96, v196, s[44:45]
    v_cndmask_b32 v97, v97, v196, s[44:45]
    v_mfma_f32_16x16x32_bf16 v[20:23], v[124:127], v[80:83], v[20:23]
    v_cndmask_b32 v98, v98, v196, s[44:45]
    v_cndmask_b32 v99, v99, v196, s[44:45]
    v_mfma_f32_16x16x32_bf16 v[40:43], v[128:131], v[80:83], v[40:43]
    ds_read_b128 v[100:103], v161 offset:10240
    ds_read_b128 v[104:107], v163 offset:10240
    v_mfma_f32_16x16x32_bf16 v[60:63], v[132:135], v[80:83], v[60:63]
    ds_read_b128 v[108:111], v165 offset:10240
    ds_read_b128 v[112:115], v167 offset:10240
    v_mfma_f32_16x16x32_bf16 v[4:7], v[120:123], v[84:87], v[4:7]
    ds_read_b128 v[116:119], v169 offset:10240
    ds_read_b64_tr_b16 v[136:137], v170 offset:0
    v_mfma_f32_16x16x32_bf16 v[24:27], v[124:127], v[84:87], v[24:27]
    ds_read_b64_tr_b16 v[138:139], v170 offset:2048
    ds_read_b64_tr_b16 v[140:141], v171 offset:0
    v_mfma_f32_16x16x32_bf16 v[44:47], v[128:131], v[84:87], v[44:47]
    ds_read_b64_tr_b16 v[142:143], v171 offset:2048
    ds_read_b64_tr_b16 v[144:145], v172 offset:0
    v_mfma_f32_16x16x32_bf16 v[64:67], v[132:135], v[84:87], v[64:67]
    ds_read_b64_tr_b16 v[146:147], v172 offset:2048
    ds_read_b64_tr_b16 v[148:149], v173 offset:0
    v_mfma_f32_16x16x32_bf16 v[8:11], v[120:123], v[88:91], v[8:11]
    ds_read_b64_tr_b16 v[150:151], v173 offset:2048
    s_add_u32 m0, s33, 32768
    v_mfma_f32_16x16x32_bf16 v[28:31], v[124:127], v[88:91], v[28:31]
    s_add_u32 s40, s36, 552960
    buffer_load_dwordx4 v177, s[16:19], s40 offen lds
    v_mfma_f32_16x16x32_bf16 v[48:51], v[128:131], v[88:91], v[48:51]
    s_add_u32 m0, s33, 34816
    s_add_u32 s40, s36, 566784
    v_mfma_f32_16x16x32_bf16 v[68:71], v[132:135], v[88:91], v[68:71]
    buffer_load_dwordx4 v177, s[16:19], s40 offen lds
    s_add_u32 m0, s33, 40960
    v_mfma_f32_16x16x32_bf16 v[12:15], v[120:123], v[92:95], v[12:15]
    s_add_u32 s40, s36, 608256
    buffer_load_dwordx4 v177, s[16:19], s40 offen lds
    v_mfma_f32_16x16x32_bf16 v[32:35], v[124:127], v[92:95], v[32:35]
    s_add_u32 m0, s33, 43008
    s_add_u32 s40, s36, 622080
    v_mfma_f32_16x16x32_bf16 v[52:55], v[128:131], v[92:95], v[52:55]
    buffer_load_dwordx4 v177, s[16:19], s40 offen lds
    v_mfma_f32_16x16x32_bf16 v[72:75], v[132:135], v[92:95], v[72:75]
    v_mfma_f32_16x16x32_bf16 v[198:201], v[152:155], v[80:83], v[198:201]
    v_mfma_f32_16x16x32_bf16 v[202:205], v[80:83], v[80:83], v[202:205]
    v_mfma_f32_16x16x32_bf16 v[16:19], v[120:123], v[96:99], v[16:19]
    v_mfma_f32_16x16x32_bf16 v[36:39], v[124:127], v[96:99], v[36:39]
    v_mfma_f32_16x16x32_bf16 v[56:59], v[128:131], v[96:99], v[56:59]
    v_mfma_f32_16x16x32_bf16 v[76:79], v[132:135], v[96:99], v[76:79]
    v_mfma_f32_16x16x32_bf16 v[206:209], v[152:155], v[96:99], v[206:209]
    v_mfma_f32_16x16x32_bf16 v[210:213], v[96:99], v[96:99], v[210:213]
    s_waitcnt vmcnt(7) lgkmcnt(0)
    s_barrier
    v_mfma_f32_16x16x32_bf16 v[0:3], v[136:139], v[100:103], v[0:3]
    v_cndmask_b32 v116, v116, v196, s[44:45]
    v_cndmask_b32 v117, v117, v196, s[44:45]
    v_mfma_f32_16x16x32_bf16 v[20:23], v[140:143], v[100:103], v[20:23]
    v_cndmask_b32 v118, v118, v196, s[44:45]
    v_cndmask_b32 v119, v119, v196, s[44:45]
    v_mfma_f32_16x16x32_bf16 v[40:43], v[144:147], v[100:103], v[40:43]
    ds_read_b128 v[80:83], v160 offset:20480
    ds_read_b128 v[84:87], v162 offset:20480
    v_mfma_f32_16x16x32_bf16 v[60:63], v[148:151], v[100:103], v[60:63]
    ds_read_b128 v[88:91], v164 offset:20480
    ds_read_b128 v[92:95], v166 offset:20480
    v_mfma_f32_16x16x32_bf16 v[4:7], v[136:139], v[104:107], v[4:7]
    ds_read_b128 v[96:99], v168 offset:20480
    ds_read_b64_tr_b16 v[120:121], v170 offset:16384
    v_mfma_f32_16x16x32_bf16 v[24:27], v[140:143], v[104:107], v[24:27]
    ds_read_b64_tr_b16 v[122:123], v170 offset:18432
    ds_read_b64_tr_b16 v[124:125], v171 offset:16384
    v_mfma_f32_16x16x32_bf16 v[44:47], v[144:147], v[104:107], v[44:47]
    ds_read_b64_tr_b16 v[126:127], v171 offset:18432
    ds_read_b64_tr_b16 v[128:129], v172 offset:16384
    v_mfma_f32_16x16x32_bf16 v[64:67], v[148:151], v[104:107], v[64:67]
    ds_read_b64_tr_b16 v[130:131], v172 offset:18432
    ds_read_b64_tr_b16 v[132:133], v173 offset:16384
    v_mfma_f32_16x16x32_bf16 v[8:11], v[136:139], v[108:111], v[8:11]
    ds_read_b64_tr_b16 v[134:135], v173 offset:18432
    s_add_u32 m0, s33, 0
    v_mfma_f32_16x16x32_bf16 v[28:31], v[140:143], v[108:111], v[28:31]
    s_add_u32 s40, s36, 663552
    buffer_load_dwordx4 v177, s[16:19], s40 offen lds
    v_mfma_f32_16x16x32_bf16 v[48:51], v[144:147], v[108:111], v[48:51]
    s_add_u32 m0, s33, 2048
    s_add_u32 s40, s36, 677376
    v_mfma_f32_16x16x32_bf16 v[68:71], v[148:151], v[108:111], v[68:71]
    buffer_load_dwordx4 v177, s[16:19], s40 offen lds
    s_add_u32 m0, s33, 8192
    v_mfma_f32_16x16x32_bf16 v[12:15], v[136:139], v[112:115], v[12:15]
    s_add_u32 s40, s36, 718848
    buffer_load_dwordx4 v177, s[16:19], s40 offen lds
    v_mfma_f32_16x16x32_bf16 v[32:35], v[140:143], v[112:115], v[32:35]
    s_add_u32 m0, s33, 10240
    s_add_u32 s40, s36, 732672
    v_mfma_f32_16x16x32_bf16 v[52:55], v[144:147], v[112:115], v[52:55]
    buffer_load_dwordx4 v177, s[16:19], s40 offen lds
    s_add_u32 s41, s37, 512
    v_mfma_f32_16x16x32_bf16 v[72:75], v[148:151], v[112:115], v[72:75]
    s_add_u32 m0, s34, 59392
    s_nop 0
    buffer_load_dwordx4 v174, s[12:15], s41 offen lds
    v_mfma_f32_16x16x32_bf16 v[198:201], v[152:155], v[100:103], v[198:201]
    s_add_u32 m0, s34, 63488
    s_nop 0
    buffer_load_dwordx4 v175, s[12:15], s41 offen lds
    v_mfma_f32_16x16x32_bf16 v[202:205], v[100:103], v[100:103], v[202:205]
    s_add_u32 m0, s35, 67584
    s_nop 0
    buffer_load_dwordx4 v176, s[12:15], s41 offen lds
    v_mfma_f32_16x16x32_bf16 v[16:19], v[136:139], v[116:119], v[16:19]
    v_mfma_f32_16x16x32_bf16 v[36:39], v[140:143], v[116:119], v[36:39]
    v_mfma_f32_16x16x32_bf16 v[56:59], v[144:147], v[116:119], v[56:59]
    v_mfma_f32_16x16x32_bf16 v[76:79], v[148:151], v[116:119], v[76:79]
    v_mfma_f32_16x16x32_bf16 v[206:209], v[152:155], v[116:119], v[206:209]
    v_mfma_f32_16x16x32_bf16 v[210:213], v[116:119], v[116:119], v[210:213]
    s_waitcnt vmcnt(7) lgkmcnt(0)
    s_barrier
    v_mfma_f32_16x16x32_bf16 v[0:3], v[120:123], v[80:83], v[0:3]
    v_cndmask_b32 v96, v96, v196, s[44:45]
    v_cndmask_b32 v97, v97, v196, s[44:45]
    v_mfma_f32_16x16x32_bf16 v[20:23], v[124:127], v[80:83], v[20:23]
    v_cndmask_b32 v98, v98, v196, s[44:45]
    v_cndmask_b32 v99, v99, v196, s[44:45]
    v_mfma_f32_16x16x32_bf16 v[40:43], v[128:131], v[80:83], v[40:43]
    ds_read_b128 v[100:103], v161 offset:20480
    ds_read_b128 v[104:107], v163 offset:20480
    v_mfma_f32_16x16x32_bf16 v[60:63], v[132:135], v[80:83], v[60:63]
    ds_read_b128 v[108:111], v165 offset:20480
    ds_read_b128 v[112:115], v167 offset:20480
    v_mfma_f32_16x16x32_bf16 v[4:7], v[120:123], v[84:87], v[4:7]
    ds_read_b128 v[116:119], v169 offset:20480
    ds_read_b64_tr_b16 v[136:137], v170 offset:32768
    v_mfma_f32_16x16x32_bf16 v[24:27], v[124:127], v[84:87], v[24:27]
    ds_read_b64_tr_b16 v[138:139], v170 offset:34816
    ds_read_b64_tr_b16 v[140:141], v171 offset:32768
    v_mfma_f32_16x16x32_bf16 v[44:47], v[128:131], v[84:87], v[44:47]
    ds_read_b64_tr_b16 v[142:143], v171 offset:34816
    ds_read_b64_tr_b16 v[144:145], v172 offset:32768
    v_mfma_f32_16x16x32_bf16 v[64:67], v[132:135], v[84:87], v[64:67]
    ds_read_b64_tr_b16 v[146:147], v172 offset:34816
    ds_read_b64_tr_b16 v[148:149], v173 offset:32768
    v_mfma_f32_16x16x32_bf16 v[8:11], v[120:123], v[88:91], v[8:11]
    ds_read_b64_tr_b16 v[150:151], v173 offset:34816
    s_add_u32 m0, s33, 16384
    v_mfma_f32_16x16x32_bf16 v[28:31], v[124:127], v[88:91], v[28:31]
    s_add_u32 s40, s36, 774144
    buffer_load_dwordx4 v177, s[16:19], s40 offen lds
    v_mfma_f32_16x16x32_bf16 v[48:51], v[128:131], v[88:91], v[48:51]
    s_add_u32 m0, s33, 18432
    s_add_u32 s40, s36, 787968
    v_mfma_f32_16x16x32_bf16 v[68:71], v[132:135], v[88:91], v[68:71]
    buffer_load_dwordx4 v177, s[16:19], s40 offen lds
    s_add_u32 m0, s33, 24576
    v_mfma_f32_16x16x32_bf16 v[12:15], v[120:123], v[92:95], v[12:15]
    s_add_u32 s40, s36, 829440
    buffer_load_dwordx4 v177, s[16:19], s40 offen lds
    v_mfma_f32_16x16x32_bf16 v[32:35], v[124:127], v[92:95], v[32:35]
    s_add_u32 m0, s33, 26624
    s_add_u32 s40, s36, 843264
    v_mfma_f32_16x16x32_bf16 v[52:55], v[128:131], v[92:95], v[52:55]
    buffer_load_dwordx4 v177, s[16:19], s40 offen lds
    v_mfma_f32_16x16x32_bf16 v[72:75], v[132:135], v[92:95], v[72:75]
    v_mfma_f32_16x16x32_bf16 v[198:201], v[152:155], v[80:83], v[198:201]
    v_mfma_f32_16x16x32_bf16 v[202:205], v[80:83], v[80:83], v[202:205]
    v_mfma_f32_16x16x32_bf16 v[16:19], v[120:123], v[96:99], v[16:19]
    v_mfma_f32_16x16x32_bf16 v[36:39], v[124:127], v[96:99], v[36:39]
    v_mfma_f32_16x16x32_bf16 v[56:59], v[128:131], v[96:99], v[56:59]
    v_mfma_f32_16x16x32_bf16 v[76:79], v[132:135], v[96:99], v[76:79]
    v_mfma_f32_16x16x32_bf16 v[206:209], v[152:155], v[96:99], v[206:209]
    v_mfma_f32_16x16x32_bf16 v[210:213], v[96:99], v[96:99], v[210:213]
    s_waitcnt vmcnt(7) lgkmcnt(0)
    s_barrier
    v_mfma_f32_16x16x32_bf16 v[0:3], v[136:139], v[100:103], v[0:3]
    v_cndmask_b32 v116, v116, v196, s[44:45]
    v_cndmask_b32 v117, v117, v196, s[44:45]
    v_mfma_f32_16x16x32_bf16 v[20:23], v[140:143], v[100:103], v[20:23]
    v_cndmask_b32 v118, v118, v196, s[44:45]
    v_cndmask_b32 v119, v119, v196, s[44:45]
    v_mfma_f32_16x16x32_bf16 v[40:43], v[144:147], v[100:103], v[40:43]
    ds_read_b128 v[80:83], v160 offset:0
    ds_read_b128 v[84:87], v162 offset:0
    v_mfma_f32_16x16x32_bf16 v[60:63], v[148:151], v[100:103], v[60:63]
    ds_read_b128 v[88:91], v164 offset:0
    ds_read_b128 v[92:95], v166 offset:0
    v_mfma_f32_16x16x32_bf16 v[4:7], v[136:139], v[104:107], v[4:7]
    ds_read_b128 v[96:99], v168 offset:0
    ds_read_b64_tr_b16 v[120:121], v170 offset:0
    v_mfma_f32_16x16x32_bf16 v[24:27], v[140:143], v[104:107], v[24:27]
    ds_read_b64_tr_b16 v[122:123], v170 offset:2048
    ds_read_b64_tr_b16 v[124:125], v171 offset:0
    v_mfma_f32_16x16x32_bf16 v[44:47], v[144:147], v[104:107], v[44:47]
    ds_read_b64_tr_b16 v[126:127], v171 offset:2048
    ds_read_b64_tr_b16 v[128:129], v172 offset:0
    v_mfma_f32_16x16x32_bf16 v[64:67], v[148:151], v[104:107], v[64:67]
    ds_read_b64_tr_b16 v[130:131], v172 offset:2048
    ds_read_b64_tr_b16 v[132:133], v173 offset:0
    v_mfma_f32_16x16x32_bf16 v[8:11], v[136:139], v[108:111], v[8:11]
    ds_read_b64_tr_b16 v[134:135], v173 offset:2048
    s_add_u32 m0, s33, 32768
    v_mfma_f32_16x16x32_bf16 v[28:31], v[140:143], v[108:111], v[28:31]
    s_add_u32 s40, s36, 884736
    buffer_load_dwordx4 v177, s[16:19], s40 offen lds
    v_mfma_f32_16x16x32_bf16 v[48:51], v[144:147], v[108:111], v[48:51]
    s_add_u32 m0, s33, 34816
    s_add_u32 s40, s36, 898560
    v_mfma_f32_16x16x32_bf16 v[68:71], v[148:151], v[108:111], v[68:71]
    buffer_load_dwordx4 v177, s[16:19], s40 offen lds
    s_add_u32 m0, s33, 40960
    v_mfma_f32_16x16x32_bf16 v[12:15], v[136:139], v[112:115], v[12:15]
    s_add_u32 s40, s36, 940032
    buffer_load_dwordx4 v177, s[16:19], s40 offen lds
    v_mfma_f32_16x16x32_bf16 v[32:35], v[140:143], v[112:115], v[32:35]
    s_add_u32 m0, s33, 43008
    s_add_u32 s40, s36, 953856
    v_mfma_f32_16x16x32_bf16 v[52:55], v[144:147], v[112:115], v[52:55]
    buffer_load_dwordx4 v177, s[16:19], s40 offen lds
    s_add_u32 s41, s37, 640
    v_mfma_f32_16x16x32_bf16 v[72:75], v[148:151], v[112:115], v[72:75]
    s_add_u32 m0, s34, 69632
    s_nop 0
    buffer_load_dwordx4 v174, s[12:15], s41 offen lds
    v_mfma_f32_16x16x32_bf16 v[198:201], v[152:155], v[100:103], v[198:201]
    s_add_u32 m0, s34, 73728
    s_nop 0
    buffer_load_dwordx4 v175, s[12:15], s41 offen lds
    v_mfma_f32_16x16x32_bf16 v[202:205], v[100:103], v[100:103], v[202:205]
    s_add_u32 m0, s35, 77824
    s_nop 0
    buffer_load_dwordx4 v176, s[12:15], s41 offen lds
    v_mfma_f32_16x16x32_bf16 v[16:19], v[136:139], v[116:119], v[16:19]
    v_mfma_f32_16x16x32_bf16 v[36:39], v[140:143], v[116:119], v[36:39]
    v_mfma_f32_16x16x32_bf16 v[56:59], v[144:147], v[116:119], v[56:59]
    v_mfma_f32_16x16x32_bf16 v[76:79], v[148:151], v[116:119], v[76:79]
    v_mfma_f32_16x16x32_bf16 v[206:209], v[152:155], v[116:119], v[206:209]
    v_mfma_f32_16x16x32_bf16 v[210:213], v[116:119], v[116:119], v[210:213]
    s_add_u32 s36, s36, 663552
    s_add_u32 s37, s37, 384
    s_add_u32 s38, s38, 1
    s_cmp_lt_u32 s38, 3
    s_cbranch_scc1 L_k1_kernel_kloop
    s_waitcnt vmcnt(0) lgkmcnt(0)
    s_load_dwordx2 s[52:53], s[0:1], 48
    s_lshl_b32 s42, s2, 2
    s_add_u32 s42, s42, s30
    s_mul_i32 s42, s42, 5248
    v_lshlrev_b32 v238, 7, v180
    v_min_u32 v238, 5120, v238
    s_waitcnt lgkmcnt(0)
    s_mov_b32 s12, s52
    s_mov_b32 s13, s53
    s_mov_b32 s14, 5308416
    s_mov_b32 s15, 0x20000
    buffer_load_dword v239, v238, s[12:15], s42 offen
    v_and_b32 v184, 3, v183
    v_lshrrev_b32 v185, 2, v183
    v_cmp_eq_u32 s[48:49], v185, v182
    v_cmp_eq_u32 vcc, 1, v184
    s_nop 1
    v_cndmask_b32 v156, v202, v203, vcc
    v_cmp_eq_u32 vcc, 2, v184
    s_nop 1
    v_cndmask_b32 v156, v156, v204, vcc
    v_cmp_eq_u32 vcc, 3, v184
    s_nop 1
    v_cndmask_b32 v156, v156, v205, vcc
    v_cmp_eq_u32 vcc, 1, v184
    s_nop 1
    v_cndmask_b32 v157, v210, v211, vcc
    v_cmp_eq_u32 vcc, 2, v184
    s_nop 1
    v_cndmask_b32 v157, v157, v212, vcc
    v_cmp_eq_u32 vcc, 3, v184
    s_nop 1
    v_cndmask_b32 v157, v157, v213, vcc
    v_mul_f32 v198, 0x3ae38e39, v198
    v_mul_f32 v156, 0x3ae38e39, v156
    v_fma_f32 v156, -v198, v198, v156
    v_max_f32 v156, 0, v156
    v_cvt_pk_bf16_f32 v158, v198, v156
    v_lshlrev_b32 v198, 16, v158
    v_and_b32 v156, 0xffff0000, v158
    v_sub_f32 v244, 0, v198
    v_add_f32 v156, 0x3727c5ac, v156
    v_cvt_pk_bf16_f32 v156, v156, v156
    v_lshlrev_b32 v156, 16, v156
    v_sqrt_f32 v156, v156
    s_nop 0
    v_cvt_pk_bf16_f32 v156, v156, v156
    v_lshlrev_b32 v156, 16, v156
    v_rcp_f32 v245, v156
    v_mul_f32 v206, 0x3ae38e39, v206
    v_mul_f32 v157, 0x3ae38e39, v157
    v_fma_f32 v157, -v206, v206, v157
    v_max_f32 v157, 0, v157
    v_cvt_pk_bf16_f32 v159, v206, v157
    v_lshlrev_b32 v206, 16, v159
    v_and_b32 v157, 0xffff0000, v159
    v_sub_f32 v252, 0, v206
    v_add_f32 v157, 0x3727c5ac, v157
    v_cvt_pk_bf16_f32 v157, v157, v157
    v_lshlrev_b32 v157, 16, v157
    v_sqrt_f32 v157, v157
    s_nop 0
    v_cvt_pk_bf16_f32 v157, v157, v157
    v_lshlrev_b32 v157, 16, v157
    v_rcp_f32 v253, v157
    v_lshlrev_b32 v184, 3, v183
    v_add_u32 v184, 80384, v184
    s_mov_b64 exec, s[48:49]
    ds_write_b64 v230, v[244:245]
    ds_write_b64 v184, v[252:253]
    s_mov_b64 exec, -1
    v_mov_b32_dpp v80, v16 row_newbcast:0 row_mask:0xf bank_mask:0xf
    v_mov_b32_dpp v81, v17 row_newbcast:0 row_mask:0xf bank_mask:0xf
    v_mov_b32_dpp v82, v18 row_newbcast:0 row_mask:0xf bank_mask:0xf
    v_mov_b32_dpp v83, v19 row_newbcast:0 row_mask:0xf bank_mask:0xf
    v_mov_b32_dpp v84, v36 row_newbcast:0 row_mask:0xf bank_mask:0xf
    v_mov_b32_dpp v85, v37 row_newbcast:0 row_mask:0xf bank_mask:0xf
    v_mov_b32_dpp v86, v38 row_newbcast:0 row_mask:0xf bank_mask:0xf
    v_mov_b32_dpp v87, v39 row_newbcast:0 row_mask:0xf bank_mask:0xf
    v_mov_b32_dpp v88, v56 row_newbcast:0 row_mask:0xf bank_mask:0xf
    v_mov_b32_dpp v89, v57 row_newbcast:0 row_mask:0xf bank_mask:0xf
    v_mov_b32_dpp v90, v58 row_newbcast:0 row_mask:0xf bank_mask:0xf
    v_mov_b32_dpp v91, v59 row_newbcast:0 row_mask:0xf bank_mask:0xf
    v_mov_b32_dpp v92, v76 row_newbcast:0 row_mask:0xf bank_mask:0xf
    v_mov_b32_dpp v93, v77 row_newbcast:0 row_mask:0xf bank_mask:0xf
    v_mov_b32_dpp v94, v78 row_newbcast:0 row_mask:0xf bank_mask:0xf
    v_mov_b32_dpp v95, v79 row_newbcast:0 row_mask:0xf bank_mask:0xf
    s_waitcnt lgkmcnt(0)
    s_barrier
    ds_read_b64 v[244:245], v230
    ds_read_b64 v[246:247], v231
    ds_read_b64 v[248:249], v232
    ds_read_b64 v[250:251], v233
    ds_read_b64 v[252:253], v184
    s_waitcnt lgkmcnt(0)
    v_pk_fma_f32 v[0:1], v[244:245], v[80:81], v[0:1] op_sel:[0,0,0] op_sel_hi:[0,1,1]
    v_pk_fma_f32 v[2:3], v[244:245], v[82:83], v[2:3] op_sel:[0,0,0] op_sel_hi:[0,1,1]
    v_pk_mul_f32 v[0:1], v[244:245], v[0:1] op_sel:[1,0] op_sel_hi:[1,1]
    v_pk_mul_f32 v[2:3], v[244:245], v[2:3] op_sel:[1,0] op_sel_hi:[1,1]
    v_cvt_pk_bf16_f32 v120, v0, v1
    v_add_u32 v121, v224, v216
    ds_write_b32 v121, v120
    v_cvt_pk_bf16_f32 v122, v2, v3
    v_add_u32 v123, v224, v217
    ds_write_b32 v123, v122
    v_pk_fma_f32 v[20:21], v[244:245], v[84:85], v[20:21] op_sel:[0,0,0] op_sel_hi:[0,1,1]
    v_pk_fma_f32 v[22:23], v[244:245], v[86:87], v[22:23] op_sel:[0,0,0] op_sel_hi:[0,1,1]
    v_pk_mul_f32 v[20:21], v[244:245], v[20:21] op_sel:[1,0] op_sel_hi:[1,1]
    v_pk_mul_f32 v[22:23], v[244:245], v[22:23] op_sel:[1,0] op_sel_hi:[1,1]
    v_cvt_pk_bf16_f32 v124, v20, v21
    v_add_u32 v125, v224, v218
    ds_write_b32 v125, v124
    v_cvt_pk_bf16_f32 v126, v22, v23
    v_add_u32 v127, v224, v219
    ds_write_b32 v127, v126
    v_pk_fma_f32 v[40:41], v[244:245], v[88:89], v[40:41] op_sel:[0,0,0] op_sel_hi:[0,1,1]
    v_pk_fma_f32 v[42:43], v[244:245], v[90:91], v[42:43] op_sel:[0,0,0] op_sel_hi:[0,1,1]
    v_pk_mul_f32 v[40:41], v[244:245], v[40:41] op_sel:[1,0] op_sel_hi:[1,1]
    v_pk_mul_f32 v[42:43], v[244:245], v[42:43] op_sel:[1,0] op_sel_hi:[1,1]
    v_cvt_pk_bf16_f32 v128, v40, v41
    v_add_u32 v129, v224, v220
    ds_write_b32 v129, v128
    v_cvt_pk_bf16_f32 v130, v42, v43
    v_add_u32 v131, v224, v221
    ds_write_b32 v131, v130
    v_pk_fma_f32 v[60:61], v[244:245], v[92:93], v[60:61] op_sel:[0,0,0] op_sel_hi:[0,1,1]
    v_pk_fma_f32 v[62:63], v[244:245], v[94:95], v[62:63] op_sel:[0,0,0] op_sel_hi:[0,1,1]
    v_pk_mul_f32 v[60:61], v[244:245], v[60:61] op_sel:[1,0] op_sel_hi:[1,1]
    v_pk_mul_f32 v[62:63], v[244:245], v[62:63] op_sel:[1,0] op_sel_hi:[1,1]
    v_cvt_pk_bf16_f32 v132, v60, v61
    v_add_u32 v133, v224, v222
    ds_write_b32 v133, v132
    v_cvt_pk_bf16_f32 v134, v62, v63
    v_add_u32 v135, v224, v223
    ds_write_b32 v135, v134
    v_pk_fma_f32 v[16:17], v[252:253], v[80:81], v[16:17] op_sel:[0,0,0] op_sel_hi:[0,1,1]
    v_pk_fma_f32 v[18:19], v[252:253], v[82:83], v[18:19] op_sel:[0,0,0] op_sel_hi:[0,1,1]
    v_pk_mul_f32 v[16:17], v[252:253], v[16:17] op_sel:[1,0] op_sel_hi:[1,1]
    v_pk_mul_f32 v[18:19], v[252:253], v[18:19] op_sel:[1,0] op_sel_hi:[1,1]
    v_cvt_pk_bf16_f32 v120, v16, v17
    v_add_u32 v121, v228, v216
    ds_write_b32 v121, v120
    v_cvt_pk_bf16_f32 v122, v18, v19
    v_add_u32 v123, v228, v217
    ds_write_b32 v123, v122
    v_pk_fma_f32 v[36:37], v[252:253], v[84:85], v[36:37] op_sel:[0,0,0] op_sel_hi:[0,1,1]
    v_pk_fma_f32 v[38:39], v[252:253], v[86:87], v[38:39] op_sel:[0,0,0] op_sel_hi:[0,1,1]
    v_pk_mul_f32 v[36:37], v[252:253], v[36:37] op_sel:[1,0] op_sel_hi:[1,1]
    v_pk_mul_f32 v[38:39], v[252:253], v[38:39] op_sel:[1,0] op_sel_hi:[1,1]
    v_cvt_pk_bf16_f32 v124, v36, v37
    v_add_u32 v125, v228, v218
    ds_write_b32 v125, v124
    v_cvt_pk_bf16_f32 v126, v38, v39
    v_add_u32 v127, v228, v219
    ds_write_b32 v127, v126
    v_pk_fma_f32 v[56:57], v[252:253], v[88:89], v[56:57] op_sel:[0,0,0] op_sel_hi:[0,1,1]
    v_pk_fma_f32 v[58:59], v[252:253], v[90:91], v[58:59] op_sel:[0,0,0] op_sel_hi:[0,1,1]
    v_pk_mul_f32 v[56:57], v[252:253], v[56:57] op_sel:[1,0] op_sel_hi:[1,1]
    v_pk_mul_f32 v[58:59], v[252:253], v[58:59] op_sel:[1,0] op_sel_hi:[1,1]
    v_cvt_pk_bf16_f32 v128, v56, v57
    v_add_u32 v129, v228, v220
    ds_write_b32 v129, v128
    v_cvt_pk_bf16_f32 v130, v58, v59
    v_add_u32 v131, v228, v221
    ds_write_b32 v131, v130
    v_pk_fma_f32 v[76:77], v[252:253], v[92:93], v[76:77] op_sel:[0,0,0] op_sel_hi:[0,1,1]
    v_pk_fma_f32 v[78:79], v[252:253], v[94:95], v[78:79] op_sel:[0,0,0] op_sel_hi:[0,1,1]
    v_pk_mul_f32 v[76:77], v[252:253], v[76:77] op_sel:[1,0] op_sel_hi:[1,1]
    v_pk_mul_f32 v[78:79], v[252:253], v[78:79] op_sel:[1,0] op_sel_hi:[1,1]
    v_cvt_pk_bf16_f32 v132, v76, v77
    v_add_u32 v133, v228, v222
    ds_write_b32 v133, v132
    v_cvt_pk_bf16_f32 v134, v78, v79
    v_add_u32 v135, v228, v223
    ds_write_b32 v135, v134
    v_pk_fma_f32 v[4:5], v[246:247], v[80:81], v[4:5] op_sel:[0,0,0] op_sel_hi:[0,1,1]
    v_pk_fma_f32 v[6:7], v[246:247], v[82:83], v[6:7] op_sel:[0,0,0] op_sel_hi:[0,1,1]
    v_pk_mul_f32 v[4:5], v[246:247], v[4:5] op_sel:[1,0] op_sel_hi:[1,1]
    v_pk_mul_f32 v[6:7], v[246:247], v[6:7] op_sel:[1,0] op_sel_hi:[1,1]
    v_cvt_pk_bf16_f32 v120, v4, v5
    v_add_u32 v121, v225, v216
    ds_write_b32 v121, v120
    v_cvt_pk_bf16_f32 v122, v6, v7
    v_add_u32 v123, v225, v217
    ds_write_b32 v123, v122
    v_pk_fma_f32 v[24:25], v[246:247], v[84:85], v[24:25] op_sel:[0,0,0] op_sel_hi:[0,1,1]
    v_pk_fma_f32 v[26:27], v[246:247], v[86:87], v[26:27] op_sel:[0,0,0] op_sel_hi:[0,1,1]
    v_pk_mul_f32 v[24:25], v[246:247], v[24:25] op_sel:[1,0] op_sel_hi:[1,1]
    v_pk_mul_f32 v[26:27], v[246:247], v[26:27] op_sel:[1,0] op_sel_hi:[1,1]
    v_cvt_pk_bf16_f32 v124, v24, v25
    v_add_u32 v125, v225, v218
    ds_write_b32 v125, v124
    v_cvt_pk_bf16_f32 v126, v26, v27
    v_add_u32 v127, v225, v219
    ds_write_b32 v127, v126
    v_pk_fma_f32 v[44:45], v[246:247], v[88:89], v[44:45] op_sel:[0,0,0] op_sel_hi:[0,1,1]
    v_pk_fma_f32 v[46:47], v[246:247], v[90:91], v[46:47] op_sel:[0,0,0] op_sel_hi:[0,1,1]
    v_pk_mul_f32 v[44:45], v[246:247], v[44:45] op_sel:[1,0] op_sel_hi:[1,1]
    v_pk_mul_f32 v[46:47], v[246:247], v[46:47] op_sel:[1,0] op_sel_hi:[1,1]
    v_cvt_pk_bf16_f32 v128, v44, v45
    v_add_u32 v129, v225, v220
    ds_write_b32 v129, v128
    v_cvt_pk_bf16_f32 v130, v46, v47
    v_add_u32 v131, v225, v221
    ds_write_b32 v131, v130
    v_pk_fma_f32 v[64:65], v[246:247], v[92:93], v[64:65] op_sel:[0,0,0] op_sel_hi:[0,1,1]
    v_pk_fma_f32 v[66:67], v[246:247], v[94:95], v[66:67] op_sel:[0,0,0] op_sel_hi:[0,1,1]
    v_pk_mul_f32 v[64:65], v[246:247], v[64:65] op_sel:[1,0] op_sel_hi:[1,1]
    v_pk_mul_f32 v[66:67], v[246:247], v[66:67] op_sel:[1,0] op_sel_hi:[1,1]
    v_cvt_pk_bf16_f32 v132, v64, v65
    v_add_u32 v133, v225, v222
    ds_write_b32 v133, v132
    v_cvt_pk_bf16_f32 v134, v66, v67
    v_add_u32 v135, v225, v223
    ds_write_b32 v135, v134
    v_pk_fma_f32 v[8:9], v[248:249], v[80:81], v[8:9] op_sel:[0,0,0] op_sel_hi:[0,1,1]
    v_pk_fma_f32 v[10:11], v[248:249], v[82:83], v[10:11] op_sel:[0,0,0] op_sel_hi:[0,1,1]
    v_pk_mul_f32 v[8:9], v[248:249], v[8:9] op_sel:[1,0] op_sel_hi:[1,1]
    v_pk_mul_f32 v[10:11], v[248:249], v[10:11] op_sel:[1,0] op_sel_hi:[1,1]
    v_cvt_pk_bf16_f32 v120, v8, v9
    v_add_u32 v121, v226, v216
    ds_write_b32 v121, v120
    v_cvt_pk_bf16_f32 v122, v10, v11
    v_add_u32 v123, v226, v217
    ds_write_b32 v123, v122
    v_pk_fma_f32 v[28:29], v[248:249], v[84:85], v[28:29] op_sel:[0,0,0] op_sel_hi:[0,1,1]
    v_pk_fma_f32 v[30:31], v[248:249], v[86:87], v[30:31] op_sel:[0,0,0] op_sel_hi:[0,1,1]
    v_pk_mul_f32 v[28:29], v[248:249], v[28:29] op_sel:[1,0] op_sel_hi:[1,1]
    v_pk_mul_f32 v[30:31], v[248:249], v[30:31] op_sel:[1,0] op_sel_hi:[1,1]
    v_cvt_pk_bf16_f32 v124, v28, v29
    v_add_u32 v125, v226, v218
    ds_write_b32 v125, v124
    v_cvt_pk_bf16_f32 v126, v30, v31
    v_add_u32 v127, v226, v219
    ds_write_b32 v127, v126
    v_pk_fma_f32 v[48:49], v[248:249], v[88:89], v[48:49] op_sel:[0,0,0] op_sel_hi:[0,1,1]
    v_pk_fma_f32 v[50:51], v[248:249], v[90:91], v[50:51] op_sel:[0,0,0] op_sel_hi:[0,1,1]
    v_pk_mul_f32 v[48:49], v[248:249], v[48:49] op_sel:[1,0] op_sel_hi:[1,1]
    v_pk_mul_f32 v[50:51], v[248:249], v[50:51] op_sel:[1,0] op_sel_hi:[1,1]
    v_cvt_pk_bf16_f32 v128, v48, v49
    v_add_u32 v129, v226, v220
    ds_write_b32 v129, v128
    v_cvt_pk_bf16_f32 v130, v50, v51
    v_add_u32 v131, v226, v221
    ds_write_b32 v131, v130
    v_pk_fma_f32 v[68:69], v[248:249], v[92:93], v[68:69] op_sel:[0,0,0] op_sel_hi:[0,1,1]
    v_pk_fma_f32 v[70:71], v[248:249], v[94:95], v[70:71] op_sel:[0,0,0] op_sel_hi:[0,1,1]
    v_pk_mul_f32 v[68:69], v[248:249], v[68:69] op_sel:[1,0] op_sel_hi:[1,1]
    v_pk_mul_f32 v[70:71], v[248:249], v[70:71] op_sel:[1,0] op_sel_hi:[1,1]
    v_cvt_pk_bf16_f32 v132, v68, v69
    v_add_u32 v133, v226, v222
    ds_write_b32 v133, v132
    v_cvt_pk_bf16_f32 v134, v70, v71
    v_add_u32 v135, v226, v223
    ds_write_b32 v135, v134
    v_pk_fma_f32 v[12:13], v[250:251], v[80:81], v[12:13] op_sel:[0,0,0] op_sel_hi:[0,1,1]
    v_pk_fma_f32 v[14:15], v[250:251], v[82:83], v[14:15] op_sel:[0,0,0] op_sel_hi:[0,1,1]
    v_pk_mul_f32 v[12:13], v[250:251], v[12:13] op_sel:[1,0] op_sel_hi:[1,1]
    v_pk_mul_f32 v[14:15], v[250:251], v[14:15] op_sel:[1,0] op_sel_hi:[1,1]
    v_cvt_pk_bf16_f32 v120, v12, v13
    v_add_u32 v121, v227, v216
    ds_write_b32 v121, v120
    v_cvt_pk_bf16_f32 v122, v14, v15
    v_add_u32 v123, v227, v217
    ds_write_b32 v123, v122
    v_pk_fma_f32 v[32:33], v[250:251], v[84:85], v[32:33] op_sel:[0,0,0] op_sel_hi:[0,1,1]
    v_pk_fma_f32 v[34:35], v[250:251], v[86:87], v[34:35] op_sel:[0,0,0] op_sel_hi:[0,1,1]
    v_pk_mul_f32 v[32:33], v[250:251], v[32:33] op_sel:[1,0] op_sel_hi:[1,1]
    v_pk_mul_f32 v[34:35], v[250:251], v[34:35] op_sel:[1,0] op_sel_hi:[1,1]
    v_cvt_pk_bf16_f32 v124, v32, v33
    v_add_u32 v125, v227, v218
    ds_write_b32 v125, v124
    v_cvt_pk_bf16_f32 v126, v34, v35
    v_add_u32 v127, v227, v219
    ds_write_b32 v127, v126
    v_pk_fma_f32 v[52:53], v[250:251], v[88:89], v[52:53] op_sel:[0,0,0] op_sel_hi:[0,1,1]
    v_pk_fma_f32 v[54:55], v[250:251], v[90:91], v[54:55] op_sel:[0,0,0] op_sel_hi:[0,1,1]
    v_pk_mul_f32 v[52:53], v[250:251], v[52:53] op_sel:[1,0] op_sel_hi:[1,1]
    v_pk_mul_f32 v[54:55], v[250:251], v[54:55] op_sel:[1,0] op_sel_hi:[1,1]
    v_cvt_pk_bf16_f32 v128, v52, v53
    v_add_u32 v129, v227, v220
    ds_write_b32 v129, v128
    v_cvt_pk_bf16_f32 v130, v54, v55
    v_add_u32 v131, v227, v221
    ds_write_b32 v131, v130
    v_pk_fma_f32 v[72:73], v[250:251], v[92:93], v[72:73] op_sel:[0,0,0] op_sel_hi:[0,1,1]
    v_pk_fma_f32 v[74:75], v[250:251], v[94:95], v[74:75] op_sel:[0,0,0] op_sel_hi:[0,1,1]
    v_pk_mul_f32 v[72:73], v[250:251], v[72:73] op_sel:[1,0] op_sel_hi:[1,1]
    v_pk_mul_f32 v[74:75], v[250:251], v[74:75] op_sel:[1,0] op_sel_hi:[1,1]
    v_cvt_pk_bf16_f32 v132, v72, v73
    v_add_u32 v133, v227, v222
    ds_write_b32 v133, v132
    v_cvt_pk_bf16_f32 v134, v74, v75
    v_add_u32 v135, v227, v223
    ds_write_b32 v135, v134
    s_waitcnt lgkmcnt(0)
    s_barrier
    v_add_u32 v185, 2, v180
    v_mul_u32_u24 v185, 592, v185
    v_mul_u32_u24 v186, 48, v181
    v_add_u32 v184, v185, v186
    ds_read_b128 v[0:3], v184 offset:8288
    ds_read_b128 v[4:7], v184 offset:8304
    ds_read_b32 v8, v184 offset:8320
    ds_read_b128 v[10:13], v184 offset:8480
    ds_read_b128 v[14:17], v184 offset:8496
    ds_read_b32 v18, v184 offset:8512
    ds_read_b128 v[20:23], v184 offset:7296
    ds_read_b128 v[24:27], v184 offset:7312
    ds_read_b32 v28, v184 offset:7328
    ds_read_b128 v[30:33], v184 offset:6112
    ds_read_b128 v[34:37], v184 offset:6128
    ds_read_b32 v38, v184 offset:6144
    ds_read_b128 v[40:43], v184 offset:4928
    ds_read_b128 v[44:47], v184 offset:4944
    ds_read_b32 v48, v184 offset:4960
    v_add_u32 v187, s31, v180
    s_waitcnt lgkmcnt(9)
    v_dot2_f32_bf16 v170, v0, v10, 0
    v_dot2_f32_bf16 v170, v1, v11, v170
    v_dot2_f32_bf16 v170, v2, v12, v170
    v_dot2_f32_bf16 v170, v3, v13, v170
    v_dot2_f32_bf16 v170, v4, v14, v170
    v_dot2_f32_bf16 v170, v5, v15, v170
    v_dot2_f32_bf16 v170, v6, v16, v170
    v_dot2_f32_bf16 v170, v7, v17, v170
    v_dot2_f32_bf16 v170, v8, v18, v170
    ds_read_b128 v[50:53], v184 offset:3744
    ds_read_b128 v[54:57], v184 offset:3760
    ds_read_b32 v58, v184 offset:3776
    s_waitcnt lgkmcnt(9)
    v_dot2_f32_bf16 v171, v0, v20, 0
    v_dot2_f32_bf16 v171, v1, v21, v171
    v_dot2_f32_bf16 v171, v2, v22, v171
    v_dot2_f32_bf16 v171, v3, v23, v171
    v_dot2_f32_bf16 v171, v4, v24, v171
    v_dot2_f32_bf16 v171, v5, v25, v171
    v_dot2_f32_bf16 v171, v6, v26, v171
    v_dot2_f32_bf16 v171, v7, v27, v171
    v_dot2_f32_bf16 v171, v8, v28, v171
    ds_read_b128 v[60:63], v184 offset:2560
    ds_read_b128 v[64:67], v184 offset:2576
    ds_read_b32 v68, v184 offset:2592
    s_waitcnt lgkmcnt(9)
    v_dot2_f32_bf16 v172, v0, v30, 0
    v_dot2_f32_bf16 v172, v1, v31, v172
    v_dot2_f32_bf16 v172, v2, v32, v172
    v_dot2_f32_bf16 v172, v3, v33, v172
    v_dot2_f32_bf16 v172, v4, v34, v172
    v_dot2_f32_bf16 v172, v5, v35, v172
    v_dot2_f32_bf16 v172, v6, v36, v172
    v_dot2_f32_bf16 v172, v7, v37, v172
    v_dot2_f32_bf16 v172, v8, v38, v172
    ds_read_b128 v[70:73], v184 offset:1376
    ds_read_b128 v[74:77], v184 offset:1392
    ds_read_b32 v78, v184 offset:1408
    s_waitcnt lgkmcnt(9)
    v_dot2_f32_bf16 v173, v0, v40, 0
    v_dot2_f32_bf16 v173, v1, v41, v173
    v_dot2_f32_bf16 v173, v2, v42, v173
    v_dot2_f32_bf16 v173, v3, v43, v173
    v_dot2_f32_bf16 v173, v4, v44, v173
    v_dot2_f32_bf16 v173, v5, v45, v173
    v_dot2_f32_bf16 v173, v6, v46, v173
    v_dot2_f32_bf16 v173, v7, v47, v173
    v_dot2_f32_bf16 v173, v8, v48, v173
    ds_read_b128 v[80:83], v184 offset:192
    ds_read_b128 v[84:87], v184 offset:208
    ds_read_b32 v88, v184 offset:224
    s_waitcnt lgkmcnt(9)
    v_dot2_f32_bf16 v174, v0, v50, 0
    v_dot2_f32_bf16 v174, v1, v51, v174
    v_dot2_f32_bf16 v174, v2, v52, v174
    v_dot2_f32_bf16 v174, v3, v53, v174
    v_dot2_f32_bf16 v174, v4, v54, v174
    v_dot2_f32_bf16 v174, v5, v55, v174
    v_dot2_f32_bf16 v174, v6, v56, v174
    v_dot2_f32_bf16 v174, v7, v57, v174
    v_dot2_f32_bf16 v174, v8, v58, v174
    ds_read_b128 v[90:93], v184 offset:8672
    ds_read_b128 v[94:97], v184 offset:8688
    ds_read_b32 v98, v184 offset:8704
    s_waitcnt lgkmcnt(9)
    v_dot2_f32_bf16 v175, v0, v60, 0
    v_dot2_f32_bf16 v175, v1, v61, v175
    v_dot2_f32_bf16 v175, v2, v62, v175
    v_dot2_f32_bf16 v175, v3, v63, v175
    v_dot2_f32_bf16 v175, v4, v64, v175
    v_dot2_f32_bf16 v175, v5, v65, v175
    v_dot2_f32_bf16 v175, v6, v66, v175
    v_dot2_f32_bf16 v175, v7, v67, v175
    v_dot2_f32_bf16 v175, v8, v68, v175
    ds_read_b128 v[100:103], v184 offset:7488
    ds_read_b128 v[104:107], v184 offset:7504
    ds_read_b32 v108, v184 offset:7520
    s_waitcnt lgkmcnt(9)
    v_dot2_f32_bf16 v176, v0, v70, 0
    v_dot2_f32_bf16 v176, v1, v71, v176
    v_dot2_f32_bf16 v176, v2, v72, v176
    v_dot2_f32_bf16 v176, v3, v73, v176
    v_dot2_f32_bf16 v176, v4, v74, v176
    v_dot2_f32_bf16 v176, v5, v75, v176
    v_dot2_f32_bf16 v176, v6, v76, v176
    v_dot2_f32_bf16 v176, v7, v77, v176
    v_dot2_f32_bf16 v176, v8, v78, v176
    ds_read_b128 v[110:113], v184 offset:6304
    ds_read_b128 v[114:117], v184 offset:6320
    ds_read_b32 v118, v184 offset:6336
    s_waitcnt lgkmcnt(9)
    v_dot2_f32_bf16 v177, v0, v80, 0
    v_dot2_f32_bf16 v177, v1, v81, v177
    v_dot2_f32_bf16 v177, v2, v82, v177
    v_dot2_f32_bf16 v177, v3, v83, v177
    v_dot2_f32_bf16 v177, v4, v84, v177
    v_dot2_f32_bf16 v177, v5, v85, v177
    v_dot2_f32_bf16 v177, v6, v86, v177
    v_dot2_f32_bf16 v177, v7, v87, v177
    v_dot2_f32_bf16 v177, v8, v88, v177
    ds_read_b128 v[120:123], v184 offset:5120
    ds_read_b128 v[124:127], v184 offset:5136
    ds_read_b32 v128, v184 offset:5152
    v_cvt_pk_bf16_f32 v10, v170, v171
    v_cvt_pk_bf16_f32 v11, v172, v173
    v_cvt_pk_bf16_f32 v12, v174, v175
    v_cvt_pk_bf16_f32 v13, v176, v177
    v_lshlrev_b32 v170, 16, v10
    v_and_b32 v171, 0xffff0000, v10
    v_lshlrev_b32 v172, 16, v11
    v_and_b32 v173, 0xffff0000, v11
    v_lshlrev_b32 v174, 16, v12
    v_and_b32 v175, 0xffff0000, v12
    v_lshlrev_b32 v176, 16, v13
    v_and_b32 v177, 0xffff0000, v13
    v_mul_f32 v170, 0x3e715bef, v170
    v_mul_f32 v171, 0x3e715bef, v171
    v_mul_f32 v172, 0x3e715bef, v172
    v_mul_f32 v173, 0x3e715bef, v173
    v_mul_f32 v174, 0x3e715bef, v174
    v_mul_f32 v175, 0x3e715bef, v175
    v_mul_f32 v176, 0x3e715bef, v176
    v_mul_f32 v177, 0x3e715bef, v177
    v_cvt_pk_bf16_f32 v10, v170, v171
    v_cvt_pk_bf16_f32 v11, v172, v173
    v_cvt_pk_bf16_f32 v12, v174, v175
    v_cvt_pk_bf16_f32 v13, v176, v177
    v_lshlrev_b32 v170, 16, v10
    v_and_b32 v171, 0xffff0000, v10
    v_lshlrev_b32 v172, 16, v11
    v_and_b32 v173, 0xffff0000, v11
    v_lshlrev_b32 v174, 16, v12
    v_and_b32 v175, 0xffff0000, v12
    v_lshlrev_b32 v176, 16, v13
    v_and_b32 v177, 0xffff0000, v13
    v_mov_b32 v14, 0xce6e6b28
    v_cmp_le_u32 vcc, 2, v187
    s_nop 1
    v_cndmask_b32 v171, v14, v171, vcc
    v_cmp_le_u32 vcc, 4, v187
    s_nop 1
    v_cndmask_b32 v172, v14, v172, vcc
    v_cmp_le_u32 vcc, 6, v187
    s_nop 1
    v_cndmask_b32 v173, v14, v173, vcc
    v_cmp_le_u32 vcc, 8, v187
    s_nop 1
    v_cndmask_b32 v174, v14, v174, vcc
    v_cmp_le_u32 vcc, 10, v187
    s_nop 1
    v_cndmask_b32 v175, v14, v175, vcc
    v_cmp_le_u32 vcc, 12, v187
    s_nop 1
    v_cndmask_b32 v176, v14, v176, vcc
    v_cmp_le_u32 vcc, 14, v187
    s_nop 1
    v_cndmask_b32 v177, v14, v177, vcc
    v_max3_f32 v15, v170, v171, v172
    v_max3_f32 v16, v173, v174, v175
    v_max3_f32 v15, v15, v176, v177
    v_max_f32 v15, v15, v16
    v_sub_f32 v170, v170, v15
    v_sub_f32 v171, v171, v15
    v_sub_f32 v172, v172, v15
    v_sub_f32 v173, v173, v15
    v_sub_f32 v174, v174, v15
    v_sub_f32 v175, v175, v15
    v_sub_f32 v176, v176, v15
    v_sub_f32 v177, v177, v15
    s_waitcnt lgkmcnt(0)
    ds_read_b128 v[130:133], v184 offset:3936
    ds_read_b128 v[134:137], v184 offset:3952
    ds_read_b32 v138, v184 offset:3968
    ds_read_b128 v[140:143], v184 offset:2752
    ds_read_b128 v[144:147], v184 offset:2768
    ds_read_b32 v148, v184 offset:2784
    ds_read_b128 v[150:153], v184 offset:1568
    ds_read_b128 v[154:157], v184 offset:1584
    ds_read_b32 v158, v184 offset:1600
    ds_read_b128 v[160:163], v184 offset:384
    ds_read_b128 v[164:167], v184 offset:400
    ds_read_b32 v168, v184 offset:416
    v_mul_f32 v170, 0x3fb8aa3b, v170
    v_mul_f32 v171, 0x3fb8aa3b, v171
    v_mul_f32 v172, 0x3fb8aa3b, v172
    v_mul_f32 v173, 0x3fb8aa3b, v173
    v_mul_f32 v174, 0x3fb8aa3b, v174
    v_mul_f32 v175, 0x3fb8aa3b, v175
    v_mul_f32 v176, 0x3fb8aa3b, v176
    v_mul_f32 v177, 0x3fb8aa3b, v177
    v_exp_f32 v170, v170
    v_exp_f32 v171, v171
    v_exp_f32 v172, v172
    v_exp_f32 v173, v173
    v_exp_f32 v174, v174
    v_exp_f32 v175, v175
    v_exp_f32 v176, v176
    v_exp_f32 v177, v177
    v_add_f32 v15, v170, v171
    v_add_f32 v16, v172, v173
    v_add_f32 v17, v174, v175
    v_add_f32 v18, v176, v177
    v_add_f32 v15, v15, v16
    v_add_f32 v17, v17, v18
    v_add_f32 v15, v15, v17
    v_rcp_f32 v15, v15
    s_nop 0
    v_mul_f32 v170, v15, v170
    v_mul_f32 v171, v15, v171
    v_mul_f32 v172, v15, v172
    v_mul_f32 v173, v15, v173
    v_mul_f32 v174, v15, v174
    v_mul_f32 v175, v15, v175
    v_mul_f32 v176, v15, v176
    v_mul_f32 v177, v15, v177
    v_cvt_pk_bf16_f32 v10, v170, v171
    v_cvt_pk_bf16_f32 v11, v172, v173
    v_cvt_pk_bf16_f32 v12, v174, v175
    v_cvt_pk_bf16_f32 v13, v176, v177
    s_mov_b32 s50, 0x05040100
    s_mov_b32 s51, 0x07060302
    v_perm_b32 v50, v100, v90, s50
    v_perm_b32 v51, v100, v90, s51
    v_dot2_f32_bf16 v30, v50, v10, 0
    v_dot2_f32_bf16 v31, v51, v10, 0
    v_perm_b32 v52, v101, v91, s50
    v_perm_b32 v53, v101, v91, s51
    v_dot2_f32_bf16 v32, v52, v10, 0
    v_dot2_f32_bf16 v33, v53, v10, 0
    v_perm_b32 v54, v102, v92, s50
    v_perm_b32 v55, v102, v92, s51
    v_dot2_f32_bf16 v34, v54, v10, 0
    v_dot2_f32_bf16 v35, v55, v10, 0
    v_perm_b32 v56, v103, v93, s50
    v_perm_b32 v57, v103, v93, s51
    v_dot2_f32_bf16 v36, v56, v10, 0
    v_dot2_f32_bf16 v37, v57, v10, 0
    v_perm_b32 v50, v104, v94, s50
    v_perm_b32 v51, v104, v94, s51
    v_dot2_f32_bf16 v38, v50, v10, 0
    v_dot2_f32_bf16 v39, v51, v10, 0
    v_perm_b32 v52, v105, v95, s50
    v_perm_b32 v53, v105, v95, s51
    v_dot2_f32_bf16 v40, v52, v10, 0
    v_dot2_f32_bf16 v41, v53, v10, 0
    v_perm_b32 v54, v106, v96, s50
    v_perm_b32 v55, v106, v96, s51
    v_dot2_f32_bf16 v42, v54, v10, 0
    v_dot2_f32_bf16 v43, v55, v10, 0
    v_perm_b32 v56, v107, v97, s50
    v_perm_b32 v57, v107, v97, s51
    v_dot2_f32_bf16 v44, v56, v10, 0
    v_dot2_f32_bf16 v45, v57, v10, 0
    v_perm_b32 v50, v108, v98, s50
    v_perm_b32 v51, v108, v98, s51
    v_dot2_f32_bf16 v46, v50, v10, 0
    v_dot2_f32_bf16 v47, v51, v10, 0
    v_perm_b32 v50, v120, v110, s50
    v_perm_b32 v51, v120, v110, s51
    v_dot2_f32_bf16 v30, v50, v11, v30
    v_dot2_f32_bf16 v31, v51, v11, v31
    v_perm_b32 v52, v121, v111, s50
    v_perm_b32 v53, v121, v111, s51
    v_dot2_f32_bf16 v32, v52, v11, v32
    v_dot2_f32_bf16 v33, v53, v11, v33
    v_perm_b32 v54, v122, v112, s50
    v_perm_b32 v55, v122, v112, s51
    v_dot2_f32_bf16 v34, v54, v11, v34
    v_dot2_f32_bf16 v35, v55, v11, v35
    v_perm_b32 v56, v123, v113, s50
    v_perm_b32 v57, v123, v113, s51
    v_dot2_f32_bf16 v36, v56, v11, v36
    v_dot2_f32_bf16 v37, v57, v11, v37
    v_perm_b32 v50, v124, v114, s50
    v_perm_b32 v51, v124, v114, s51
    v_dot2_f32_bf16 v38, v50, v11, v38
    v_dot2_f32_bf16 v39, v51, v11, v39
    v_perm_b32 v52, v125, v115, s50
    v_perm_b32 v53, v125, v115, s51
    v_dot2_f32_bf16 v40, v52, v11, v40
    v_dot2_f32_bf16 v41, v53, v11, v41
    v_perm_b32 v54, v126, v116, s50
    v_perm_b32 v55, v126, v116, s51
    v_dot2_f32_bf16 v42, v54, v11, v42
    v_dot2_f32_bf16 v43, v55, v11, v43
    v_perm_b32 v56, v127, v117, s50
    v_perm_b32 v57, v127, v117, s51
    v_dot2_f32_bf16 v44, v56, v11, v44
    v_dot2_f32_bf16 v45, v57, v11, v45
    v_perm_b32 v50, v128, v118, s50
    v_perm_b32 v51, v128, v118, s51
    v_dot2_f32_bf16 v46, v50, v11, v46
    v_dot2_f32_bf16 v47, v51, v11, v47
    s_waitcnt lgkmcnt(0)
    v_perm_b32 v50, v140, v130, s50
    v_perm_b32 v51, v140, v130, s51
    v_dot2_f32_bf16 v30, v50, v12, v30
    v_dot2_f32_bf16 v31, v51, v12, v31
    v_perm_b32 v52, v141, v131, s50
    v_perm_b32 v53, v141, v131, s51
    v_dot2_f32_bf16 v32, v52, v12, v32
    v_dot2_f32_bf16 v33, v53, v12, v33
    v_perm_b32 v54, v142, v132, s50
    v_perm_b32 v55, v142, v132, s51
    v_dot2_f32_bf16 v34, v54, v12, v34
    v_dot2_f32_bf16 v35, v55, v12, v35
    v_perm_b32 v56, v143, v133, s50
    v_perm_b32 v57, v143, v133, s51
    v_dot2_f32_bf16 v36, v56, v12, v36
    v_dot2_f32_bf16 v37, v57, v12, v37
    v_perm_b32 v50, v144, v134, s50
    v_perm_b32 v51, v144, v134, s51
    v_dot2_f32_bf16 v38, v50, v12, v38
    v_dot2_f32_bf16 v39, v51, v12, v39
    v_perm_b32 v52, v145, v135, s50
    v_perm_b32 v53, v145, v135, s51
    v_dot2_f32_bf16 v40, v52, v12, v40
    v_dot2_f32_bf16 v41, v53, v12, v41
    v_perm_b32 v54, v146, v136, s50
    v_perm_b32 v55, v146, v136, s51
    v_dot2_f32_bf16 v42, v54, v12, v42
    v_dot2_f32_bf16 v43, v55, v12, v43
    v_perm_b32 v56, v147, v137, s50
    v_perm_b32 v57, v147, v137, s51
    v_dot2_f32_bf16 v44, v56, v12, v44
    v_dot2_f32_bf16 v45, v57, v12, v45
    v_perm_b32 v50, v148, v138, s50
    v_perm_b32 v51, v148, v138, s51
    v_dot2_f32_bf16 v46, v50, v12, v46
    v_dot2_f32_bf16 v47, v51, v12, v47
    v_perm_b32 v50, v160, v150, s50
    v_perm_b32 v51, v160, v150, s51
    v_dot2_f32_bf16 v30, v50, v13, v30
    v_dot2_f32_bf16 v31, v51, v13, v31
    v_perm_b32 v52, v161, v151, s50
    v_perm_b32 v53, v161, v151, s51
    v_dot2_f32_bf16 v32, v52, v13, v32
    v_dot2_f32_bf16 v33, v53, v13, v33
    v_perm_b32 v54, v162, v152, s50
    v_perm_b32 v55, v162, v152, s51
    v_dot2_f32_bf16 v34, v54, v13, v34
    v_dot2_f32_bf16 v35, v55, v13, v35
    v_perm_b32 v56, v163, v153, s50
    v_perm_b32 v57, v163, v153, s51
    v_dot2_f32_bf16 v36, v56, v13, v36
    v_dot2_f32_bf16 v37, v57, v13, v37
    v_perm_b32 v50, v164, v154, s50
    v_perm_b32 v51, v164, v154, s51
    v_dot2_f32_bf16 v38, v50, v13, v38
    v_dot2_f32_bf16 v39, v51, v13, v39
    v_perm_b32 v52, v165, v155, s50
    v_perm_b32 v53, v165, v155, s51
    v_dot2_f32_bf16 v40, v52, v13, v40
    v_dot2_f32_bf16 v41, v53, v13, v41
    v_perm_b32 v54, v166, v156, s50
    v_perm_b32 v55, v166, v156, s51
    v_dot2_f32_bf16 v42, v54, v13, v42
    v_dot2_f32_bf16 v43, v55, v13, v43
    v_perm_b32 v56, v167, v157, s50
    v_perm_b32 v57, v167, v157, s51
    v_dot2_f32_bf16 v44, v56, v13, v44
    v_dot2_f32_bf16 v45, v57, v13, v45
    v_perm_b32 v50, v168, v158, s50
    v_perm_b32 v51, v168, v158, s51
    v_dot2_f32_bf16 v46, v50, v13, v46
    v_dot2_f32_bf16 v47, v51, v13, v47
    v_mul_u32_u24 v185, 176, v180
    v_mul_u32_u24 v186, 36, v181
    v_add_u32 v186, v185, v186
    v_cvt_pk_bf16_f32 v0, v30, v31
    ds_write_b32 v186, v0 offset:49152
    v_cvt_pk_bf16_f32 v1, v32, v33
    ds_write_b32 v186, v1 offset:49156
    v_cvt_pk_bf16_f32 v2, v34, v35
    ds_write_b32 v186, v2 offset:49160
    v_cvt_pk_bf16_f32 v3, v36, v37
    ds_write_b32 v186, v3 offset:49164
    v_cvt_pk_bf16_f32 v4, v38, v39
    ds_write_b32 v186, v4 offset:49168
    v_cvt_pk_bf16_f32 v5, v40, v41
    ds_write_b32 v186, v5 offset:49172
    v_cvt_pk_bf16_f32 v6, v42, v43
    ds_write_b32 v186, v6 offset:49176
    v_cvt_pk_bf16_f32 v7, v44, v45
    ds_write_b32 v186, v7 offset:49180
    v_cvt_pk_bf16_f32 v8, v46, v47
    ds_write_b32 v186, v8 offset:49184
    s_add_u32 s20, s4, 0
    s_addc_u32 s21, s5, 0
    s_mov_b32 s22, 2359296
    s_mov_b32 s23, 0x20000
    v_lshlrev_b32 v187, 10, v182
    v_lshl_add_u32 v187, v183, 4, v187
    v_lshl_add_u32 v185, v181, 4, v185
    s_mul_i32 s36, s29, 9
    s_add_u32 s36, s36, s30
    s_mul_i32 s37, s28, 18
    s_waitcnt lgkmcnt(0)
    s_barrier
    ds_read_b128 v[12:15], v185 offset:49152
    ds_read_b128 v[16:19], v185 offset:49216
    ds_read_b128 v[20:23], v185 offset:49280
    s_add_u32 s38, s36, 0
    s_lshr_b32 s39, s38, 2
    s_add_u32 s39, s39, s37
    s_lshl_b32 s39, s39, 12
    s_and_b32 s38, s38, 3
    s_lshl_b32 s38, s38, 8
    s_add_u32 s39, s39, s38
    s_waitcnt lgkmcnt(2)
    buffer_store_dwordx4 v[12:15], v187, s[20:23], s39 offen
    s_add_u32 s38, s36, 4
    s_lshr_b32 s39, s38, 2
    s_add_u32 s39, s39, s37
    s_lshl_b32 s39, s39, 12
    s_and_b32 s38, s38, 3
    s_lshl_b32 s38, s38, 8
    s_add_u32 s39, s39, s38
    s_waitcnt lgkmcnt(1)
    buffer_store_dwordx4 v[16:19], v187, s[20:23], s39 offen
    s_cmp_lg_u32 s30, 0
    s_cbranch_scc1 L_k1_kernel_m_done
    s_add_u32 s38, s36, 8
    s_lshr_b32 s39, s38, 2
    s_add_u32 s39, s39, s37
    s_lshl_b32 s39, s39, 12
    s_and_b32 s38, s38, 3
    s_lshl_b32 s38, s38, 8
    s_add_u32 s39, s39, s38
    s_waitcnt lgkmcnt(0)
    buffer_store_dwordx4 v[20:23], v187, s[20:23], s39 offen
L_k1_kernel_m_done:
    s_endpgm
L_k1_kernel_side:
    s_setprio 3
    s_nop 0
    s_waitcnt lgkmcnt(0)
    s_sub_u32 s3, s2, 256
    s_load_dwordx2 s[4:5], s[0:1], 72
    s_load_dwordx2 s[6:7], s[0:1], 16
    s_load_dwordx4 s[8:11], s[0:1], 32
    s_load_dwordx2 s[12:13], s[0:1], 48
    s_load_dwordx4 s[56:59], s[0:1], 0
    s_load_dwordx2 s[14:15], s[0:1], 64
    v_and_b32 v80, 63, v0
    v_lshrrev_b32 v81, 6, v0
    s_nop 0
    v_readfirstlane_b32 s30, v81
    s_nop 0
    s_lshr_b32 s27, s30, 2
    s_and_b32 s30, s30, 3
    s_mul_i32 s31, s27, 73728
    v_lshlrev_b32 v82, 4, v80
    v_lshrrev_b32 v83, 4, v80
    v_bfe_u32 v84, v80, 2, 2
    v_and_b32 v85, 3, v80
    v_lshl_add_u32 v86, v83, 3, v84
    v_lshlrev_b32 v87, 7, v0
    v_mov_b32 v96, 0
    s_waitcnt lgkmcnt(0)
    s_mov_b32 s20, s4
    s_mov_b32 s21, s5
    s_mov_b32 s22, 67108864
    s_mov_b32 s23, 0x20000
    s_cmp_ge_u32 s3, 20
    s_cbranch_scc1 L_k1_kernel_pk_nz
    s_lshl_b32 s53, s3, 10
    s_add_u32 s53, s53, 9961472
    v_lshlrev_b32 v88, 2, v0
    buffer_store_dword v96, v88, s[20:23], s53 offen
L_k1_kernel_pk_nz:
    s_cmp_ge_u32 s3, 9
    s_cbranch_scc1 L_k1_kernel_pk_not_wo
    s_mov_b32 s16, s6
    s_mov_b32 s17, s7
    s_mov_b32 s18, 663552
    s_mov_b32 s19, 0x20000
    s_mul_i32 s40, s3, 73728
    s_lshl_b32 s41, s30, 10
    s_add_u32 s32, s41, s31
    s_add_u32 s40, s40, s41
    s_add_u32 m0, s32, 0
    s_nop 0
    buffer_load_dwordx4 v82, s[16:19], s40 offen lds
    s_add_u32 s40, s40, 4096
    s_add_u32 m0, s32, 4096
    s_nop 0
    buffer_load_dwordx4 v82, s[16:19], s40 offen lds
    s_add_u32 s40, s40, 4096
    s_add_u32 m0, s32, 8192
    s_nop 0
    buffer_load_dwordx4 v82, s[16:19], s40 offen lds
    s_add_u32 s40, s40, 4096
    s_add_u32 m0, s32, 12288
    s_nop 0
    buffer_load_dwordx4 v82, s[16:19], s40 offen lds
    s_add_u32 s40, s40, 4096
    s_add_u32 m0, s32, 16384
    s_nop 0
    buffer_load_dwordx4 v82, s[16:19], s40 offen lds
    s_add_u32 s40, s40, 4096
    s_add_u32 m0, s32, 20480
    s_nop 0
    buffer_load_dwordx4 v82, s[16:19], s40 offen lds
    s_add_u32 s40, s40, 4096
    s_add_u32 m0, s32, 24576
    s_nop 0
    buffer_load_dwordx4 v82, s[16:19], s40 offen lds
    s_add_u32 s40, s40, 4096
    s_add_u32 m0, s32, 28672
    s_nop 0
    buffer_load_dwordx4 v82, s[16:19], s40 offen lds
    s_add_u32 s40, s40, 4096
    s_add_u32 m0, s32, 32768
    s_nop 0
    buffer_load_dwordx4 v82, s[16:19], s40 offen lds
    s_add_u32 s40, s40, 4096
    s_add_u32 m0, s32, 36864
    s_nop 0
    buffer_load_dwordx4 v82, s[16:19], s40 offen lds
    s_add_u32 s40, s40, 4096
    s_add_u32 m0, s32, 40960
    s_nop 0
    buffer_load_dwordx4 v82, s[16:19], s40 offen lds
    s_add_u32 s40, s40, 4096
    s_add_u32 m0, s32, 45056
    s_nop 0
    buffer_load_dwordx4 v82, s[16:19], s40 offen lds
    s_add_u32 s40, s40, 4096
    s_add_u32 m0, s32, 49152
    s_nop 0
    buffer_load_dwordx4 v82, s[16:19], s40 offen lds
    s_add_u32 s40, s40, 4096
    s_add_u32 m0, s32, 53248
    s_nop 0
    buffer_load_dwordx4 v82, s[16:19], s40 offen lds
    s_add_u32 s40, s40, 4096
    s_add_u32 m0, s32, 57344
    s_nop 0
    buffer_load_dwordx4 v82, s[16:19], s40 offen lds
    s_add_u32 s40, s40, 4096
    s_add_u32 m0, s32, 61440
    s_nop 0
    buffer_load_dwordx4 v82, s[16:19], s40 offen lds
    s_add_u32 s40, s40, 4096
    s_add_u32 m0, s32, 65536
    s_nop 0
    buffer_load_dwordx4 v82, s[16:19], s40 offen lds
    s_add_u32 s40, s40, 4096
    s_add_u32 m0, s32, 69632
    s_nop 0
    buffer_load_dwordx4 v82, s[16:19], s40 offen lds
    s_add_u32 s40, s40, 4096
    v_mul_u32_u24 v88, 1152, v86
    s_mul_i32 s47, s30, 288
    s_add_u32 s47, s47, s31
    v_add_u32 v88, s47, v88
    v_and_b32 v89, 1, v85
    v_lshl_add_u32 v89, v89, 3, v88
    v_lshl_add_u32 v88, v85, 4, v88
    v_and_b32 v93, 7, v80
    v_lshl_add_u32 v93, v83, 3, v93
    v_lshlrev_b32 v93, 4, v93
    v_add_u32 v93, 4096, v93
    s_mul_i32 s54, s30, 165888
    s_mul_i32 s47, s3, 9216
    s_add_u32 s54, s54, s47
    s_add_u32 s54, s54, 10485760
    s_waitcnt vmcnt(9)
    s_barrier
    ds_read_b64_tr_b16 v[0:1], v88 offset:0
    ds_read_b64_tr_b16 v[2:3], v88 offset:4608
    ds_read_b64_tr_b16 v[4:5], v88 offset:8
    ds_read_b64_tr_b16 v[6:7], v88 offset:4616
    ds_read_b64_tr_b16 v[8:9], v88 offset:64
    ds_read_b64_tr_b16 v[10:11], v88 offset:4672
    ds_read_b64_tr_b16 v[12:13], v88 offset:72
    ds_read_b64_tr_b16 v[14:15], v88 offset:4680
    ds_read_b64_tr_b16 v[16:17], v89 offset:128
    ds_read_b64_tr_b16 v[18:19], v89 offset:4736
    s_add_u32 s55, s54, 0
    s_waitcnt lgkmcnt(8)
    buffer_store_dwordx4 v[0:3], v82, s[20:23], s55 offen offset:0
    s_waitcnt lgkmcnt(6)
    buffer_store_dwordx4 v[4:7], v82, s[20:23], s55 offen offset:1024
    s_waitcnt lgkmcnt(4)
    buffer_store_dwordx4 v[8:11], v82, s[20:23], s55 offen offset:2048
    s_waitcnt lgkmcnt(2)
    buffer_store_dwordx4 v[12:15], v82, s[20:23], s55 offen offset:3072
    s_waitcnt lgkmcnt(0)
    buffer_store_dwordx4 v[16:19], v93, s[20:23], s55 offen
    ds_read_b64_tr_b16 v[20:21], v88 offset:144
    ds_read_b64_tr_b16 v[22:23], v88 offset:4752
    ds_read_b64_tr_b16 v[24:25], v88 offset:152
    ds_read_b64_tr_b16 v[26:27], v88 offset:4760
    ds_read_b64_tr_b16 v[28:29], v88 offset:208
    ds_read_b64_tr_b16 v[30:31], v88 offset:4816
    ds_read_b64_tr_b16 v[32:33], v88 offset:216
    ds_read_b64_tr_b16 v[34:35], v88 offset:4824
    ds_read_b64_tr_b16 v[36:37], v89 offset:272
    ds_read_b64_tr_b16 v[38:39], v89 offset:4880
    s_add_u32 s55, s54, 82944
    s_waitcnt lgkmcnt(8)
    buffer_store_dwordx4 v[20:23], v82, s[20:23], s55 offen offset:0
    s_waitcnt lgkmcnt(6)
    buffer_store_dwordx4 v[24:27], v82, s[20:23], s55 offen offset:1024
    s_waitcnt lgkmcnt(4)
    buffer_store_dwordx4 v[28:31], v82, s[20:23], s55 offen offset:2048
    s_waitcnt lgkmcnt(2)
    buffer_store_dwordx4 v[32:35], v82, s[20:23], s55 offen offset:3072
    s_waitcnt lgkmcnt(0)
    buffer_store_dwordx4 v[36:39], v93, s[20:23], s55 offen
    s_waitcnt vmcnt(10)
    s_barrier
    ds_read_b64_tr_b16 v[0:1], v88 offset:36864
    ds_read_b64_tr_b16 v[2:3], v88 offset:41472
    ds_read_b64_tr_b16 v[4:5], v88 offset:36872
    ds_read_b64_tr_b16 v[6:7], v88 offset:41480
    ds_read_b64_tr_b16 v[8:9], v88 offset:36928
    ds_read_b64_tr_b16 v[10:11], v88 offset:41536
    ds_read_b64_tr_b16 v[12:13], v88 offset:36936
    ds_read_b64_tr_b16 v[14:15], v88 offset:41544
    ds_read_b64_tr_b16 v[16:17], v89 offset:36992
    ds_read_b64_tr_b16 v[18:19], v89 offset:41600
    s_add_u32 s55, s54, 4608
    s_waitcnt lgkmcnt(8)
    buffer_store_dwordx4 v[0:3], v82, s[20:23], s55 offen offset:0
    s_waitcnt lgkmcnt(6)
    buffer_store_dwordx4 v[4:7], v82, s[20:23], s55 offen offset:1024
    s_waitcnt lgkmcnt(4)
    buffer_store_dwordx4 v[8:11], v82, s[20:23], s55 offen offset:2048
    s_waitcnt lgkmcnt(2)
    buffer_store_dwordx4 v[12:15], v82, s[20:23], s55 offen offset:3072
    s_waitcnt lgkmcnt(0)
    buffer_store_dwordx4 v[16:19], v93, s[20:23], s55 offen
    ds_read_b64_tr_b16 v[20:21], v88 offset:37008
    ds_read_b64_tr_b16 v[22:23], v88 offset:41616
    ds_read_b64_tr_b16 v[24:25], v88 offset:37016
    ds_read_b64_tr_b16 v[26:27], v88 offset:41624
    ds_read_b64_tr_b16 v[28:29], v88 offset:37072
    ds_read_b64_tr_b16 v[30:31], v88 offset:41680
    ds_read_b64_tr_b16 v[32:33], v88 offset:37080
    ds_read_b64_tr_b16 v[34:35], v88 offset:41688
    ds_read_b64_tr_b16 v[36:37], v89 offset:37136
    ds_read_b64_tr_b16 v[38:39], v89 offset:41744
    s_add_u32 s55, s54, 87552
    s_waitcnt lgkmcnt(8)
    buffer_store_dwordx4 v[20:23], v82, s[20:23], s55 offen offset:0
    s_waitcnt lgkmcnt(6)
    buffer_store_dwordx4 v[24:27], v82, s[20:23], s55 offen offset:1024
    s_waitcnt lgkmcnt(4)
    buffer_store_dwordx4 v[28:31], v82, s[20:23], s55 offen offset:2048
    s_waitcnt lgkmcnt(2)
    buffer_store_dwordx4 v[32:35], v82, s[20:23], s55 offen offset:3072
    s_waitcnt lgkmcnt(0)
    buffer_store_dwordx4 v[36:39], v93, s[20:23], s55 offen
    s_branch L_k1_kernel_pk_fin
L_k1_kernel_pk_not_wo:
    s_sub_u32 s3, s3, 9
    s_and_b32 s45, s3, 1
    s_lshr_b32 s46, s3, 1
    s_cmp_eq_u32 s45, 0
    s_cselect_b32 s16, s8, s10
    s_cselect_b32 s17, s9, s11
    s_mov_b32 s18, 5308416
    s_mov_b32 s19, 0x20000
    v_lshrrev_b32 v88, 3, v80
    v_mul_u32_u24 v88, 9216, v88
    v_and_b32 v89, 7, v80
    v_lshl_add_u32 v88, v89, 4, v88
    s_mul_i32 s40, s30, 73728
    s_lshl_b32 s47, s46, 7
    s_add_u32 s40, s40, s47
    s_lshl_b32 s41, s30, 10
    s_add_u32 s32, s41, s31
    v_mov_b32 v95, v88
    s_add_u32 m0, s32, 0
    s_nop 0
    buffer_load_dwordx4 v95, s[16:19], s40 offen lds
    s_add_u32 s40, s40, 294912
    s_add_u32 m0, s32, 4096
    s_nop 0
    buffer_load_dwordx4 v95, s[16:19], s40 offen lds
    s_add_u32 s40, s40, 294912
    s_add_u32 m0, s32, 8192
    s_nop 0
    buffer_load_dwordx4 v95, s[16:19], s40 offen lds
    s_add_u32 s40, s40, 294912
    s_add_u32 m0, s32, 12288
    s_nop 0
    buffer_load_dwordx4 v95, s[16:19], s40 offen lds
    s_add_u32 s40, s40, 294912
    s_add_u32 m0, s32, 16384
    s_nop 0
    buffer_load_dwordx4 v95, s[16:19], s40 offen lds
    s_add_u32 s40, s40, 294912
    s_add_u32 m0, s32, 20480
    s_nop 0
    buffer_load_dwordx4 v95, s[16:19], s40 offen lds
    s_add_u32 s40, s40, 294912
    s_add_u32 m0, s32, 24576
    s_nop 0
    buffer_load_dwordx4 v95, s[16:19], s40 offen lds
    s_add_u32 s40, s40, 294912
    s_add_u32 m0, s32, 28672
    s_nop 0
    buffer_load_dwordx4 v95, s[16:19], s40 offen lds
    s_add_u32 s40, s40, 294912
    s_add_u32 m0, s32, 32768
    s_nop 0
    buffer_load_dwordx4 v95, s[16:19], s40 offen lds
    s_add_u32 s40, s40, 294912
    s_add_u32 m0, s32, 36864
    s_nop 0
    buffer_load_dwordx4 v95, s[16:19], s40 offen lds
    s_add_u32 s40, s40, 294912
    s_add_u32 m0, s32, 40960
    s_nop 0
    buffer_load_dwordx4 v95, s[16:19], s40 offen lds
    s_add_u32 s40, s40, 294912
    s_add_u32 m0, s32, 45056
    s_nop 0
    buffer_load_dwordx4 v95, s[16:19], s40 offen lds
    s_add_u32 s40, s40, 294912
    s_add_u32 m0, s32, 49152
    s_nop 0
    buffer_load_dwordx4 v95, s[16:19], s40 offen lds
    s_add_u32 s40, s40, 294912
    s_add_u32 m0, s32, 53248
    s_nop 0
    buffer_load_dwordx4 v95, s[16:19], s40 offen lds
    s_add_u32 s40, s40, 294912
    s_add_u32 m0, s32, 57344
    s_nop 0
    buffer_load_dwordx4 v95, s[16:19], s40 offen lds
    s_add_u32 s40, s40, 294912
    s_add_u32 m0, s32, 61440
    s_nop 0
    buffer_load_dwordx4 v95, s[16:19], s40 offen lds
    s_add_u32 s40, s40, 294912
    s_add_u32 m0, s32, 65536
    s_nop 0
    buffer_load_dwordx4 v95, s[16:19], s40 offen lds
    s_add_u32 s40, s40, 294912
    s_add_u32 m0, s32, 69632
    s_nop 0
    buffer_load_dwordx4 v95, s[16:19], s40 offen lds
    s_add_u32 s40, s40, 294912
    v_lshlrev_b32 v88, 7, v86
    v_lshl_add_u32 v88, v85, 4, v88
    s_lshr_b32 s47, s30, 1
    s_lshl_b32 s47, s47, 6
    s_and_b32 s48, s30, 1
    s_lshl_b32 s48, s48, 3
    s_add_u32 s47, s47, s48
    s_add_u32 s47, s47, s31
    v_add_u32 v88, s47, v88
    v_add_u32 v89, 0x9000, v88
    s_lshl_b32 s47, s46, 2
    s_add_u32 s47, s47, s30
    s_mul_i32 s54, s47, 36864
    s_lshl_b32 s48, s45, 10
    s_add_u32 s54, s54, s48
    s_add_u32 s54, s54, 20971520
    s_lshl_b32 s43, s47, 7
    s_lshl_b32 s48, s45, 6
    s_add_u32 s43, s43, s48
    s_add_u32 s43, s43, 9437184
    v_mov_b32 v94, 0x3f803f80
    v_mov_b32 v97, 0
    s_waitcnt vmcnt(12)
    s_barrier
    ds_read_b64_tr_b16 v[0:1], v88 offset:0
    ds_read_b64_tr_b16 v[2:3], v88 offset:512
    ds_read_b64_tr_b16 v[4:5], v88 offset:4096
    ds_read_b64_tr_b16 v[6:7], v88 offset:4608
    ds_read_b64_tr_b16 v[8:9], v88 offset:8192
    ds_read_b64_tr_b16 v[10:11], v88 offset:8704
    ds_read_b64_tr_b16 v[12:13], v88 offset:12288
    ds_read_b64_tr_b16 v[14:15], v88 offset:12800
    ds_read_b64_tr_b16 v[16:17], v88 offset:16384
    ds_read_b64_tr_b16 v[18:19], v88 offset:16896
    ds_read_b64_tr_b16 v[20:21], v88 offset:20480
    ds_read_b64_tr_b16 v[22:23], v88 offset:20992
    s_waitcnt lgkmcnt(10)
    buffer_store_dwordx4 v[0:3], v82, s[20:23], s54 offen
    s_add_u32 s54, s54, 2048
    v_dot2_f32_bf16 v96, v0, v94, v96
    v_dot2_f32_bf16 v97, v1, v94, v97
    v_dot2_f32_bf16 v96, v2, v94, v96
    v_dot2_f32_bf16 v97, v3, v94, v97
    s_waitcnt lgkmcnt(8)
    buffer_store_dwordx4 v[4:7], v82, s[20:23], s54 offen
    s_add_u32 s54, s54, 2048
    v_dot2_f32_bf16 v96, v4, v94, v96
    v_dot2_f32_bf16 v97, v5, v94, v97
    v_dot2_f32_bf16 v96, v6, v94, v96
    v_dot2_f32_bf16 v97, v7, v94, v97
    s_waitcnt lgkmcnt(6)
    buffer_store_dwordx4 v[8:11], v82, s[20:23], s54 offen
    s_add_u32 s54, s54, 2048
    v_dot2_f32_bf16 v96, v8, v94, v96
    v_dot2_f32_bf16 v97, v9, v94, v97
    v_dot2_f32_bf16 v96, v10, v94, v96
    v_dot2_f32_bf16 v97, v11, v94, v97
    s_waitcnt lgkmcnt(4)
    buffer_store_dwordx4 v[12:15], v82, s[20:23], s54 offen
    s_add_u32 s54, s54, 2048
    v_dot2_f32_bf16 v96, v12, v94, v96
    v_dot2_f32_bf16 v97, v13, v94, v97
    v_dot2_f32_bf16 v96, v14, v94, v96
    v_dot2_f32_bf16 v97, v15, v94, v97
    s_waitcnt lgkmcnt(2)
    buffer_store_dwordx4 v[16:19], v82, s[20:23], s54 offen
    s_add_u32 s54, s54, 2048
    v_dot2_f32_bf16 v96, v16, v94, v96
    v_dot2_f32_bf16 v97, v17, v94, v97
    v_dot2_f32_bf16 v96, v18, v94, v96
    v_dot2_f32_bf16 v97, v19, v94, v97
    s_waitcnt lgkmcnt(0)
    buffer_store_dwordx4 v[20:23], v82, s[20:23], s54 offen
    s_add_u32 s54, s54, 2048
    v_dot2_f32_bf16 v96, v20, v94, v96
    v_dot2_f32_bf16 v97, v21, v94, v97
    v_dot2_f32_bf16 v96, v22, v94, v96
    v_dot2_f32_bf16 v97, v23, v94, v97
    s_waitcnt vmcnt(12)
    s_barrier
    ds_read_b64_tr_b16 v[0:1], v88 offset:24576
    ds_read_b64_tr_b16 v[2:3], v88 offset:25088
    ds_read_b64_tr_b16 v[4:5], v88 offset:28672
    ds_read_b64_tr_b16 v[6:7], v88 offset:29184
    ds_read_b64_tr_b16 v[8:9], v88 offset:32768
    ds_read_b64_tr_b16 v[10:11], v88 offset:33280
    ds_read_b64_tr_b16 v[12:13], v89 offset:0
    ds_read_b64_tr_b16 v[14:15], v89 offset:512
    ds_read_b64_tr_b16 v[16:17], v89 offset:4096
    ds_read_b64_tr_b16 v[18:19], v89 offset:4608
    ds_read_b64_tr_b16 v[20:21], v89 offset:8192
    ds_read_b64_tr_b16 v[22:23], v89 offset:8704
    s_waitcnt lgkmcnt(10)
    buffer_store_dwordx4 v[0:3], v82, s[20:23], s54 offen
    s_add_u32 s54, s54, 2048
    v_dot2_f32_bf16 v96, v0, v94, v96
    v_dot2_f32_bf16 v97, v1, v94, v97
    v_dot2_f32_bf16 v96, v2, v94, v96
    v_dot2_f32_bf16 v97, v3, v94, v97
    s_waitcnt lgkmcnt(8)
    buffer_store_dwordx4 v[4:7], v82, s[20:23], s54 offen
    s_add_u32 s54, s54, 2048
    v_dot2_f32_bf16 v96, v4, v94, v96
    v_dot2_f32_bf16 v97, v5, v94, v97
    v_dot2_f32_bf16 v96, v6, v94, v96
    v_dot2_f32_bf16 v97, v7, v94, v97
    s_waitcnt lgkmcnt(6)
    buffer_store_dwordx4 v[8:11], v82, s[20:23], s54 offen
    s_add_u32 s54, s54, 2048
    v_dot2_f32_bf16 v96, v8, v94, v96
    v_dot2_f32_bf16 v97, v9, v94, v97
    v_dot2_f32_bf16 v96, v10, v94, v96
    v_dot2_f32_bf16 v97, v11, v94, v97
    s_waitcnt lgkmcnt(4)
    buffer_store_dwordx4 v[12:15], v82, s[20:23], s54 offen
    s_add_u32 s54, s54, 2048
    v_dot2_f32_bf16 v96, v12, v94, v96
    v_dot2_f32_bf16 v97, v13, v94, v97
    v_dot2_f32_bf16 v96, v14, v94, v96
    v_dot2_f32_bf16 v97, v15, v94, v97
    s_waitcnt lgkmcnt(2)
    buffer_store_dwordx4 v[16:19], v82, s[20:23], s54 offen
    s_add_u32 s54, s54, 2048
    v_dot2_f32_bf16 v96, v16, v94, v96
    v_dot2_f32_bf16 v97, v17, v94, v97
    v_dot2_f32_bf16 v96, v18, v94, v96
    v_dot2_f32_bf16 v97, v19, v94, v97
    s_waitcnt lgkmcnt(0)
    buffer_store_dwordx4 v[20:23], v82, s[20:23], s54 offen
    s_add_u32 s54, s54, 2048
    v_dot2_f32_bf16 v96, v20, v94, v96
    v_dot2_f32_bf16 v97, v21, v94, v97
    v_dot2_f32_bf16 v96, v22, v94, v96
    v_dot2_f32_bf16 v97, v23, v94, v97
    s_waitcnt vmcnt(12)
    s_barrier
    ds_read_b64_tr_b16 v[0:1], v89 offset:12288
    ds_read_b64_tr_b16 v[2:3], v89 offset:12800
    ds_read_b64_tr_b16 v[4:5], v89 offset:16384
    ds_read_b64_tr_b16 v[6:7], v89 offset:16896
    ds_read_b64_tr_b16 v[8:9], v89 offset:20480
    ds_read_b64_tr_b16 v[10:11], v89 offset:20992
    ds_read_b64_tr_b16 v[12:13], v89 offset:24576
    ds_read_b64_tr_b16 v[14:15], v89 offset:25088
    ds_read_b64_tr_b16 v[16:17], v89 offset:28672
    ds_read_b64_tr_b16 v[18:19], v89 offset:29184
    ds_read_b64_tr_b16 v[20:21], v89 offset:32768
    ds_read_b64_tr_b16 v[22:23], v89 offset:33280
    s_waitcnt lgkmcnt(10)
    buffer_store_dwordx4 v[0:3], v82, s[20:23], s54 offen
    s_add_u32 s54, s54, 2048
    v_dot2_f32_bf16 v96, v0, v94, v96
    v_dot2_f32_bf16 v97, v1, v94, v97
    v_dot2_f32_bf16 v96, v2, v94, v96
    v_dot2_f32_bf16 v97, v3, v94, v97
    s_waitcnt lgkmcnt(8)
    buffer_store_dwordx4 v[4:7], v82, s[20:23], s54 offen
    s_add_u32 s54, s54, 2048
    v_dot2_f32_bf16 v96, v4, v94, v96
    v_dot2_f32_bf16 v97, v5, v94, v97
    v_dot2_f32_bf16 v96, v6, v94, v96
    v_dot2_f32_bf16 v97, v7, v94, v97
    s_waitcnt lgkmcnt(6)
    buffer_store_dwordx4 v[8:11], v82, s[20:23], s54 offen
    s_add_u32 s54, s54, 2048
    v_dot2_f32_bf16 v96, v8, v94, v96
    v_dot2_f32_bf16 v97, v9, v94, v97
    v_dot2_f32_bf16 v96, v10, v94, v96
    v_dot2_f32_bf16 v97, v11, v94, v97
    s_waitcnt lgkmcnt(4)
    buffer_store_dwordx4 v[12:15], v82, s[20:23], s54 offen
    s_add_u32 s54, s54, 2048
    v_dot2_f32_bf16 v96, v12, v94, v96
    v_dot2_f32_bf16 v97, v13, v94, v97
    v_dot2_f32_bf16 v96, v14, v94, v96
    v_dot2_f32_bf16 v97, v15, v94, v97
    s_waitcnt lgkmcnt(2)
    buffer_store_dwordx4 v[16:19], v82, s[20:23], s54 offen
    s_add_u32 s54, s54, 2048
    v_dot2_f32_bf16 v96, v16, v94, v96
    v_dot2_f32_bf16 v97, v17, v94, v97
    v_dot2_f32_bf16 v96, v18, v94, v96
    v_dot2_f32_bf16 v97, v19, v94, v97
    s_waitcnt lgkmcnt(0)
    buffer_store_dwordx4 v[20:23], v82, s[20:23], s54 offen
    s_add_u32 s54, s54, 2048
    v_dot2_f32_bf16 v96, v20, v94, v96
    v_dot2_f32_bf16 v97, v21, v94, v97
    v_dot2_f32_bf16 v96, v22, v94, v96
    v_dot2_f32_bf16 v97, v23, v94, v97
    s_nop 2
    v_add_f32 v96, v96, v97
    v_mov_b32 v98, v96
    v_mov_b32 v99, v97
    s_nop 0
    v_permlane16_swap_b32 v96, v98
    v_permlane16_swap_b32 v97, v99
    v_add_f32 v96, v96, v98
    v_add_f32 v97, v97, v99
    v_mov_b32 v98, v96
    v_mov_b32 v99, v97
    s_nop 0
    v_permlane32_swap_b32 v96, v98
    v_permlane32_swap_b32 v97, v99
    v_add_f32 v96, v96, v98
    v_add_f32 v97, v97, v99
    v_and_b32 v88, 15, v80
    v_lshlrev_b32 v88, 2, v88
    buffer_store_dword v96, v88, s[20:23], s43 offen
L_k1_kernel_pk_fin:
L_k1_kernel_end:
    s_endpgm
.section .rodata,"a"
.p2align 6
.amdhsa_kernel k1_kernel
  .amdhsa_next_free_vgpr 254
  .amdhsa_next_free_sgpr 60
  .amdhsa_accum_offset 256
  .amdhsa_group_segment_fixed_size 0
  .amdhsa_kernarg_size 80
  .amdhsa_user_sgpr_count 2
  .amdhsa_user_sgpr_kernarg_segment_ptr 1
  .amdhsa_system_sgpr_workgroup_id_x 1
  .amdhsa_float_denorm_mode_32 3
  .amdhsa_float_denorm_mode_16_64 3
.end_amdhsa_kernel

.text
.globl k2_kernel
.p2align 8
.type k2_kernel,@function
k2_kernel:
    s_cmp_ge_u32 s2, 256
    s_cbranch_scc1 L_k2_kernel_end
    s_load_dwordx2 s[4:5], s[0:1], 72
    s_load_dwordx2 s[6:7], s[0:1], 0
    s_and_b32 s28, s2, 7
    s_lshl_b32 s28, s28, 2
    s_bfe_u32 s29, s2, 0x20003
    s_add_u32 s28, s28, s29
    s_bfe_u32 s29, s2, 0x30005
    v_and_b32 v8, 63, v0
    v_lshrrev_b32 v9, 6, v0
    s_nop 0
    v_readfirstlane_b32 s30, v9
    v_lshlrev_b32 v18, 4, v8
    v_lshrrev_b32 v80, 4, v8
    v_mov_b32 v83, v8
    v_mul_u32_u24 v10, 4608, v9
    v_lshl_add_u32 v90, v8, 4, v10
    v_lshrrev_b32 v12, 4, v8
    v_lshlrev_b32 v12, 7, v12
    v_add_u32 v10, v10, v12
    v_and_b32 v12, 7, v8
    v_lshl_add_u32 v10, v12, 4, v10
    v_add_u32 v91, 4096, v10
    v_add_u32 v10, 0, v9
    v_and_b32 v10, 3, v10
    v_lshlrev_b32 v10, 10, v10
    v_lshl_add_u32 v10, v9, 12, v10
    v_add_u32 v86, v10, v18
    v_add_u32 v10, 1, v9
    v_and_b32 v10, 3, v10
    v_lshlrev_b32 v10, 10, v10
    v_lshl_add_u32 v10, v9, 12, v10
    v_add_u32 v87, v10, v18
    v_add_u32 v10, 2, v9
    v_and_b32 v10, 3, v10
    v_lshlrev_b32 v10, 10, v10
    v_lshl_add_u32 v10, v9, 12, v10
    v_add_u32 v88, v10, v18
    v_add_u32 v10, 3, v9
    v_and_b32 v10, 3, v10
    v_lshlrev_b32 v10, 10, v10
    v_lshl_add_u32 v10, v9, 12, v10
    v_add_u32 v89, v10, v18
    s_waitcnt lgkmcnt(0)
    s_mul_i32 s43, s29, 82944
    s_add_u32 s43, s43, 10485760
    s_add_u32 s12, s4, s43
    s_addc_u32 s13, s5, 0
    s_mov_b32 s14, 82944
    s_mov_b32 s15, 0x20000
    s_mul_i32 s32, s28, 73728
    s_add_u32 s32, s32, 0
    s_add_u32 s8, s4, s32
    s_addc_u32 s9, s5, 0
    s_mov_b32 s10, 73728
    s_mov_b32 s11, 0x20000
    s_mov_b32 s41, 0
    buffer_load_dwordx4 a[16:19], v90, s[12:15], s41 offen offset:0
    buffer_load_dwordx4 a[20:23], v90, s[12:15], s41 offen offset:1024
    buffer_load_dwordx4 a[24:27], v90, s[12:15], s41 offen offset:2048
    buffer_load_dwordx4 a[28:31], v90, s[12:15], s41 offen offset:3072
    buffer_load_dwordx4 a[32:35], v91, s[12:15], s41 offen
    s_mov_b32 s40, 0
    buffer_load_dwordx4 a[0:3], v86, s[8:11], s40 offen
    buffer_load_dwordx4 a[4:7], v87, s[8:11], s40 offen
    buffer_load_dwordx4 a[8:11], v88, s[8:11], s40 offen
    buffer_load_dwordx4 a[12:15], v89, s[8:11], s40 offen
    s_mov_b32 s41, 18432
    buffer_load_dwordx4 a[52:55], v90, s[12:15], s41 offen offset:0
    buffer_load_dwordx4 a[56:59], v90, s[12:15], s41 offen offset:1024
    buffer_load_dwordx4 a[60:63], v90, s[12:15], s41 offen offset:2048
    buffer_load_dwordx4 a[64:67], v90, s[12:15], s41 offen offset:3072
    buffer_load_dwordx4 a[68:71], v91, s[12:15], s41 offen
    s_mov_b32 s40, 16384
    buffer_load_dwordx4 a[36:39], v86, s[8:11], s40 offen
    buffer_load_dwordx4 a[40:43], v87, s[8:11], s40 offen
    buffer_load_dwordx4 a[44:47], v88, s[8:11], s40 offen
    buffer_load_dwordx4 a[48:51], v89, s[8:11], s40 offen
    v_and_b32 v13, 15, v8
    s_lshl_b32 s32, s28, 6
    s_lshl_b32 s33, s30, 4
    s_add_u32 s32, s32, s33
    v_add_u32 v14, s32, v13
    v_mul_u32_u24 v15, 1152, v14
    s_mul_i32 s33, s29, 144
    v_add_u32 v15, s33, v15
    v_lshl_add_u32 v96, v80, 4, v15
    v_lshl_add_u32 v97, v80, 3, v15
    s_mul_i32 s33, s29, 9
    s_mul_i32 s34, s28, 73728
    s_lshl_b32 s35, s30, 10
    s_add_u32 s34, s34, s35
    v_add_u32 v16, s33, v80
    v_lshrrev_b32 v17, 2, v16
    v_lshlrev_b32 v17, 12, v17
    v_and_b32 v16, 3, v16
    v_lshl_add_u32 v16, v16, 4, v13
    v_lshl_add_u32 v17, v16, 4, v17
    v_add_u32 v98, s34, v17
    v_add_u32 v16, s33, v80
    v_add_u32 v16, 4, v16
    v_lshrrev_b32 v17, 2, v16
    v_lshlrev_b32 v17, 12, v17
    v_and_b32 v16, 3, v16
    v_lshl_add_u32 v16, v16, 4, v13
    v_lshl_add_u32 v17, v16, 4, v17
    v_add_u32 v99, s34, v17
    s_add_u32 s35, s33, 8
    v_mov_b32 v16, s35
    v_lshrrev_b32 v17, 2, v16
    v_lshlrev_b32 v17, 12, v17
    v_and_b32 v16, 3, v16
    v_lshl_add_u32 v16, v16, 4, v13
    v_lshl_add_u32 v17, v16, 4, v17
    v_add_u32 v100, s34, v17
    v_and_b32 v16, 1, v80
    v_lshl_add_u32 v100, v16, 3, v100
    s_add_u32 s24, s4, 8388608
    s_addc_u32 s25, s5, 0
    s_mov_b32 s26, 131072
    s_mov_b32 s27, 0x20000
    v_lshlrev_b32 v101, 6, v14
    s_mov_b32 s16, s6
    s_mov_b32 s17, s7
    s_mov_b32 s18, 2359296
    s_mov_b32 s19, 0x20000
    s_add_u32 s20, s4, 4194304
    s_addc_u32 s21, s5, 0
    s_mov_b32 s22, 2359296
    s_mov_b32 s23, 0x20000
    s_lshl_b32 s33, s29, 3
    v_add_u32 v101, s33, v101
    v_add_u32 v16, 1, v9
    v_and_b32 v16, 3, v16
    v_mul_u32_u24 v16, 15360, v16
    v_add_u32 v16, 0, v16
    v_add_u32 v92, v16, v18
    v_add_u32 v16, 2, v9
    v_and_b32 v16, 3, v16
    v_mul_u32_u24 v16, 15360, v16
    v_add_u32 v16, 5120, v16
    v_add_u32 v93, v16, v18
    v_add_u32 v16, 3, v9
    v_and_b32 v16, 3, v16
    v_mul_u32_u24 v16, 15360, v16
    v_add_u32 v16, 10240, v16
    v_add_u32 v94, v16, v18
    v_mul_u32_u24 v16, 15360, v9
    v_add_u32 v16, 0, v16
    v_add_u32 v95, v16, v18
    s_mov_b32 s41, 36864
    buffer_load_dwordx4 a[88:91], v90, s[12:15], s41 offen offset:0
    buffer_load_dwordx4 a[92:95], v90, s[12:15], s41 offen offset:1024
    buffer_load_dwordx4 a[96:99], v90, s[12:15], s41 offen offset:2048
    buffer_load_dwordx4 a[100:103], v90, s[12:15], s41 offen offset:3072
    buffer_load_dwordx4 a[104:107], v91, s[12:15], s41 offen
    s_mov_b32 s40, 32768
    buffer_load_dwordx4 a[72:75], v86, s[8:11], s40 offen
    buffer_load_dwordx4 a[76:79], v87, s[8:11], s40 offen
    buffer_load_dwordx4 a[80:83], v88, s[8:11], s40 offen
    buffer_load_dwordx4 a[84:87], v89, s[8:11], s40 offen
    s_waitcnt vmcnt(18)
    v_mfma_f32_16x16x32_bf16 v[0:3], a[16:19], a[0:3], 0
    s_mov_b32 s41, 55296
    v_mfma_f32_16x16x32_bf16 v[4:7], a[16:19], a[4:7], 0
    buffer_load_dwordx4 a[124:127], v90, s[12:15], s41 offen offset:0
    v_mfma_f32_16x16x32_bf16 v[8:11], a[16:19], a[8:11], 0
    buffer_load_dwordx4 a[128:131], v90, s[12:15], s41 offen offset:1024
    v_mfma_f32_16x16x32_bf16 v[12:15], a[16:19], a[12:15], 0
    buffer_load_dwordx4 a[132:135], v90, s[12:15], s41 offen offset:2048
    v_mfma_f32_16x16x32_bf16 v[16:19], a[20:23], a[0:3], 0
    buffer_load_dwordx4 a[136:139], v90, s[12:15], s41 offen offset:3072
    v_mfma_f32_16x16x32_bf16 v[20:23], a[20:23], a[4:7], 0
    buffer_load_dwordx4 a[140:143], v91, s[12:15], s41 offen
    s_mov_b32 s40, 49152
    v_mfma_f32_16x16x32_bf16 v[24:27], a[20:23], a[8:11], 0
    buffer_load_dwordx4 a[108:111], v86, s[8:11], s40 offen
    v_mfma_f32_16x16x32_bf16 v[28:31], a[20:23], a[12:15], 0
    buffer_load_dwordx4 a[112:115], v87, s[8:11], s40 offen
    v_mfma_f32_16x16x32_bf16 v[32:35], a[24:27], a[0:3], 0
    buffer_load_dwordx4 a[116:119], v88, s[8:11], s40 offen
    v_mfma_f32_16x16x32_bf16 v[36:39], a[24:27], a[4:7], 0
    buffer_load_dwordx4 a[120:123], v89, s[8:11], s40 offen
    s_mov_b32 s41, 73728
    v_mfma_f32_16x16x32_bf16 v[40:43], a[24:27], a[8:11], 0
    buffer_load_dwordx4 a[160:163], v90, s[12:15], s41 offen offset:0
    v_mfma_f32_16x16x32_bf16 v[44:47], a[24:27], a[12:15], 0
    buffer_load_dwordx4 a[164:167], v90, s[12:15], s41 offen offset:1024
    v_mfma_f32_16x16x32_bf16 v[48:51], a[28:31], a[0:3], 0
    buffer_load_dwordx4 a[168:171], v90, s[12:15], s41 offen offset:2048
    v_mfma_f32_16x16x32_bf16 v[52:55], a[28:31], a[4:7], 0
    buffer_load_dwordx4 a[172:175], v90, s[12:15], s41 offen offset:3072
    v_mfma_f32_16x16x32_bf16 v[56:59], a[28:31], a[8:11], 0
    buffer_load_dwordx4 a[176:179], v91, s[12:15], s41 offen
    s_mov_b32 s40, 65536
    v_mfma_f32_16x16x32_bf16 v[60:63], a[28:31], a[12:15], 0
    buffer_load_dwordx4 a[144:147], v86, s[8:11], s40 offen
    v_mfma_f32_16x16x32_bf16 v[64:67], a[32:35], a[0:3], 0
    buffer_load_dwordx4 a[148:151], v87, s[8:11], s40 offen
    v_mfma_f32_16x16x32_bf16 v[68:71], a[32:35], a[4:7], 0
    buffer_load_dwordx4 a[152:155], v88, s[8:11], s40 offen
    v_mfma_f32_16x16x32_bf16 v[72:75], a[32:35], a[8:11], 0
    buffer_load_dwordx4 a[156:159], v89, s[8:11], s40 offen
    v_mfma_f32_16x16x32_bf16 v[76:79], a[32:35], a[12:15], 0
    s_waitcnt vmcnt(27)
    v_mfma_f32_16x16x32_bf16 v[0:3], a[52:55], a[36:39], v[0:3]
    v_mfma_f32_16x16x32_bf16 v[4:7], a[52:55], a[40:43], v[4:7]
    v_mfma_f32_16x16x32_bf16 v[8:11], a[52:55], a[44:47], v[8:11]
    v_mfma_f32_16x16x32_bf16 v[12:15], a[52:55], a[48:51], v[12:15]
    v_mfma_f32_16x16x32_bf16 v[16:19], a[56:59], a[36:39], v[16:19]
    v_mfma_f32_16x16x32_bf16 v[20:23], a[56:59], a[40:43], v[20:23]
    v_mfma_f32_16x16x32_bf16 v[24:27], a[56:59], a[44:47], v[24:27]
    v_mfma_f32_16x16x32_bf16 v[28:31], a[56:59], a[48:51], v[28:31]
    v_mfma_f32_16x16x32_bf16 v[32:35], a[60:63], a[36:39], v[32:35]
    v_mfma_f32_16x16x32_bf16 v[36:39], a[60:63], a[40:43], v[36:39]
    v_mfma_f32_16x16x32_bf16 v[40:43], a[60:63], a[44:47], v[40:43]
    v_mfma_f32_16x16x32_bf16 v[44:47], a[60:63], a[48:51], v[44:47]
    v_mfma_f32_16x16x32_bf16 v[48:51], a[64:67], a[36:39], v[48:51]
    v_mfma_f32_16x16x32_bf16 v[52:55], a[64:67], a[40:43], v[52:55]
    v_mfma_f32_16x16x32_bf16 v[56:59], a[64:67], a[44:47], v[56:59]
    v_mfma_f32_16x16x32_bf16 v[60:63], a[64:67], a[48:51], v[60:63]
    v_mfma_f32_16x16x32_bf16 v[64:67], a[68:71], a[36:39], v[64:67]
    v_mfma_f32_16x16x32_bf16 v[68:71], a[68:71], a[40:43], v[68:71]
    v_mfma_f32_16x16x32_bf16 v[72:75], a[68:71], a[44:47], v[72:75]
    v_mfma_f32_16x16x32_bf16 v[76:79], a[68:71], a[48:51], v[76:79]
    s_waitcnt vmcnt(18)
    v_mfma_f32_16x16x32_bf16 v[0:3], a[88:91], a[72:75], v[0:3]
    buffer_load_dwordx4 v[102:105], v96, s[16:19], 0 offen
    v_mfma_f32_16x16x32_bf16 v[4:7], a[88:91], a[76:79], v[4:7]
    buffer_load_dwordx4 v[106:109], v96, s[16:19], 0 offen offset:64
    v_mfma_f32_16x16x32_bf16 v[8:11], a[88:91], a[80:83], v[8:11]
    buffer_load_dwordx2 v[110:111], v97, s[16:19], 0 offen offset:128
    v_mfma_f32_16x16x32_bf16 v[12:15], a[88:91], a[84:87], v[12:15]
    s_lshr_b32 s46, s2, 3
    s_getpc_b64 s[48:49]
L_k2_kernel_pc:
    s_add_u32 s48, s48, fk_kernel-L_k2_kernel_pc
    s_addc_u32 s49, s49, 0
    s_mul_i32 s50, s46, ((L_fk_kernel_end-fk_kernel+4095)/4096)*128
    v_lshlrev_b32 v81, 7, v83
    v_min_u32 v81, ((L_fk_kernel_end-fk_kernel+4095)/4096-1)*128, v81
    v_add_u32 v81, s50, v81
    v_min_u32 v81, L_fk_kernel_end-fk_kernel-4, v81
    global_load_dword v82, v81, s[48:49]
    v_mfma_f32_16x16x32_bf16 v[16:19], a[92:95], a[72:75], v[16:19]
    v_mfma_f32_16x16x32_bf16 v[20:23], a[92:95], a[76:79], v[20:23]
    v_mfma_f32_16x16x32_bf16 v[24:27], a[92:95], a[80:83], v[24:27]
    v_mfma_f32_16x16x32_bf16 v[28:31], a[92:95], a[84:87], v[28:31]
    v_mfma_f32_16x16x32_bf16 v[32:35], a[96:99], a[72:75], v[32:35]
    v_mfma_f32_16x16x32_bf16 v[36:39], a[96:99], a[76:79], v[36:39]
    v_mfma_f32_16x16x32_bf16 v[40:43], a[96:99], a[80:83], v[40:43]
    v_mfma_f32_16x16x32_bf16 v[44:47], a[96:99], a[84:87], v[44:47]
    v_mfma_f32_16x16x32_bf16 v[48:51], a[100:103], a[72:75], v[48:51]
    v_mfma_f32_16x16x32_bf16 v[52:55], a[100:103], a[76:79], v[52:55]
    v_mfma_f32_16x16x32_bf16 v[56:59], a[100:103], a[80:83], v[56:59]
    v_mfma_f32_16x16x32_bf16 v[60:63], a[100:103], a[84:87], v[60:63]
    v_mfma_f32_16x16x32_bf16 v[64:67], a[104:107], a[72:75], v[64:67]
    v_mfma_f32_16x16x32_bf16 v[68:71], a[104:107], a[76:79], v[68:71]
    v_mfma_f32_16x16x32_bf16 v[72:75], a[104:107], a[80:83], v[72:75]
    v_mfma_f32_16x16x32_bf16 v[76:79], a[104:107], a[84:87], v[76:79]
    s_waitcnt vmcnt(13)
    v_mfma_f32_16x16x32_bf16 v[0:3], a[124:127], a[108:111], v[0:3]
    v_mfma_f32_16x16x32_bf16 v[4:7], a[124:127], a[112:115], v[4:7]
    v_mfma_f32_16x16x32_bf16 v[8:11], a[124:127], a[116:119], v[8:11]
    v_mfma_f32_16x16x32_bf16 v[12:15], a[124:127], a[120:123], v[12:15]
    v_mfma_f32_16x16x32_bf16 v[16:19], a[128:131], a[108:111], v[16:19]
    v_mfma_f32_16x16x32_bf16 v[20:23], a[128:131], a[112:115], v[20:23]
    v_mfma_f32_16x16x32_bf16 v[24:27], a[128:131], a[116:119], v[24:27]
    v_mfma_f32_16x16x32_bf16 v[28:31], a[128:131], a[120:123], v[28:31]
    v_mfma_f32_16x16x32_bf16 v[32:35], a[132:135], a[108:111], v[32:35]
    v_mfma_f32_16x16x32_bf16 v[36:39], a[132:135], a[112:115], v[36:39]
    v_mfma_f32_16x16x32_bf16 v[40:43], a[132:135], a[116:119], v[40:43]
    v_mfma_f32_16x16x32_bf16 v[44:47], a[132:135], a[120:123], v[44:47]
    v_mfma_f32_16x16x32_bf16 v[48:51], a[136:139], a[108:111], v[48:51]
    v_mfma_f32_16x16x32_bf16 v[52:55], a[136:139], a[112:115], v[52:55]
    v_mfma_f32_16x16x32_bf16 v[56:59], a[136:139], a[116:119], v[56:59]
    v_mfma_f32_16x16x32_bf16 v[60:63], a[136:139], a[120:123], v[60:63]
    v_mfma_f32_16x16x32_bf16 v[64:67], a[140:143], a[108:111], v[64:67]
    v_mfma_f32_16x16x32_bf16 v[68:71], a[140:143], a[112:115], v[68:71]
    v_mfma_f32_16x16x32_bf16 v[72:75], a[140:143], a[116:119], v[72:75]
    v_mfma_f32_16x16x32_bf16 v[76:79], a[140:143], a[120:123], v[76:79]
    s_waitcnt vmcnt(4)
    v_mfma_f32_16x16x32_bf16 v[4:7], a[160:163], a[148:151], v[4:7]
    v_mfma_f32_16x16x32_bf16 v[20:23], a[164:167], a[148:151], v[20:23]
    v_mfma_f32_16x16x32_bf16 v[36:39], a[168:171], a[148:151], v[36:39]
    v_mfma_f32_16x16x32_bf16 v[52:55], a[172:175], a[148:151], v[52:55]
    v_mfma_f32_16x16x32_bf16 v[68:71], a[176:179], a[148:151], v[68:71]
    v_mfma_f32_16x16x32_bf16 v[8:11], a[160:163], a[152:155], v[8:11]
    v_mfma_f32_16x16x32_bf16 v[24:27], a[164:167], a[152:155], v[24:27]
    s_nop 1
    ds_write_b128 v92, v[4:7] offset:0
    v_mfma_f32_16x16x32_bf16 v[40:43], a[168:171], a[152:155], v[40:43]
    ds_write_b128 v92, v[20:23] offset:1024
    v_mfma_f32_16x16x32_bf16 v[56:59], a[172:175], a[152:155], v[56:59]
    ds_write_b128 v92, v[36:39] offset:2048
    v_mfma_f32_16x16x32_bf16 v[72:75], a[176:179], a[152:155], v[72:75]
    ds_write_b128 v92, v[52:55] offset:3072
    v_mfma_f32_16x16x32_bf16 v[12:15], a[160:163], a[156:159], v[12:15]
    ds_write_b128 v92, v[68:71] offset:4096
    v_mfma_f32_16x16x32_bf16 v[28:31], a[164:167], a[156:159], v[28:31]
    ds_write_b128 v93, v[8:11] offset:0
    v_mfma_f32_16x16x32_bf16 v[44:47], a[168:171], a[156:159], v[44:47]
    ds_write_b128 v93, v[24:27] offset:1024
    v_mfma_f32_16x16x32_bf16 v[60:63], a[172:175], a[156:159], v[60:63]
    ds_write_b128 v93, v[40:43] offset:2048
    v_mfma_f32_16x16x32_bf16 v[76:79], a[176:179], a[156:159], v[76:79]
    ds_write_b128 v93, v[56:59] offset:3072
    v_mfma_f32_16x16x32_bf16 v[0:3], a[160:163], a[144:147], v[0:3]
    ds_write_b128 v93, v[72:75] offset:4096
    v_mfma_f32_16x16x32_bf16 v[16:19], a[164:167], a[144:147], v[16:19]
    ds_write_b128 v94, v[12:15] offset:0
    v_mfma_f32_16x16x32_bf16 v[32:35], a[168:171], a[144:147], v[32:35]
    ds_write_b128 v94, v[28:31] offset:1024
    v_mfma_f32_16x16x32_bf16 v[48:51], a[172:175], a[144:147], v[48:51]
    ds_write_b128 v94, v[44:47] offset:2048
    v_mfma_f32_16x16x32_bf16 v[64:67], a[176:179], a[144:147], v[64:67]
    ds_write_b128 v94, v[60:63] offset:3072
    ds_write_b128 v94, v[76:79] offset:4096
    s_waitcnt lgkmcnt(0)
    s_barrier
    ds_read_b128 v[4:7], v95 offset:0
    ds_read_b128 v[20:23], v95 offset:1024
    ds_read_b128 v[36:39], v95 offset:2048
    ds_read_b128 v[52:55], v95 offset:3072
    ds_read_b128 v[68:71], v95 offset:4096
    ds_read_b128 v[8:11], v95 offset:5120
    ds_read_b128 v[24:27], v95 offset:6144
    ds_read_b128 v[40:43], v95 offset:7168
    ds_read_b128 v[56:59], v95 offset:8192
    ds_read_b128 v[72:75], v95 offset:9216
    ds_read_b128 v[12:15], v95 offset:10240
    ds_read_b128 v[28:31], v95 offset:11264
    ds_read_b128 v[44:47], v95 offset:12288
    ds_read_b128 v[60:63], v95 offset:13312
    ds_read_b128 v[76:79], v95 offset:14336
    s_waitcnt lgkmcnt(10)
    v_pk_add_f32 v[0:1], v[0:1], v[4:5]
    v_pk_add_f32 v[2:3], v[2:3], v[6:7]
    v_pk_add_f32 v[16:17], v[16:17], v[20:21]
    v_pk_add_f32 v[18:19], v[18:19], v[22:23]
    v_pk_add_f32 v[32:33], v[32:33], v[36:37]
    v_pk_add_f32 v[34:35], v[34:35], v[38:39]
    v_pk_add_f32 v[48:49], v[48:49], v[52:53]
    v_pk_add_f32 v[50:51], v[50:51], v[54:55]
    v_pk_add_f32 v[64:65], v[64:65], v[68:69]
    v_pk_add_f32 v[66:67], v[66:67], v[70:71]
    s_waitcnt lgkmcnt(5)
    v_pk_add_f32 v[0:1], v[0:1], v[8:9]
    v_pk_add_f32 v[2:3], v[2:3], v[10:11]
    v_pk_add_f32 v[16:17], v[16:17], v[24:25]
    v_pk_add_f32 v[18:19], v[18:19], v[26:27]
    v_pk_add_f32 v[32:33], v[32:33], v[40:41]
    v_pk_add_f32 v[34:35], v[34:35], v[42:43]
    v_pk_add_f32 v[48:49], v[48:49], v[56:57]
    v_pk_add_f32 v[50:51], v[50:51], v[58:59]
    v_pk_add_f32 v[64:65], v[64:65], v[72:73]
    v_pk_add_f32 v[66:67], v[66:67], v[74:75]
    s_waitcnt lgkmcnt(0)
    v_pk_add_f32 v[0:1], v[0:1], v[12:13]
    v_pk_add_f32 v[2:3], v[2:3], v[14:15]
    v_pk_add_f32 v[16:17], v[16:17], v[28:29]
    v_pk_add_f32 v[18:19], v[18:19], v[30:31]
    v_pk_add_f32 v[32:33], v[32:33], v[44:45]
    v_pk_add_f32 v[34:35], v[34:35], v[46:47]
    v_pk_add_f32 v[48:49], v[48:49], v[60:61]
    v_pk_add_f32 v[50:51], v[50:51], v[62:63]
    v_pk_add_f32 v[64:65], v[64:65], v[76:77]
    v_pk_add_f32 v[66:67], v[66:67], v[78:79]
    s_waitcnt vmcnt(1)
    v_cvt_pk_bf16_f32 v20, v0, v1
    v_lshlrev_b32 v22, 16, v102
    v_and_b32 v23, 0xffff0000, v102
    v_lshlrev_b32 v0, 16, v20
    v_and_b32 v1, 0xffff0000, v20
    v_pk_add_f32 v[0:1], v[0:1], v[22:23]
    v_cvt_pk_bf16_f32 v4, v0, v1
    v_cvt_pk_bf16_f32 v24, v2, v3
    v_lshlrev_b32 v26, 16, v103
    v_and_b32 v27, 0xffff0000, v103
    v_lshlrev_b32 v2, 16, v24
    v_and_b32 v3, 0xffff0000, v24
    v_pk_add_f32 v[2:3], v[2:3], v[26:27]
    v_cvt_pk_bf16_f32 v5, v2, v3
    v_cvt_pk_bf16_f32 v28, v16, v17
    v_lshlrev_b32 v30, 16, v104
    v_and_b32 v31, 0xffff0000, v104
    v_lshlrev_b32 v16, 16, v28
    v_and_b32 v17, 0xffff0000, v28
    v_pk_add_f32 v[16:17], v[16:17], v[30:31]
    v_cvt_pk_bf16_f32 v6, v16, v17
    v_cvt_pk_bf16_f32 v20, v18, v19
    v_lshlrev_b32 v22, 16, v105
    v_and_b32 v23, 0xffff0000, v105
    v_lshlrev_b32 v18, 16, v20
    v_and_b32 v19, 0xffff0000, v20
    v_pk_add_f32 v[18:19], v[18:19], v[22:23]
    v_cvt_pk_bf16_f32 v7, v18, v19
    buffer_store_dwordx4 v[4:7], v98, s[20:23], 0 offen
    v_cvt_pk_bf16_f32 v24, v32, v33
    v_lshlrev_b32 v26, 16, v106
    v_and_b32 v27, 0xffff0000, v106
    v_lshlrev_b32 v32, 16, v24
    v_and_b32 v33, 0xffff0000, v24
    v_pk_add_f32 v[32:33], v[32:33], v[26:27]
    v_cvt_pk_bf16_f32 v8, v32, v33
    v_cvt_pk_bf16_f32 v28, v34, v35
    v_lshlrev_b32 v30, 16, v107
    v_and_b32 v31, 0xffff0000, v107
    v_lshlrev_b32 v34, 16, v28
    v_and_b32 v35, 0xffff0000, v28
    v_pk_add_f32 v[34:35], v[34:35], v[30:31]
    v_cvt_pk_bf16_f32 v9, v34, v35
    v_cvt_pk_bf16_f32 v20, v48, v49
    v_lshlrev_b32 v22, 16, v108
    v_and_b32 v23, 0xffff0000, v108
    v_lshlrev_b32 v48, 16, v20
    v_and_b32 v49, 0xffff0000, v20
    v_pk_add_f32 v[48:49], v[48:49], v[22:23]
    v_cvt_pk_bf16_f32 v10, v48, v49
    v_cvt_pk_bf16_f32 v24, v50, v51
    v_lshlrev_b32 v26, 16, v109
    v_and_b32 v27, 0xffff0000, v109
    v_lshlrev_b32 v50, 16, v24
    v_and_b32 v51, 0xffff0000, v24
    v_pk_add_f32 v[50:51], v[50:51], v[26:27]
    v_cvt_pk_bf16_f32 v11, v50, v51
    buffer_store_dwordx4 v[8:11], v99, s[20:23], 0 offen
    v_cvt_pk_bf16_f32 v28, v64, v65
    v_lshlrev_b32 v30, 16, v110
    v_and_b32 v31, 0xffff0000, v110
    v_lshlrev_b32 v64, 16, v28
    v_and_b32 v65, 0xffff0000, v28
    v_pk_add_f32 v[64:65], v[64:65], v[30:31]
    v_cvt_pk_bf16_f32 v12, v64, v65
    v_cvt_pk_bf16_f32 v20, v66, v67
    v_lshlrev_b32 v22, 16, v111
    v_and_b32 v23, 0xffff0000, v111
    v_lshlrev_b32 v66, 16, v20
    v_and_b32 v67, 0xffff0000, v20
    v_pk_add_f32 v[66:67], v[66:67], v[22:23]
    v_cvt_pk_bf16_f32 v13, v66, v67
    v_cmp_gt_u32 vcc, 2, v80
    v_mov_b32 v24, 0x3f803f80
    s_nop 0
    v_cndmask_b32 v25, 0, v12, vcc
    v_cndmask_b32 v26, 0, v13, vcc
    v_dot2_f32_bf16 v20, v4, v24, 0
    v_dot2_f32_bf16 v21, v4, v4, 0
    v_dot2_f32_bf16 v20, v5, v24, v20
    v_dot2_f32_bf16 v21, v5, v5, v21
    v_dot2_f32_bf16 v20, v6, v24, v20
    v_dot2_f32_bf16 v21, v6, v6, v21
    v_dot2_f32_bf16 v20, v7, v24, v20
    v_dot2_f32_bf16 v21, v7, v7, v21
    v_dot2_f32_bf16 v20, v8, v24, v20
    v_dot2_f32_bf16 v21, v8, v8, v21
    v_dot2_f32_bf16 v20, v9, v24, v20
    v_dot2_f32_bf16 v21, v9, v9, v21
    v_dot2_f32_bf16 v20, v10, v24, v20
    v_dot2_f32_bf16 v21, v10, v10, v21
    v_dot2_f32_bf16 v20, v11, v24, v20
    v_dot2_f32_bf16 v21, v11, v11, v21
    v_dot2_f32_bf16 v20, v25, v24, v20
    v_dot2_f32_bf16 v21, v25, v25, v21
    v_dot2_f32_bf16 v20, v26, v24, v20
    v_dot2_f32_bf16 v21, v26, v26, v21
    s_nop 1
    v_mov_b32 v22, v20
    v_mov_b32 v23, v21
    s_nop 0
    v_permlane16_swap_b32 v20, v22
    v_permlane16_swap_b32 v21, v23
    v_add_f32 v20, v20, v22
    v_add_f32 v21, v21, v23
    v_mov_b32 v22, v20
    v_mov_b32 v23, v21
    s_nop 0
    v_permlane32_swap_b32 v20, v22
    v_permlane32_swap_b32 v21, v23
    v_add_f32 v20, v20, v22
    v_add_f32 v21, v21, v23
    buffer_store_dwordx2 v[20:21], v101, s[24:27], 0 offen
    s_and_saveexec_b64 s[44:45], vcc
    buffer_store_dwordx2 v[12:13], v100, s[20:23], 0 offen
    s_mov_b64 exec, s[44:45]
L_k2_kernel_end:
    s_endpgm
.section .rodata,"a"
.p2align 6
.amdhsa_kernel k2_kernel
  .amdhsa_next_free_vgpr 292
  .amdhsa_next_free_sgpr 51
  .amdhsa_accum_offset 112
  .amdhsa_group_segment_fixed_size 0
  .amdhsa_kernarg_size 80
  .amdhsa_user_sgpr_count 2
  .amdhsa_user_sgpr_kernarg_segment_ptr 1
  .amdhsa_system_sgpr_workgroup_id_x 1
  .amdhsa_float_denorm_mode_32 3
  .amdhsa_float_denorm_mode_16_64 3
.end_amdhsa_kernel

.text
.globl fk_kernel
.p2align 8
.type fk_kernel,@function
fk_kernel:
    s_cmp_ge_u32 s2, 256
    s_cbranch_scc1 L_fk_kernel_end
    s_load_dwordx2 s[4:5], s[0:1], 72
    s_load_dwordx2 s[6:7], s[0:1], 56
    s_load_dwordx2 s[78:79], s[0:1], 48
    s_bfe_u32 s28, s2, 0x20001
    s_lshl_b32 s28, s28, 3
    s_bfe_u32 s29, s2, 0x30003
    s_add_u32 s28, s28, s29
    s_and_b32 s29, s2, 1
    s_lshl_b32 s29, s29, 2
    s_bfe_u32 s36, s2, 0x20006
    s_add_u32 s29, s29, s36
    s_lshr_b32 s36, s28, 1
    s_mul_i32 s36, s36, 9
    s_and_b32 s37, s28, 1
    s_mul_i32 s46, s37, 5
    v_and_b32 v32, 63, v0
    v_lshrrev_b32 v33, 6, v0
    v_lshlrev_b32 v248, 4, v32
    v_readfirstlane_b32 s30, v33
    v_add_u32 v249, 0x10000, v248
    v_lshl_add_u32 v250, v33, 10, v248
    v_lshrrev_b32 v34, 4, v32
    v_lshlrev_b32 v254, 4, v34
    s_lshl_b32 s33, s46, 8
    v_add_u32 v251, s33, v254
    s_lshl_b32 s33, s37, 11
    s_xor_b32 s34, s33, 2048
    v_add_u32 v252, s33, v248
    v_add_u32 v253, s34, v248
    s_lshl_b32 s31, s30, 10
    s_lshl_b32 s32, s29, 2
    s_add_u32 s32, s32, s30
    v_and_b32 v35, 15, v32
    v_lshlrev_b32 v35, 6, v35
    v_lshl_add_u32 v35, v34, 4, v35
    s_lshl_b32 s35, s32, 12
    s_add_u32 s33, s33, s35
    s_add_u32 s34, s34, s35
    v_add_u32 v176, s33, v35
    v_add_u32 v177, s34, v35
    s_mul_i32 s44, s46, 73728
    s_lshl_b32 s45, s46, 12
    s_waitcnt lgkmcnt(0)
    s_mul_i32 s33, s36, 73728
    s_add_u32 s33, s33, 20971520
    s_add_u32 s12, s4, s33
    s_addc_u32 s13, s5, 0
    s_mov_b32 s14, 663552
    s_mov_b32 s15, 0x20000
    s_mul_i32 s33, s32, 73728
    s_add_u32 s33, s33, 4194304
    s_add_u32 s8, s4, s33
    s_addc_u32 s9, s5, 0
    s_mov_b32 s10, 73728
    s_mov_b32 s11, 0x20000
    s_mul_i32 s33, s32, 589824
    s_lshl_b32 s34, s36, 12
    s_add_u32 s33, s33, s34
    s_add_u32 s33, s33, 33554432
    s_add_u32 s16, s4, s33
    s_addc_u32 s17, s5, 0
    s_mov_b32 s18, 36864
    s_mov_b32 s19, 0x20000
    s_lshl_b32 s33, s36, 8
    s_add_u32 s33, s33, 9437184
    s_add_u32 s20, s4, s33
    s_addc_u32 s21, s5, 0
    s_mov_b32 s22, 4096
    s_mov_b32 s23, 0x20000
    s_add_u32 s24, s4, 8388608
    s_addc_u32 s25, s5, 0
    s_mov_b32 s26, 131072
    s_mov_b32 s27, 0x20000
    s_lshl_b32 s59, s32, 5
    s_add_u32 s59, s59, s28
    s_lshl_b32 s59, s59, 2
    s_add_u32 s48, s4, 9961472
    s_addc_u32 s49, s5, 0
    s_mov_b32 s50, 20480
    s_mov_b32 s51, 0x20000
    s_cmp_lt_u32 s2, 144
    s_cselect_b32 s94, 5308416, 0
    s_cselect_b32 s98, 67108864, 0
    s_mov_b32 s92, s78
    s_mov_b32 s93, s79
    s_mov_b32 s95, 0x20000
    s_mov_b32 s96, s4
    s_mov_b32 s97, s5
    s_mov_b32 s99, 0x20000
    s_mul_i32 s56, s2, 36864
    s_mov_b32 s57, s2
    s_mul_i32 s33, s2, 57
    s_lshr_b32 s33, s33, 9
    s_mul_i32 s34, s33, 9
    s_sub_u32 s34, s2, s34
    s_lshr_b32 s35, s33, 2
    s_mul_i32 s35, s35, 36
    s_and_b32 s33, s33, 3
    s_sub_u32 s38, s34, 5
    s_cmp_gt_u32 s34, 4
    s_cselect_b32 s38, s38, s34
    s_cselect_b32 s39, 1, 0
    s_lshl_b32 s38, s38, 3
    s_lshl_b32 s57, s33, 1
    s_add_u32 s38, s38, s57
    s_add_u32 s38, s38, s39
    s_add_u32 s57, s33, 32
    s_cmp_eq_u32 s34, 4
    s_cselect_b32 s38, s57, s38
    s_add_u32 s57, s35, s38
    s_mul_i32 s100, s30, 144
    s_add_u32 s100, s100, s57
    s_lshl_b32 s100, s100, 2
    s_add_u32 s100, s100, 9973760
    s_mul_i32 s57, s57, 9216
    s_mul_i32 s33, s30, 1327104
    s_add_u32 s57, s57, s33
    s_add_u32 s57, s57, 12582912
    s_mul_i32 s101, s30, 288
    s_add_u32 s101, s101, 126976
    s_add_u32 m0, s31, 4096
    s_add_u32 s40, s44, 0
    buffer_load_dwordx4 v250, s[12:15], s40 offen lds
    s_add_u32 m0, s31, 8192
    s_add_u32 s40, s44, 36864
    buffer_load_dwordx4 v250, s[12:15], s40 offen lds
    s_add_u32 m0, s31, 12288
    s_add_u32 s40, s44, 73728
    buffer_load_dwordx4 v250, s[12:15], s40 offen lds
    s_mov_b32 s41, 0
    buffer_load_dwordx4 a[0:3], v252, s[8:11], s41 offen offset:0
    buffer_load_dwordx4 a[4:7], v252, s[8:11], s41 offen offset:1024
    buffer_load_dwordx4 a[8:11], v253, s[8:11], s41 offen offset:0
    buffer_load_dwordx4 a[12:15], v253, s[8:11], s41 offen offset:1024
    s_mov_b32 s41, 4096
    buffer_load_dwordx4 a[16:19], v252, s[8:11], s41 offen offset:0
    buffer_load_dwordx4 a[20:23], v252, s[8:11], s41 offen offset:1024
    buffer_load_dwordx4 a[24:27], v253, s[8:11], s41 offen offset:0
    buffer_load_dwordx4 a[28:31], v253, s[8:11], s41 offen offset:1024
    s_add_u32 m0, s31, 16384
    s_add_u32 s40, s44, 4096
    buffer_load_dwordx4 v250, s[12:15], s40 offen lds
    s_add_u32 m0, s31, 20480
    s_add_u32 s40, s44, 40960
    buffer_load_dwordx4 v250, s[12:15], s40 offen lds
    s_add_u32 m0, s31, 24576
    s_add_u32 s40, s44, 77824
    buffer_load_dwordx4 v250, s[12:15], s40 offen lds
    s_mov_b32 s41, 8192
    buffer_load_dwordx4 a[32:35], v252, s[8:11], s41 offen offset:0
    buffer_load_dwordx4 a[36:39], v252, s[8:11], s41 offen offset:1024
    buffer_load_dwordx4 a[40:43], v253, s[8:11], s41 offen offset:0
    buffer_load_dwordx4 a[44:47], v253, s[8:11], s41 offen offset:1024
    s_waitcnt vmcnt(15)
    s_barrier
    ds_read_b128 v[192:195], v248 offset:4096
    ds_read_b128 v[196:199], v248 offset:5120
    ds_read_b128 v[200:203], v248 offset:8192
    ds_read_b128 v[204:207], v248 offset:9216
    s_waitcnt lgkmcnt(2)
    s_waitcnt vmcnt(13)
    v_mfma_f32_16x16x32_bf16 v[32:35], v[192:195], a[0:3], 0
    ds_read_b128 v[208:211], v248 offset:12288
    v_mfma_f32_16x16x32_bf16 v[36:39], v[192:195], a[4:7], 0
    ds_read_b128 v[212:215], v248 offset:13312
    s_waitcnt vmcnt(11)
    v_mfma_f32_16x16x32_bf16 v[40:43], v[192:195], a[8:11], 0
    s_add_u32 m0, s31, 0
    s_nop 0
    buffer_load_dwordx4 v250, s[20:23], 0 offen lds
    v_mfma_f32_16x16x32_bf16 v[44:47], v[192:195], a[12:15], 0
    s_mov_b32 s41, 12288
    buffer_load_dwordx4 a[48:51], v252, s[8:11], s41 offen offset:0
    v_mfma_f32_16x16x32_bf16 v[48:51], v[196:199], a[0:3], 0
    buffer_load_dwordx4 a[52:55], v252, s[8:11], s41 offen offset:1024
    buffer_load_dwordx4 a[56:59], v253, s[8:11], s41 offen offset:0
    v_mfma_f32_16x16x32_bf16 v[52:55], v[196:199], a[4:7], 0
    buffer_load_dwordx4 a[60:63], v253, s[8:11], s41 offen offset:1024
    v_mfma_f32_16x16x32_bf16 v[56:59], v[196:199], a[8:11], 0
    s_add_u32 m0, s31, 28672
    s_add_u32 s40, s44, 8192
    buffer_load_dwordx4 v250, s[12:15], s40 offen lds
    v_mfma_f32_16x16x32_bf16 v[60:63], v[196:199], a[12:15], 0
    s_waitcnt lgkmcnt(2)
    v_mfma_f32_16x16x32_bf16 v[64:67], v[200:203], a[0:3], 0
    ds_read_b128 v[192:195], v248 offset:6144
    v_mfma_f32_16x16x32_bf16 v[68:71], v[200:203], a[4:7], 0
    ds_read_b128 v[196:199], v248 offset:7168
    v_mfma_f32_16x16x32_bf16 v[72:75], v[200:203], a[8:11], 0
    s_add_u32 m0, s31, 32768
    s_add_u32 s40, s44, 45056
    buffer_load_dwordx4 v250, s[12:15], s40 offen lds
    v_mfma_f32_16x16x32_bf16 v[76:79], v[200:203], a[12:15], 0
    s_add_u32 m0, s31, 36864
    s_add_u32 s40, s44, 81920
    buffer_load_dwordx4 v250, s[12:15], s40 offen lds
    v_mfma_f32_16x16x32_bf16 v[80:83], v[204:207], a[0:3], 0
    v_mfma_f32_16x16x32_bf16 v[84:87], v[204:207], a[4:7], 0
    v_mfma_f32_16x16x32_bf16 v[88:91], v[204:207], a[8:11], 0
    v_mfma_f32_16x16x32_bf16 v[92:95], v[204:207], a[12:15], 0
    s_waitcnt lgkmcnt(2)
    v_mfma_f32_16x16x32_bf16 v[96:99], v[208:211], a[0:3], 0
    ds_read_b128 v[200:203], v248 offset:10240
    s_mov_b32 s41, 16384
    v_mfma_f32_16x16x32_bf16 v[100:103], v[208:211], a[4:7], 0
    ds_read_b128 v[204:207], v248 offset:11264
    buffer_load_dwordx4 a[64:67], v252, s[8:11], s41 offen offset:0
    v_mfma_f32_16x16x32_bf16 v[104:107], v[208:211], a[8:11], 0
    buffer_load_dwordx4 a[68:71], v252, s[8:11], s41 offen offset:1024
    buffer_load_dwordx4 a[72:75], v253, s[8:11], s41 offen offset:0
    v_mfma_f32_16x16x32_bf16 v[108:111], v[208:211], a[12:15], 0
    buffer_load_dwordx4 a[76:79], v253, s[8:11], s41 offen offset:1024
    v_mfma_f32_16x16x32_bf16 v[112:115], v[212:215], a[0:3], 0
    v_mfma_f32_16x16x32_bf16 v[116:119], v[212:215], a[4:7], 0
    v_mfma_f32_16x16x32_bf16 v[120:123], v[212:215], a[8:11], 0
    v_mfma_f32_16x16x32_bf16 v[124:127], v[212:215], a[12:15], 0
    s_waitcnt lgkmcnt(2)
    s_waitcnt vmcnt(21)
    v_mfma_f32_16x16x32_bf16 v[32:35], v[192:195], a[16:19], v[32:35]
    ds_read_b128 v[208:211], v248 offset:14336
    v_mfma_f32_16x16x32_bf16 v[36:39], v[192:195], a[20:23], v[36:39]
    ds_read_b128 v[212:215], v248 offset:15360
    s_waitcnt vmcnt(19)
    v_mfma_f32_16x16x32_bf16 v[40:43], v[192:195], a[24:27], v[40:43]
    v_mfma_f32_16x16x32_bf16 v[44:47], v[192:195], a[28:31], v[44:47]
    v_mfma_f32_16x16x32_bf16 v[48:51], v[196:199], a[16:19], v[48:51]
    v_mfma_f32_16x16x32_bf16 v[52:55], v[196:199], a[20:23], v[52:55]
    v_mfma_f32_16x16x32_bf16 v[56:59], v[196:199], a[24:27], v[56:59]
    v_mfma_f32_16x16x32_bf16 v[60:63], v[196:199], a[28:31], v[60:63]
    s_waitcnt lgkmcnt(2)
    v_mfma_f32_16x16x32_bf16 v[64:67], v[200:203], a[16:19], v[64:67]
    s_waitcnt vmcnt(16)
    s_barrier
    v_mfma_f32_16x16x32_bf16 v[68:71], v[200:203], a[20:23], v[68:71]
    ds_read_b128 v[192:195], v248 offset:16384
    v_mfma_f32_16x16x32_bf16 v[72:75], v[200:203], a[24:27], v[72:75]
    ds_read_b128 v[196:199], v248 offset:17408
    v_mfma_f32_16x16x32_bf16 v[76:79], v[200:203], a[28:31], v[76:79]
    v_mfma_f32_16x16x32_bf16 v[80:83], v[204:207], a[16:19], v[80:83]
    v_mfma_f32_16x16x32_bf16 v[84:87], v[204:207], a[20:23], v[84:87]
    v_mfma_f32_16x16x32_bf16 v[88:91], v[204:207], a[24:27], v[88:91]
    v_mfma_f32_16x16x32_bf16 v[92:95], v[204:207], a[28:31], v[92:95]
    s_waitcnt lgkmcnt(2)
    v_mfma_f32_16x16x32_bf16 v[96:99], v[208:211], a[16:19], v[96:99]
    ds_read_b128 v[200:203], v248 offset:20480
    s_mov_b32 s41, 20480
    v_mfma_f32_16x16x32_bf16 v[100:103], v[208:211], a[20:23], v[100:103]
    ds_read_b128 v[204:207], v248 offset:21504
    buffer_load_dwordx4 a[80:83], v252, s[8:11], s41 offen offset:0
    v_mfma_f32_16x16x32_bf16 v[104:107], v[208:211], a[24:27], v[104:107]
    buffer_load_dwordx4 a[84:87], v252, s[8:11], s41 offen offset:1024
    buffer_load_dwordx4 a[88:91], v253, s[8:11], s41 offen offset:0
    v_mfma_f32_16x16x32_bf16 v[108:111], v[208:211], a[28:31], v[108:111]
    buffer_load_dwordx4 a[92:95], v253, s[8:11], s41 offen offset:1024
    v_mfma_f32_16x16x32_bf16 v[112:115], v[212:215], a[16:19], v[112:115]
    v_mfma_f32_16x16x32_bf16 v[116:119], v[212:215], a[20:23], v[116:119]
    v_mfma_f32_16x16x32_bf16 v[120:123], v[212:215], a[24:27], v[120:123]
    v_mfma_f32_16x16x32_bf16 v[124:127], v[212:215], a[28:31], v[124:127]
    s_waitcnt lgkmcnt(2)
    s_waitcnt vmcnt(18)
    v_mfma_f32_16x16x32_bf16 v[32:35], v[192:195], a[32:35], v[32:35]
    ds_read_b128 v[208:211], v248 offset:24576
    v_mfma_f32_16x16x32_bf16 v[36:39], v[192:195], a[36:39], v[36:39]
    ds_read_b128 v[212:215], v248 offset:25600
    s_waitcnt vmcnt(16)
    v_mfma_f32_16x16x32_bf16 v[40:43], v[192:195], a[40:43], v[40:43]
    s_add_u32 m0, s31, 40960
    s_add_u32 s40, s44, 12288
    buffer_load_dwordx4 v250, s[12:15], s40 offen lds
    v_mfma_f32_16x16x32_bf16 v[44:47], v[192:195], a[44:47], v[44:47]
    s_add_u32 m0, s31, 45056
    s_add_u32 s40, s44, 49152
    buffer_load_dwordx4 v250, s[12:15], s40 offen lds
    v_mfma_f32_16x16x32_bf16 v[48:51], v[196:199], a[32:35], v[48:51]
    s_add_u32 m0, s31, 49152
    s_add_u32 s40, s44, 86016
    buffer_load_dwordx4 v250, s[12:15], s40 offen lds
    v_mfma_f32_16x16x32_bf16 v[52:55], v[196:199], a[36:39], v[52:55]
    v_mfma_f32_16x16x32_bf16 v[56:59], v[196:199], a[40:43], v[56:59]
    v_mfma_f32_16x16x32_bf16 v[60:63], v[196:199], a[44:47], v[60:63]
    s_waitcnt lgkmcnt(2)
    v_mfma_f32_16x16x32_bf16 v[64:67], v[200:203], a[32:35], v[64:67]
    ds_read_b128 v[192:195], v248 offset:18432
    v_mfma_f32_16x16x32_bf16 v[68:71], v[200:203], a[36:39], v[68:71]
    ds_read_b128 v[196:199], v248 offset:19456
    v_mfma_f32_16x16x32_bf16 v[72:75], v[200:203], a[40:43], v[72:75]
    v_mfma_f32_16x16x32_bf16 v[76:79], v[200:203], a[44:47], v[76:79]
    v_mfma_f32_16x16x32_bf16 v[80:83], v[204:207], a[32:35], v[80:83]
    v_mfma_f32_16x16x32_bf16 v[84:87], v[204:207], a[36:39], v[84:87]
    v_mfma_f32_16x16x32_bf16 v[88:91], v[204:207], a[40:43], v[88:91]
    v_mfma_f32_16x16x32_bf16 v[92:95], v[204:207], a[44:47], v[92:95]
    s_waitcnt lgkmcnt(2)
    v_mfma_f32_16x16x32_bf16 v[96:99], v[208:211], a[32:35], v[96:99]
    ds_read_b128 v[200:203], v248 offset:22528
    s_mov_b32 s41, 24576
    v_mfma_f32_16x16x32_bf16 v[100:103], v[208:211], a[36:39], v[100:103]
    ds_read_b128 v[204:207], v248 offset:23552
    buffer_load_dwordx4 a[96:99], v252, s[8:11], s41 offen offset:0
    v_mfma_f32_16x16x32_bf16 v[104:107], v[208:211], a[40:43], v[104:107]
    buffer_load_dwordx4 a[100:103], v252, s[8:11], s41 offen offset:1024
    buffer_load_dwordx4 a[104:107], v253, s[8:11], s41 offen offset:0
    v_mfma_f32_16x16x32_bf16 v[108:111], v[208:211], a[44:47], v[108:111]
    buffer_load_dwordx4 a[108:111], v253, s[8:11], s41 offen offset:1024
    v_mfma_f32_16x16x32_bf16 v[112:115], v[212:215], a[32:35], v[112:115]
    v_mfma_f32_16x16x32_bf16 v[116:119], v[212:215], a[36:39], v[116:119]
    v_mfma_f32_16x16x32_bf16 v[120:123], v[212:215], a[40:43], v[120:123]
    v_mfma_f32_16x16x32_bf16 v[124:127], v[212:215], a[44:47], v[124:127]
    s_waitcnt lgkmcnt(2)
    s_waitcnt vmcnt(20)
    v_mfma_f32_16x16x32_bf16 v[32:35], v[192:195], a[48:51], v[32:35]
    ds_read_b128 v[208:211], v248 offset:26624
    v_mfma_f32_16x16x32_bf16 v[36:39], v[192:195], a[52:55], v[36:39]
    ds_read_b128 v[212:215], v248 offset:27648
    s_waitcnt vmcnt(18)
    v_mfma_f32_16x16x32_bf16 v[40:43], v[192:195], a[56:59], v[40:43]
    v_mfma_f32_16x16x32_bf16 v[44:47], v[192:195], a[60:63], v[44:47]
    v_mfma_f32_16x16x32_bf16 v[48:51], v[196:199], a[48:51], v[48:51]
    v_mfma_f32_16x16x32_bf16 v[52:55], v[196:199], a[52:55], v[52:55]
    v_mfma_f32_16x16x32_bf16 v[56:59], v[196:199], a[56:59], v[56:59]
    v_mfma_f32_16x16x32_bf16 v[60:63], v[196:199], a[60:63], v[60:63]
    s_waitcnt lgkmcnt(2)
    v_mfma_f32_16x16x32_bf16 v[64:67], v[200:203], a[48:51], v[64:67]
    s_waitcnt vmcnt(15)
    s_barrier
    v_mfma_f32_16x16x32_bf16 v[68:71], v[200:203], a[52:55], v[68:71]
    ds_read_b128 v[192:195], v248 offset:28672
    v_mfma_f32_16x16x32_bf16 v[72:75], v[200:203], a[56:59], v[72:75]
    ds_read_b128 v[196:199], v248 offset:29696
    v_mfma_f32_16x16x32_bf16 v[76:79], v[200:203], a[60:63], v[76:79]
    v_mfma_f32_16x16x32_bf16 v[80:83], v[204:207], a[48:51], v[80:83]
    v_mfma_f32_16x16x32_bf16 v[84:87], v[204:207], a[52:55], v[84:87]
    v_mfma_f32_16x16x32_bf16 v[88:91], v[204:207], a[56:59], v[88:91]
    v_mfma_f32_16x16x32_bf16 v[92:95], v[204:207], a[60:63], v[92:95]
    s_waitcnt lgkmcnt(2)
    v_mfma_f32_16x16x32_bf16 v[96:99], v[208:211], a[48:51], v[96:99]
    ds_read_b128 v[200:203], v248 offset:32768
    s_mov_b32 s41, 28672
    v_mfma_f32_16x16x32_bf16 v[100:103], v[208:211], a[52:55], v[100:103]
    ds_read_b128 v[204:207], v248 offset:33792
    buffer_load_dwordx4 a[112:115], v252, s[8:11], s41 offen offset:0
    v_mfma_f32_16x16x32_bf16 v[104:107], v[208:211], a[56:59], v[104:107]
    buffer_load_dwordx4 a[116:119], v252, s[8:11], s41 offen offset:1024
    buffer_load_dwordx4 a[120:123], v253, s[8:11], s41 offen offset:0
    v_mfma_f32_16x16x32_bf16 v[108:111], v[208:211], a[60:63], v[108:111]
    buffer_load_dwordx4 a[124:127], v253, s[8:11], s41 offen offset:1024
    v_mfma_f32_16x16x32_bf16 v[112:115], v[212:215], a[48:51], v[112:115]
    v_mfma_f32_16x16x32_bf16 v[116:119], v[212:215], a[52:55], v[116:119]
    v_mfma_f32_16x16x32_bf16 v[120:123], v[212:215], a[56:59], v[120:123]
    v_mfma_f32_16x16x32_bf16 v[124:127], v[212:215], a[60:63], v[124:127]
    s_waitcnt lgkmcnt(2)
    s_waitcnt vmcnt(17)
    v_mfma_f32_16x16x32_bf16 v[32:35], v[192:195], a[64:67], v[32:35]
    ds_read_b128 v[208:211], v248 offset:36864
    v_mfma_f32_16x16x32_bf16 v[36:39], v[192:195], a[68:71], v[36:39]
    ds_read_b128 v[212:215], v248 offset:37888
    s_waitcnt vmcnt(15)
    v_mfma_f32_16x16x32_bf16 v[40:43], v[192:195], a[72:75], v[40:43]
    s_add_u32 m0, s31, 53248
    s_add_u32 s40, s44, 16384
    buffer_load_dwordx4 v250, s[12:15], s40 offen lds
    v_mfma_f32_16x16x32_bf16 v[44:47], v[192:195], a[76:79], v[44:47]
    s_add_u32 m0, s31, 57344
    s_add_u32 s40, s44, 53248
    buffer_load_dwordx4 v250, s[12:15], s40 offen lds
    v_mfma_f32_16x16x32_bf16 v[48:51], v[196:199], a[64:67], v[48:51]
    s_add_u32 m0, s31, 61440
    s_add_u32 s40, s44, 90112
    buffer_load_dwordx4 v250, s[12:15], s40 offen lds
    v_mfma_f32_16x16x32_bf16 v[52:55], v[196:199], a[68:71], v[52:55]
    v_mfma_f32_16x16x32_bf16 v[56:59], v[196:199], a[72:75], v[56:59]
    v_mfma_f32_16x16x32_bf16 v[60:63], v[196:199], a[76:79], v[60:63]
    s_waitcnt lgkmcnt(2)
    v_mfma_f32_16x16x32_bf16 v[64:67], v[200:203], a[64:67], v[64:67]
    ds_read_b128 v[192:195], v248 offset:30720
    v_mfma_f32_16x16x32_bf16 v[68:71], v[200:203], a[68:71], v[68:71]
    ds_read_b128 v[196:199], v248 offset:31744
    v_mfma_f32_16x16x32_bf16 v[72:75], v[200:203], a[72:75], v[72:75]
    v_mfma_f32_16x16x32_bf16 v[76:79], v[200:203], a[76:79], v[76:79]
    v_mfma_f32_16x16x32_bf16 v[80:83], v[204:207], a[64:67], v[80:83]
    v_mfma_f32_16x16x32_bf16 v[84:87], v[204:207], a[68:71], v[84:87]
    v_mfma_f32_16x16x32_bf16 v[88:91], v[204:207], a[72:75], v[88:91]
    v_mfma_f32_16x16x32_bf16 v[92:95], v[204:207], a[76:79], v[92:95]
    s_waitcnt lgkmcnt(2)
    v_mfma_f32_16x16x32_bf16 v[96:99], v[208:211], a[64:67], v[96:99]
    ds_read_b128 v[200:203], v248 offset:34816
    s_mov_b32 s41, 32768
    v_mfma_f32_16x16x32_bf16 v[100:103], v[208:211], a[68:71], v[100:103]
    ds_read_b128 v[204:207], v248 offset:35840
    buffer_load_dwordx4 a[128:131], v252, s[8:11], s41 offen offset:0
    v_mfma_f32_16x16x32_bf16 v[104:107], v[208:211], a[72:75], v[104:107]
    buffer_load_dwordx4 a[132:135], v252, s[8:11], s41 offen offset:1024
    buffer_load_dwordx4 a[136:139], v253, s[8:11], s41 offen offset:0
    v_mfma_f32_16x16x32_bf16 v[108:111], v[208:211], a[76:79], v[108:111]
    buffer_load_dwordx4 a[140:143], v253, s[8:11], s41 offen offset:1024
    v_mfma_f32_16x16x32_bf16 v[112:115], v[212:215], a[64:67], v[112:115]
    v_mfma_f32_16x16x32_bf16 v[116:119], v[212:215], a[68:71], v[116:119]
    v_mfma_f32_16x16x32_bf16 v[120:123], v[212:215], a[72:75], v[120:123]
    v_mfma_f32_16x16x32_bf16 v[124:127], v[212:215], a[76:79], v[124:127]
    s_waitcnt lgkmcnt(2)
    s_waitcnt vmcnt(20)
    v_mfma_f32_16x16x32_bf16 v[32:35], v[192:195], a[80:83], v[32:35]
    ds_read_b128 v[208:211], v248 offset:38912
    buffer_load_dwordx4 v[160:163], v176, s[24:27], 0 offen offset:0
    v_mfma_f32_16x16x32_bf16 v[36:39], v[192:195], a[84:87], v[36:39]
    ds_read_b128 v[212:215], v248 offset:39936
    s_waitcnt vmcnt(19)
    v_mfma_f32_16x16x32_bf16 v[40:43], v[192:195], a[88:91], v[40:43]
    buffer_load_dwordx4 v[164:167], v176, s[24:27], 0 offen offset:1024
    buffer_load_dwordx4 v[168:171], v177, s[24:27], 0 offen offset:0
    v_mfma_f32_16x16x32_bf16 v[44:47], v[192:195], a[92:95], v[44:47]
    buffer_load_dwordx4 v[172:175], v177, s[24:27], 0 offen offset:1024
    v_mfma_f32_16x16x32_bf16 v[48:51], v[196:199], a[80:83], v[48:51]
    v_mfma_f32_16x16x32_bf16 v[52:55], v[196:199], a[84:87], v[52:55]
    v_mfma_f32_16x16x32_bf16 v[56:59], v[196:199], a[88:91], v[56:59]
    v_mfma_f32_16x16x32_bf16 v[60:63], v[196:199], a[92:95], v[60:63]
    s_waitcnt lgkmcnt(2)
    v_mfma_f32_16x16x32_bf16 v[64:67], v[200:203], a[80:83], v[64:67]
    s_waitcnt vmcnt(19)
    s_barrier
    v_mfma_f32_16x16x32_bf16 v[68:71], v[200:203], a[84:87], v[68:71]
    ds_read_b128 v[192:195], v248 offset:40960
    v_mfma_f32_16x16x32_bf16 v[72:75], v[200:203], a[88:91], v[72:75]
    ds_read_b128 v[196:199], v248 offset:41984
    v_mfma_f32_16x16x32_bf16 v[76:79], v[200:203], a[92:95], v[76:79]
    v_mfma_f32_16x16x32_bf16 v[80:83], v[204:207], a[80:83], v[80:83]
    v_mfma_f32_16x16x32_bf16 v[84:87], v[204:207], a[84:87], v[84:87]
    v_mfma_f32_16x16x32_bf16 v[88:91], v[204:207], a[88:91], v[88:91]
    v_mfma_f32_16x16x32_bf16 v[92:95], v[204:207], a[92:95], v[92:95]
    s_waitcnt lgkmcnt(2)
    v_mfma_f32_16x16x32_bf16 v[96:99], v[208:211], a[80:83], v[96:99]
    ds_read_b128 v[200:203], v248 offset:45056
    s_mov_b32 s41, 36864
    v_mfma_f32_16x16x32_bf16 v[100:103], v[208:211], a[84:87], v[100:103]
    ds_read_b128 v[204:207], v248 offset:46080
    buffer_load_dwordx4 a[144:147], v252, s[8:11], s41 offen offset:0
    v_mfma_f32_16x16x32_bf16 v[104:107], v[208:211], a[88:91], v[104:107]
    buffer_load_dwordx4 a[148:151], v252, s[8:11], s41 offen offset:1024
    buffer_load_dwordx4 a[152:155], v253, s[8:11], s41 offen offset:0
    v_mfma_f32_16x16x32_bf16 v[108:111], v[208:211], a[92:95], v[108:111]
    buffer_load_dwordx4 a[156:159], v253, s[8:11], s41 offen offset:1024
    v_mfma_f32_16x16x32_bf16 v[112:115], v[212:215], a[80:83], v[112:115]
    v_mfma_f32_16x16x32_bf16 v[116:119], v[212:215], a[84:87], v[116:119]
    v_mfma_f32_16x16x32_bf16 v[120:123], v[212:215], a[88:91], v[120:123]
    v_mfma_f32_16x16x32_bf16 v[124:127], v[212:215], a[92:95], v[124:127]
    s_waitcnt lgkmcnt(2)
    s_waitcnt vmcnt(21)
    v_mfma_f32_16x16x32_bf16 v[32:35], v[192:195], a[96:99], v[32:35]
    ds_read_b128 v[208:211], v248 offset:49152
    v_mfma_f32_16x16x32_bf16 v[36:39], v[192:195], a[100:103], v[36:39]
    ds_read_b128 v[212:215], v248 offset:50176
    s_waitcnt vmcnt(19)
    v_mfma_f32_16x16x32_bf16 v[40:43], v[192:195], a[104:107], v[40:43]
    s_add_u32 m0, s31, 65536
    s_add_u32 s40, s44, 20480
    buffer_load_dwordx4 v250, s[12:15], s40 offen lds
    v_mfma_f32_16x16x32_bf16 v[44:47], v[192:195], a[108:111], v[44:47]
    s_add_u32 m0, s31, 69632
    s_add_u32 s40, s44, 57344
    buffer_load_dwordx4 v250, s[12:15], s40 offen lds
    v_mfma_f32_16x16x32_bf16 v[48:51], v[196:199], a[96:99], v[48:51]
    s_add_u32 m0, s31, 73728
    s_add_u32 s40, s44, 94208
    buffer_load_dwordx4 v250, s[12:15], s40 offen lds
    v_mfma_f32_16x16x32_bf16 v[52:55], v[196:199], a[100:103], v[52:55]
    v_mfma_f32_16x16x32_bf16 v[56:59], v[196:199], a[104:107], v[56:59]
    v_mfma_f32_16x16x32_bf16 v[60:63], v[196:199], a[108:111], v[60:63]
    s_waitcnt lgkmcnt(2)
    v_mfma_f32_16x16x32_bf16 v[64:67], v[200:203], a[96:99], v[64:67]
    ds_read_b128 v[192:195], v248 offset:43008
    v_mfma_f32_16x16x32_bf16 v[68:71], v[200:203], a[100:103], v[68:71]
    ds_read_b128 v[196:199], v248 offset:44032
    v_mfma_f32_16x16x32_bf16 v[72:75], v[200:203], a[104:107], v[72:75]
    v_mfma_f32_16x16x32_bf16 v[76:79], v[200:203], a[108:111], v[76:79]
    v_mfma_f32_16x16x32_bf16 v[80:83], v[204:207], a[96:99], v[80:83]
    v_mfma_f32_16x16x32_bf16 v[84:87], v[204:207], a[100:103], v[84:87]
    v_mfma_f32_16x16x32_bf16 v[88:91], v[204:207], a[104:107], v[88:91]
    v_mfma_f32_16x16x32_bf16 v[92:95], v[204:207], a[108:111], v[92:95]
    s_waitcnt lgkmcnt(2)
    v_mfma_f32_16x16x32_bf16 v[96:99], v[208:211], a[96:99], v[96:99]
    ds_read_b128 v[200:203], v248 offset:47104
    s_mov_b32 s41, 40960
    v_mfma_f32_16x16x32_bf16 v[100:103], v[208:211], a[100:103], v[100:103]
    ds_read_b128 v[204:207], v248 offset:48128
    buffer_load_dwordx4 a[160:163], v252, s[8:11], s41 offen offset:0
    v_mfma_f32_16x16x32_bf16 v[104:107], v[208:211], a[104:107], v[104:107]
    buffer_load_dwordx4 a[164:167], v252, s[8:11], s41 offen offset:1024
    buffer_load_dwordx4 a[168:171], v253, s[8:11], s41 offen offset:0
    v_mfma_f32_16x16x32_bf16 v[108:111], v[208:211], a[108:111], v[108:111]
    buffer_load_dwordx4 a[172:175], v253, s[8:11], s41 offen offset:1024
    v_mfma_f32_16x16x32_bf16 v[112:115], v[212:215], a[96:99], v[112:115]
    v_mfma_f32_16x16x32_bf16 v[116:119], v[212:215], a[100:103], v[116:119]
    v_mfma_f32_16x16x32_bf16 v[120:123], v[212:215], a[104:107], v[120:123]
    v_mfma_f32_16x16x32_bf16 v[124:127], v[212:215], a[108:111], v[124:127]
    s_waitcnt lgkmcnt(2)
    s_waitcnt vmcnt(24)
    v_mfma_f32_16x16x32_bf16 v[32:35], v[192:195], a[112:115], v[32:35]
    ds_read_b128 v[208:211], v248 offset:51200
    v_mfma_f32_16x16x32_bf16 v[36:39], v[192:195], a[116:119], v[36:39]
    ds_read_b128 v[212:215], v248 offset:52224
    s_waitcnt vmcnt(22)
    v_mfma_f32_16x16x32_bf16 v[40:43], v[192:195], a[120:123], v[40:43]
    v_mfma_f32_16x16x32_bf16 v[44:47], v[192:195], a[124:127], v[44:47]
    v_mfma_f32_16x16x32_bf16 v[48:51], v[196:199], a[112:115], v[48:51]
    v_mfma_f32_16x16x32_bf16 v[52:55], v[196:199], a[116:119], v[52:55]
    v_mfma_f32_16x16x32_bf16 v[56:59], v[196:199], a[120:123], v[56:59]
    v_mfma_f32_16x16x32_bf16 v[60:63], v[196:199], a[124:127], v[60:63]
    s_waitcnt lgkmcnt(2)
    v_mfma_f32_16x16x32_bf16 v[64:67], v[200:203], a[112:115], v[64:67]
    s_waitcnt vmcnt(19)
    s_barrier
    v_mfma_f32_16x16x32_bf16 v[68:71], v[200:203], a[116:119], v[68:71]
    ds_read_b128 v[192:195], v248 offset:53248
    v_mfma_f32_16x16x32_bf16 v[72:75], v[200:203], a[120:123], v[72:75]
    ds_read_b128 v[196:199], v248 offset:54272
    v_mfma_f32_16x16x32_bf16 v[76:79], v[200:203], a[124:127], v[76:79]
    v_mfma_f32_16x16x32_bf16 v[80:83], v[204:207], a[112:115], v[80:83]
    v_mfma_f32_16x16x32_bf16 v[84:87], v[204:207], a[116:119], v[84:87]
    v_mfma_f32_16x16x32_bf16 v[88:91], v[204:207], a[120:123], v[88:91]
    v_mfma_f32_16x16x32_bf16 v[92:95], v[204:207], a[124:127], v[92:95]
    s_waitcnt lgkmcnt(2)
    v_mfma_f32_16x16x32_bf16 v[96:99], v[208:211], a[112:115], v[96:99]
    ds_read_b128 v[200:203], v248 offset:57344
    s_mov_b32 s41, 45056
    v_mfma_f32_16x16x32_bf16 v[100:103], v[208:211], a[116:119], v[100:103]
    ds_read_b128 v[204:207], v248 offset:58368
    buffer_load_dwordx4 a[176:179], v252, s[8:11], s41 offen offset:0
    v_mfma_f32_16x16x32_bf16 v[104:107], v[208:211], a[120:123], v[104:107]
    buffer_load_dwordx4 a[180:183], v252, s[8:11], s41 offen offset:1024
    buffer_load_dwordx4 a[184:187], v253, s[8:11], s41 offen offset:0
    v_mfma_f32_16x16x32_bf16 v[108:111], v[208:211], a[124:127], v[108:111]
    buffer_load_dwordx4 a[188:191], v253, s[8:11], s41 offen offset:1024
    v_mfma_f32_16x16x32_bf16 v[112:115], v[212:215], a[112:115], v[112:115]
    v_mfma_f32_16x16x32_bf16 v[116:119], v[212:215], a[116:119], v[116:119]
    v_mfma_f32_16x16x32_bf16 v[120:123], v[212:215], a[120:123], v[120:123]
    v_mfma_f32_16x16x32_bf16 v[124:127], v[212:215], a[124:127], v[124:127]
    s_waitcnt lgkmcnt(2)
    s_waitcnt vmcnt(21)
    v_mfma_f32_16x16x32_bf16 v[32:35], v[192:195], a[128:131], v[32:35]
    ds_read_b128 v[208:211], v248 offset:61440
    v_mfma_f32_16x16x32_bf16 v[36:39], v[192:195], a[132:135], v[36:39]
    ds_read_b128 v[212:215], v248 offset:62464
    s_waitcnt vmcnt(19)
    v_mfma_f32_16x16x32_bf16 v[40:43], v[192:195], a[136:139], v[40:43]
    s_add_u32 m0, s31, 77824
    s_add_u32 s40, s44, 24576
    buffer_load_dwordx4 v250, s[12:15], s40 offen lds
    v_mfma_f32_16x16x32_bf16 v[44:47], v[192:195], a[140:143], v[44:47]
    s_add_u32 m0, s31, 81920
    s_add_u32 s40, s44, 61440
    buffer_load_dwordx4 v250, s[12:15], s40 offen lds
    v_mfma_f32_16x16x32_bf16 v[48:51], v[196:199], a[128:131], v[48:51]
    s_add_u32 m0, s31, 86016
    s_add_u32 s40, s44, 98304
    buffer_load_dwordx4 v250, s[12:15], s40 offen lds
    v_mfma_f32_16x16x32_bf16 v[52:55], v[196:199], a[132:135], v[52:55]
    v_mfma_f32_16x16x32_bf16 v[56:59], v[196:199], a[136:139], v[56:59]
    v_mfma_f32_16x16x32_bf16 v[60:63], v[196:199], a[140:143], v[60:63]
    s_waitcnt lgkmcnt(2)
    v_mfma_f32_16x16x32_bf16 v[64:67], v[200:203], a[128:131], v[64:67]
    ds_read_b128 v[192:195], v248 offset:55296
    v_mfma_f32_16x16x32_bf16 v[68:71], v[200:203], a[132:135], v[68:71]
    ds_read_b128 v[196:199], v248 offset:56320
    v_mfma_f32_16x16x32_bf16 v[72:75], v[200:203], a[136:139], v[72:75]
    v_mfma_f32_16x16x32_bf16 v[76:79], v[200:203], a[140:143], v[76:79]
    v_mfma_f32_16x16x32_bf16 v[80:83], v[204:207], a[128:131], v[80:83]
    v_mfma_f32_16x16x32_bf16 v[84:87], v[204:207], a[132:135], v[84:87]
    v_mfma_f32_16x16x32_bf16 v[88:91], v[204:207], a[136:139], v[88:91]
    v_mfma_f32_16x16x32_bf16 v[92:95], v[204:207], a[140:143], v[92:95]
    s_waitcnt lgkmcnt(2)
    v_mfma_f32_16x16x32_bf16 v[96:99], v[208:211], a[128:131], v[96:99]
    ds_read_b128 v[200:203], v248 offset:59392
    s_mov_b32 s41, 49152
    v_mfma_f32_16x16x32_bf16 v[100:103], v[208:211], a[132:135], v[100:103]
    ds_read_b128 v[204:207], v248 offset:60416
    buffer_load_dwordx4 a[192:195], v252, s[8:11], s41 offen offset:0
    v_mfma_f32_16x16x32_bf16 v[104:107], v[208:211], a[136:139], v[104:107]
    buffer_load_dwordx4 a[196:199], v252, s[8:11], s41 offen offset:1024
    buffer_load_dwordx4 a[200:203], v253, s[8:11], s41 offen offset:0
    v_mfma_f32_16x16x32_bf16 v[108:111], v[208:211], a[140:143], v[108:111]
    buffer_load_dwordx4 a[204:207], v253, s[8:11], s41 offen offset:1024
    v_mfma_f32_16x16x32_bf16 v[112:115], v[212:215], a[128:131], v[112:115]
    v_mfma_f32_16x16x32_bf16 v[116:119], v[212:215], a[132:135], v[116:119]
    v_mfma_f32_16x16x32_bf16 v[120:123], v[212:215], a[136:139], v[120:123]
    v_mfma_f32_16x16x32_bf16 v[124:127], v[212:215], a[140:143], v[124:127]
    s_waitcnt lgkmcnt(2)
    s_waitcnt vmcnt(20)
    v_mfma_f32_16x16x32_bf16 v[32:35], v[192:195], a[144:147], v[32:35]
    ds_read_b128 v[208:211], v248 offset:63488
    v_mfma_f32_16x16x32_bf16 v[36:39], v[192:195], a[148:151], v[36:39]
    ds_read_b128 v[212:215], v248 offset:64512
    s_waitcnt vmcnt(18)
    v_mfma_f32_16x16x32_bf16 v[40:43], v[192:195], a[152:155], v[40:43]
    v_mfma_f32_16x16x32_bf16 v[44:47], v[192:195], a[156:159], v[44:47]
    v_mfma_f32_16x16x32_bf16 v[48:51], v[196:199], a[144:147], v[48:51]
    v_mfma_f32_16x16x32_bf16 v[52:55], v[196:199], a[148:151], v[52:55]
    v_mfma_f32_16x16x32_bf16 v[56:59], v[196:199], a[152:155], v[56:59]
    v_mfma_f32_16x16x32_bf16 v[60:63], v[196:199], a[156:159], v[60:63]
    s_waitcnt lgkmcnt(2)
    v_mfma_f32_16x16x32_bf16 v[64:67], v[200:203], a[144:147], v[64:67]
    s_waitcnt vmcnt(15)
    s_barrier
    v_mfma_f32_16x16x32_bf16 v[68:71], v[200:203], a[148:151], v[68:71]
    ds_read_b128 v[192:195], v249 offset:0
    v_mfma_f32_16x16x32_bf16 v[72:75], v[200:203], a[152:155], v[72:75]
    ds_read_b128 v[196:199], v249 offset:1024
    v_mfma_f32_16x16x32_bf16 v[76:79], v[200:203], a[156:159], v[76:79]
    v_mfma_f32_16x16x32_bf16 v[80:83], v[204:207], a[144:147], v[80:83]
    v_mfma_f32_16x16x32_bf16 v[84:87], v[204:207], a[148:151], v[84:87]
    v_mfma_f32_16x16x32_bf16 v[88:91], v[204:207], a[152:155], v[88:91]
    v_mfma_f32_16x16x32_bf16 v[92:95], v[204:207], a[156:159], v[92:95]
    s_waitcnt lgkmcnt(2)
    v_mfma_f32_16x16x32_bf16 v[96:99], v[208:211], a[144:147], v[96:99]
    ds_read_b128 v[200:203], v249 offset:4096
    s_mov_b32 s41, 53248
    v_mfma_f32_16x16x32_bf16 v[100:103], v[208:211], a[148:151], v[100:103]
    ds_read_b128 v[204:207], v249 offset:5120
    buffer_load_dwordx4 a[208:211], v252, s[8:11], s41 offen offset:0
    v_mfma_f32_16x16x32_bf16 v[104:107], v[208:211], a[152:155], v[104:107]
    buffer_load_dwordx4 a[212:215], v252, s[8:11], s41 offen offset:1024
    buffer_load_dwordx4 a[216:219], v253, s[8:11], s41 offen offset:0
    v_mfma_f32_16x16x32_bf16 v[108:111], v[208:211], a[156:159], v[108:111]
    buffer_load_dwordx4 a[220:223], v253, s[8:11], s41 offen offset:1024
    v_mfma_f32_16x16x32_bf16 v[112:115], v[212:215], a[144:147], v[112:115]
    v_mfma_f32_16x16x32_bf16 v[116:119], v[212:215], a[148:151], v[116:119]
    v_mfma_f32_16x16x32_bf16 v[120:123], v[212:215], a[152:155], v[120:123]
    v_mfma_f32_16x16x32_bf16 v[124:127], v[212:215], a[156:159], v[124:127]
    s_waitcnt lgkmcnt(2)
    s_waitcnt vmcnt(17)
    v_mfma_f32_16x16x32_bf16 v[32:35], v[192:195], a[160:163], v[32:35]
    ds_read_b128 v[208:211], v249 offset:8192
    v_add_f32 v160, v160, v162
    v_mfma_f32_16x16x32_bf16 v[36:39], v[192:195], a[164:167], v[36:39]
    ds_read_b128 v[212:215], v249 offset:9216
    s_waitcnt vmcnt(15)
    v_mfma_f32_16x16x32_bf16 v[40:43], v[192:195], a[168:171], v[40:43]
    s_add_u32 m0, s31, 4096
    s_add_u32 s40, s44, 28672
    buffer_load_dwordx4 v250, s[12:15], s40 offen lds
    v_mfma_f32_16x16x32_bf16 v[44:47], v[192:195], a[172:175], v[44:47]
    s_add_u32 m0, s31, 8192
    s_add_u32 s40, s44, 65536
    buffer_load_dwordx4 v250, s[12:15], s40 offen lds
    v_mfma_f32_16x16x32_bf16 v[48:51], v[196:199], a[160:163], v[48:51]
    s_add_u32 m0, s31, 12288
    s_add_u32 s40, s44, 102400
    buffer_load_dwordx4 v250, s[12:15], s40 offen lds
    v_mfma_f32_16x16x32_bf16 v[52:55], v[196:199], a[164:167], v[52:55]
    v_add_f32 v161, v161, v163
    v_mov_b32 v162, v160
    v_mfma_f32_16x16x32_bf16 v[56:59], v[196:199], a[168:171], v[56:59]
    v_mov_b32 v163, v161
    s_nop 0
    v_mfma_f32_16x16x32_bf16 v[60:63], v[196:199], a[172:175], v[60:63]
    v_permlane16_swap_b32 v160, v162
    s_waitcnt lgkmcnt(2)
    v_mfma_f32_16x16x32_bf16 v[64:67], v[200:203], a[160:163], v[64:67]
    ds_read_b128 v[192:195], v249 offset:2048
    v_permlane16_swap_b32 v161, v163
    v_mfma_f32_16x16x32_bf16 v[68:71], v[200:203], a[164:167], v[68:71]
    ds_read_b128 v[196:199], v249 offset:3072
    v_add_f32 v160, v160, v162
    v_mfma_f32_16x16x32_bf16 v[72:75], v[200:203], a[168:171], v[72:75]
    v_add_f32 v161, v161, v163
    v_mov_b32 v162, v160
    v_mfma_f32_16x16x32_bf16 v[76:79], v[200:203], a[172:175], v[76:79]
    v_mov_b32 v163, v161
    s_nop 0
    v_mfma_f32_16x16x32_bf16 v[80:83], v[204:207], a[160:163], v[80:83]
    v_permlane32_swap_b32 v160, v162
    v_permlane32_swap_b32 v161, v163
    v_mfma_f32_16x16x32_bf16 v[84:87], v[204:207], a[164:167], v[84:87]
    v_add_f32 v160, v160, v162
    v_add_f32 v161, v161, v163
    v_mfma_f32_16x16x32_bf16 v[88:91], v[204:207], a[168:171], v[88:91]
    v_add_f32 v164, v164, v166
    v_add_f32 v165, v165, v167
    v_mfma_f32_16x16x32_bf16 v[92:95], v[204:207], a[172:175], v[92:95]
    v_mov_b32 v166, v164
    s_waitcnt lgkmcnt(2)
    v_mfma_f32_16x16x32_bf16 v[96:99], v[208:211], a[160:163], v[96:99]
    ds_read_b128 v[200:203], v249 offset:6144
    s_mov_b32 s41, 57344
    v_mfma_f32_16x16x32_bf16 v[100:103], v[208:211], a[164:167], v[100:103]
    ds_read_b128 v[204:207], v249 offset:7168
    buffer_load_dwordx4 a[224:227], v252, s[8:11], s41 offen offset:0
    v_mfma_f32_16x16x32_bf16 v[104:107], v[208:211], a[168:171], v[104:107]
    buffer_load_dwordx4 a[228:231], v252, s[8:11], s41 offen offset:1024
    buffer_load_dwordx4 a[232:235], v253, s[8:11], s41 offen offset:0
    v_mfma_f32_16x16x32_bf16 v[108:111], v[208:211], a[172:175], v[108:111]
    buffer_load_dwordx4 a[236:239], v253, s[8:11], s41 offen offset:1024
    v_mov_b32 v167, v165
    v_mfma_f32_16x16x32_bf16 v[112:115], v[212:215], a[160:163], v[112:115]
    s_nop 0
    v_permlane16_swap_b32 v164, v166
    v_mfma_f32_16x16x32_bf16 v[116:119], v[212:215], a[164:167], v[116:119]
    v_permlane16_swap_b32 v165, v167
    v_add_f32 v164, v164, v166
    v_mfma_f32_16x16x32_bf16 v[120:123], v[212:215], a[168:171], v[120:123]
    v_add_f32 v165, v165, v167
    v_mov_b32 v166, v164
    v_mfma_f32_16x16x32_bf16 v[124:127], v[212:215], a[172:175], v[124:127]
    v_mov_b32 v167, v165
    s_waitcnt lgkmcnt(2)
    s_waitcnt vmcnt(20)
    v_mfma_f32_16x16x32_bf16 v[32:35], v[192:195], a[176:179], v[32:35]
    ds_read_b128 v[208:211], v249 offset:10240
    s_nop 0
    v_mfma_f32_16x16x32_bf16 v[36:39], v[192:195], a[180:183], v[36:39]
    ds_read_b128 v[212:215], v249 offset:11264
    s_waitcnt vmcnt(18)
    v_mfma_f32_16x16x32_bf16 v[40:43], v[192:195], a[184:187], v[40:43]
    v_permlane32_swap_b32 v164, v166
    v_permlane32_swap_b32 v165, v167
    v_mfma_f32_16x16x32_bf16 v[44:47], v[192:195], a[188:191], v[44:47]
    v_add_f32 v164, v164, v166
    v_add_f32 v165, v165, v167
    v_mfma_f32_16x16x32_bf16 v[48:51], v[196:199], a[176:179], v[48:51]
    v_add_f32 v168, v168, v170
    v_add_f32 v169, v169, v171
    v_mfma_f32_16x16x32_bf16 v[52:55], v[196:199], a[180:183], v[52:55]
    v_mov_b32 v170, v168
    v_mov_b32 v171, v169
    v_mfma_f32_16x16x32_bf16 v[56:59], v[196:199], a[184:187], v[56:59]
    s_nop 0
    v_permlane16_swap_b32 v168, v170
    v_mfma_f32_16x16x32_bf16 v[60:63], v[196:199], a[188:191], v[60:63]
    v_permlane16_swap_b32 v169, v171
    s_waitcnt lgkmcnt(2)
    v_mfma_f32_16x16x32_bf16 v[64:67], v[200:203], a[176:179], v[64:67]
    s_waitcnt vmcnt(15)
    s_barrier
    v_mfma_f32_16x16x32_bf16 v[68:71], v[200:203], a[180:183], v[68:71]
    ds_read_b128 v[192:195], v249 offset:12288
    v_add_f32 v168, v168, v170
    v_mfma_f32_16x16x32_bf16 v[72:75], v[200:203], a[184:187], v[72:75]
    ds_read_b128 v[196:199], v249 offset:13312
    v_add_f32 v169, v169, v171
    v_mfma_f32_16x16x32_bf16 v[76:79], v[200:203], a[188:191], v[76:79]
    v_mov_b32 v170, v168
    v_mov_b32 v171, v169
    v_mfma_f32_16x16x32_bf16 v[80:83], v[204:207], a[176:179], v[80:83]
    s_nop 0
    v_permlane32_swap_b32 v168, v170
    v_mfma_f32_16x16x32_bf16 v[84:87], v[204:207], a[180:183], v[84:87]
    v_permlane32_swap_b32 v169, v171
    v_add_f32 v168, v168, v170
    v_mfma_f32_16x16x32_bf16 v[88:91], v[204:207], a[184:187], v[88:91]
    v_add_f32 v169, v169, v171
    v_add_f32 v172, v172, v174
    v_mfma_f32_16x16x32_bf16 v[92:95], v[204:207], a[188:191], v[92:95]
    v_add_f32 v173, v173, v175
    s_waitcnt lgkmcnt(2)
    v_mfma_f32_16x16x32_bf16 v[96:99], v[208:211], a[176:179], v[96:99]
    ds_read_b128 v[200:203], v249 offset:16384
    s_mov_b32 s41, 61440
    v_mfma_f32_16x16x32_bf16 v[100:103], v[208:211], a[180:183], v[100:103]
    ds_read_b128 v[204:207], v249 offset:17408
    buffer_load_dwordx4 a[240:243], v252, s[8:11], s41 offen offset:0
    v_mfma_f32_16x16x32_bf16 v[104:107], v[208:211], a[184:187], v[104:107]
    buffer_load_dwordx4 a[244:247], v252, s[8:11], s41 offen offset:1024
    buffer_load_dwordx4 a[248:251], v253, s[8:11], s41 offen offset:0
    v_mfma_f32_16x16x32_bf16 v[108:111], v[208:211], a[188:191], v[108:111]
    buffer_load_dwordx4 a[252:255], v253, s[8:11], s41 offen offset:1024
    v_mov_b32 v174, v172
    v_mfma_f32_16x16x32_bf16 v[112:115], v[212:215], a[176:179], v[112:115]
    v_mov_b32 v175, v173
    s_nop 0
    v_mfma_f32_16x16x32_bf16 v[116:119], v[212:215], a[180:183], v[116:119]
    v_permlane16_swap_b32 v172, v174
    v_permlane16_swap_b32 v173, v175
    v_mfma_f32_16x16x32_bf16 v[120:123], v[212:215], a[184:187], v[120:123]
    v_add_f32 v172, v172, v174
    v_add_f32 v173, v173, v175
    v_mfma_f32_16x16x32_bf16 v[124:127], v[212:215], a[188:191], v[124:127]
    v_mov_b32 v174, v172
    s_waitcnt lgkmcnt(2)
    s_waitcnt vmcnt(17)
    v_mfma_f32_16x16x32_bf16 v[32:35], v[192:195], a[192:195], v[32:35]
    ds_read_b128 v[208:211], v249 offset:20480
    v_mov_b32 v175, v173
    v_mfma_f32_16x16x32_bf16 v[36:39], v[192:195], a[196:199], v[36:39]
    ds_read_b128 v[212:215], v249 offset:21504
    s_waitcnt vmcnt(15)
    v_mfma_f32_16x16x32_bf16 v[40:43], v[192:195], a[200:203], v[40:43]
    s_add_u32 m0, s31, 16384
    s_add_u32 s40, s44, 32768
    buffer_load_dwordx4 v250, s[12:15], s40 offen lds
    v_mfma_f32_16x16x32_bf16 v[44:47], v[192:195], a[204:207], v[44:47]
    s_add_u32 m0, s31, 20480
    s_add_u32 s40, s44, 69632
    buffer_load_dwordx4 v250, s[12:15], s40 offen lds
    v_mfma_f32_16x16x32_bf16 v[48:51], v[196:199], a[192:195], v[48:51]
    s_add_u32 m0, s31, 24576
    s_add_u32 s40, s44, 106496
    buffer_load_dwordx4 v250, s[12:15], s40 offen lds
    v_mfma_f32_16x16x32_bf16 v[52:55], v[196:199], a[196:199], v[52:55]
    s_nop 0
    v_permlane32_swap_b32 v172, v174
    v_mfma_f32_16x16x32_bf16 v[56:59], v[196:199], a[200:203], v[56:59]
    v_permlane32_swap_b32 v173, v175
    v_add_f32 v172, v172, v174
    v_mfma_f32_16x16x32_bf16 v[60:63], v[196:199], a[204:207], v[60:63]
    v_add_f32 v173, v173, v175
    s_waitcnt lgkmcnt(2)
    v_mfma_f32_16x16x32_bf16 v[64:67], v[200:203], a[192:195], v[64:67]
    ds_read_b128 v[192:195], v249 offset:14336
    v_mul_f32 v160, 0x3ae38e39, v160
    v_mfma_f32_16x16x32_bf16 v[68:71], v[200:203], a[196:199], v[68:71]
    ds_read_b128 v[196:199], v249 offset:15360
    v_mul_f32 v161, 0x3ae38e39, v161
    v_mfma_f32_16x16x32_bf16 v[72:75], v[200:203], a[200:203], v[72:75]
    v_fma_f32 v161, -v160, v160, v161
    v_max_f32 v161, 0, v161
    v_mfma_f32_16x16x32_bf16 v[76:79], v[200:203], a[204:207], v[76:79]
    v_cvt_pk_bf16_f32 v178, v160, v161
    v_lshlrev_b32 v160, 16, v178
    v_mfma_f32_16x16x32_bf16 v[80:83], v[204:207], a[192:195], v[80:83]
    v_and_b32 v161, 0xffff0000, v178
    v_sub_f32 v224, 0, v160
    v_mfma_f32_16x16x32_bf16 v[84:87], v[204:207], a[196:199], v[84:87]
    v_add_f32 v161, 0x3727c5ac, v161
    v_cvt_pk_bf16_f32 v161, v161, v161
    v_mfma_f32_16x16x32_bf16 v[88:91], v[204:207], a[200:203], v[88:91]
    v_lshlrev_b32 v161, 16, v161
    v_mfma_f32_16x16x32_bf16 v[92:95], v[204:207], a[204:207], v[92:95]
    s_waitcnt lgkmcnt(2)
    v_mfma_f32_16x16x32_bf16 v[96:99], v[208:211], a[192:195], v[96:99]
    ds_read_b128 v[200:203], v249 offset:18432
    s_mov_b32 s41, 65536
    v_mfma_f32_16x16x32_bf16 v[100:103], v[208:211], a[196:199], v[100:103]
    ds_read_b128 v[204:207], v249 offset:19456
    buffer_load_dwordx4 v[0:3], v252, s[8:11], s41 offen offset:0
    v_mfma_f32_16x16x32_bf16 v[104:107], v[208:211], a[200:203], v[104:107]
    buffer_load_dwordx4 v[4:7], v252, s[8:11], s41 offen offset:1024
    buffer_load_dwordx4 v[8:11], v253, s[8:11], s41 offen offset:0
    v_mfma_f32_16x16x32_bf16 v[108:111], v[208:211], a[204:207], v[108:111]
    buffer_load_dwordx4 v[12:15], v253, s[8:11], s41 offen offset:1024
    v_mfma_f32_16x16x32_bf16 v[112:115], v[212:215], a[192:195], v[112:115]
    v_sqrt_f32 v161, v161
    v_mfma_f32_16x16x32_bf16 v[116:119], v[212:215], a[196:199], v[116:119]
    v_cvt_pk_bf16_f32 v161, v161, v161
    v_lshlrev_b32 v161, 16, v161
    v_mfma_f32_16x16x32_bf16 v[120:123], v[212:215], a[200:203], v[120:123]
    v_rcp_f32 v161, v161
    v_mfma_f32_16x16x32_bf16 v[124:127], v[212:215], a[204:207], v[124:127]
    v_mul_f32 v228, 0xbfb8aa3b, v161
    s_waitcnt lgkmcnt(2)
    s_waitcnt vmcnt(20)
    v_mfma_f32_16x16x32_bf16 v[32:35], v[192:195], a[208:211], v[32:35]
    ds_read_b128 v[208:211], v249 offset:22528
    v_mul_f32 v164, 0x3ae38e39, v164
    v_mfma_f32_16x16x32_bf16 v[36:39], v[192:195], a[212:215], v[36:39]
    ds_read_b128 v[212:215], v249 offset:23552
    s_waitcnt vmcnt(18)
    v_mfma_f32_16x16x32_bf16 v[40:43], v[192:195], a[216:219], v[40:43]
    v_mul_f32 v165, 0x3ae38e39, v165
    v_fma_f32 v165, -v164, v164, v165
    v_mfma_f32_16x16x32_bf16 v[44:47], v[192:195], a[220:223], v[44:47]
    v_max_f32 v165, 0, v165
    v_cvt_pk_bf16_f32 v179, v164, v165
    v_mfma_f32_16x16x32_bf16 v[48:51], v[196:199], a[208:211], v[48:51]
    v_lshlrev_b32 v164, 16, v179
    v_and_b32 v165, 0xffff0000, v179
    v_mfma_f32_16x16x32_bf16 v[52:55], v[196:199], a[212:215], v[52:55]
    v_sub_f32 v225, 0, v164
    v_add_f32 v165, 0x3727c5ac, v165
    v_mfma_f32_16x16x32_bf16 v[56:59], v[196:199], a[216:219], v[56:59]
    v_cvt_pk_bf16_f32 v165, v165, v165
    v_lshlrev_b32 v165, 16, v165
    v_mfma_f32_16x16x32_bf16 v[60:63], v[196:199], a[220:223], v[60:63]
    s_waitcnt lgkmcnt(2)
    v_mfma_f32_16x16x32_bf16 v[64:67], v[200:203], a[208:211], v[64:67]
    s_waitcnt vmcnt(15)
    s_barrier
    v_mfma_f32_16x16x32_bf16 v[68:71], v[200:203], a[212:215], v[68:71]
    ds_read_b128 v[192:195], v248 offset:4096
    v_mfma_f32_16x16x32_bf16 v[72:75], v[200:203], a[216:219], v[72:75]
    ds_read_b128 v[196:199], v248 offset:5120
    v_mfma_f32_16x16x32_bf16 v[76:79], v[200:203], a[220:223], v[76:79]
    v_sqrt_f32 v165, v165
    v_mfma_f32_16x16x32_bf16 v[80:83], v[204:207], a[208:211], v[80:83]
    v_cvt_pk_bf16_f32 v165, v165, v165
    v_lshlrev_b32 v165, 16, v165
    v_mfma_f32_16x16x32_bf16 v[84:87], v[204:207], a[212:215], v[84:87]
    v_rcp_f32 v165, v165
    v_mfma_f32_16x16x32_bf16 v[88:91], v[204:207], a[216:219], v[88:91]
    v_mul_f32 v229, 0xbfb8aa3b, v165
    v_mul_f32 v168, 0x3ae38e39, v168
    v_mfma_f32_16x16x32_bf16 v[92:95], v[204:207], a[220:223], v[92:95]
    v_mul_f32 v169, 0x3ae38e39, v169
    s_waitcnt lgkmcnt(2)
    v_mfma_f32_16x16x32_bf16 v[96:99], v[208:211], a[208:211], v[96:99]
    ds_read_b128 v[200:203], v248 offset:8192
    s_mov_b32 s41, 69632
    v_mfma_f32_16x16x32_bf16 v[100:103], v[208:211], a[212:215], v[100:103]
    ds_read_b128 v[204:207], v248 offset:9216
    buffer_load_dwordx4 v[16:19], v252, s[8:11], s41 offen offset:0
    v_mfma_f32_16x16x32_bf16 v[104:107], v[208:211], a[216:219], v[104:107]
    buffer_load_dwordx4 v[20:23], v252, s[8:11], s41 offen offset:1024
    buffer_load_dwordx4 v[24:27], v253, s[8:11], s41 offen offset:0
    v_mfma_f32_16x16x32_bf16 v[108:111], v[208:211], a[220:223], v[108:111]
    buffer_load_dwordx4 v[28:31], v253, s[8:11], s41 offen offset:1024
    v_fma_f32 v169, -v168, v168, v169
    v_mfma_f32_16x16x32_bf16 v[112:115], v[212:215], a[208:211], v[112:115]
    s_add_u32 m0, s31, 28672
    s_add_u32 s40, s44, 110592
    buffer_load_dwordx4 v250, s[12:15], s40 offen lds
    v_mfma_f32_16x16x32_bf16 v[116:119], v[212:215], a[212:215], v[116:119]
    s_add_u32 m0, s31, 32768
    s_add_u32 s40, s44, 114688
    buffer_load_dwordx4 v250, s[12:15], s40 offen lds
    v_mfma_f32_16x16x32_bf16 v[120:123], v[212:215], a[216:219], v[120:123]
    s_add_u32 m0, s31, 36864
    s_add_u32 s40, s44, 118784
    buffer_load_dwordx4 v250, s[12:15], s40 offen lds
    v_mfma_f32_16x16x32_bf16 v[124:127], v[212:215], a[220:223], v[124:127]
    v_max_f32 v169, 0, v169
    s_waitcnt lgkmcnt(2)
    s_waitcnt vmcnt(20)
    v_mfma_f32_16x16x32_bf16 v[32:35], v[192:195], a[224:227], v[32:35]
    ds_read_b128 v[208:211], v248 offset:12288
    v_cvt_pk_bf16_f32 v178, v168, v169
    v_mfma_f32_16x16x32_bf16 v[36:39], v[192:195], a[228:231], v[36:39]
    ds_read_b128 v[212:215], v248 offset:13312
    s_waitcnt vmcnt(18)
    v_mfma_f32_16x16x32_bf16 v[40:43], v[192:195], a[232:235], v[40:43]
    s_add_u32 m0, s31, 40960
    s_add_u32 s40, s44, 122880
    buffer_load_dwordx4 v250, s[12:15], s40 offen lds
    v_mfma_f32_16x16x32_bf16 v[44:47], v[192:195], a[236:239], v[44:47]
    s_add_u32 m0, s31, 45056
    s_add_u32 s40, s44, 126976
    buffer_load_dwordx4 v250, s[12:15], s40 offen lds
    v_mfma_f32_16x16x32_bf16 v[48:51], v[196:199], a[224:227], v[48:51]
    s_add_u32 m0, s31, 49152
    s_add_u32 s40, s44, 131072
    buffer_load_dwordx4 v250, s[12:15], s40 offen lds
    v_mfma_f32_16x16x32_bf16 v[52:55], v[196:199], a[228:231], v[52:55]
    s_add_u32 m0, s31, 53248
    s_add_u32 s40, s44, 135168
    buffer_load_dwordx4 v250, s[12:15], s40 offen lds
    v_mfma_f32_16x16x32_bf16 v[56:59], v[196:199], a[232:235], v[56:59]
    s_add_u32 m0, s31, 57344
    s_add_u32 s40, s44, 139264
    buffer_load_dwordx4 v250, s[12:15], s40 offen lds
    v_mfma_f32_16x16x32_bf16 v[60:63], v[196:199], a[236:239], v[60:63]
    v_lshlrev_b32 v168, 16, v178
    s_waitcnt lgkmcnt(2)
    v_mfma_f32_16x16x32_bf16 v[64:67], v[200:203], a[224:227], v[64:67]
    ds_read_b128 v[192:195], v248 offset:6144
    v_and_b32 v169, 0xffff0000, v178
    v_mfma_f32_16x16x32_bf16 v[68:71], v[200:203], a[228:231], v[68:71]
    ds_read_b128 v[196:199], v248 offset:7168
    v_sub_f32 v226, 0, v168
    v_mfma_f32_16x16x32_bf16 v[72:75], v[200:203], a[232:235], v[72:75]
    s_add_u32 m0, s31, 61440
    s_add_u32 s40, s44, 143360
    buffer_load_dwordx4 v250, s[12:15], s40 offen lds
    v_mfma_f32_16x16x32_bf16 v[76:79], v[200:203], a[236:239], v[76:79]
    s_add_u32 m0, s31, 65536
    s_add_u32 s40, s44, 147456
    buffer_load_dwordx4 v250, s[12:15], s40 offen lds
    v_mfma_f32_16x16x32_bf16 v[80:83], v[204:207], a[224:227], v[80:83]
    s_add_u32 m0, s31, 69632
    s_add_u32 s40, s44, 151552
    buffer_load_dwordx4 v250, s[12:15], s40 offen lds
    v_mfma_f32_16x16x32_bf16 v[84:87], v[204:207], a[228:231], v[84:87]
    s_add_u32 m0, s31, 73728
    s_add_u32 s40, s44, 155648
    buffer_load_dwordx4 v250, s[12:15], s40 offen lds
    v_mfma_f32_16x16x32_bf16 v[88:91], v[204:207], a[232:235], v[88:91]
    v_add_f32 v169, 0x3727c5ac, v169
    v_cvt_pk_bf16_f32 v169, v169, v169
    v_mfma_f32_16x16x32_bf16 v[92:95], v[204:207], a[236:239], v[92:95]
    v_lshlrev_b32 v169, 16, v169
    s_waitcnt lgkmcnt(2)
    v_mfma_f32_16x16x32_bf16 v[96:99], v[208:211], a[224:227], v[96:99]
    ds_read_b128 v[200:203], v248 offset:10240
    v_mfma_f32_16x16x32_bf16 v[100:103], v[208:211], a[228:231], v[100:103]
    ds_read_b128 v[204:207], v248 offset:11264
    v_mfma_f32_16x16x32_bf16 v[104:107], v[208:211], a[232:235], v[104:107]
    v_sqrt_f32 v169, v169
    v_mfma_f32_16x16x32_bf16 v[108:111], v[208:211], a[236:239], v[108:111]
    v_cvt_pk_bf16_f32 v169, v169, v169
    v_lshlrev_b32 v169, 16, v169
    v_mfma_f32_16x16x32_bf16 v[112:115], v[212:215], a[224:227], v[112:115]
    v_rcp_f32 v169, v169
    v_mfma_f32_16x16x32_bf16 v[116:119], v[212:215], a[228:231], v[116:119]
    v_mul_f32 v230, 0xbfb8aa3b, v169
    v_mul_f32 v172, 0x3ae38e39, v172
    v_mfma_f32_16x16x32_bf16 v[120:123], v[212:215], a[232:235], v[120:123]
    v_mul_f32 v173, 0x3ae38e39, v173
    v_fma_f32 v173, -v172, v172, v173
    v_mfma_f32_16x16x32_bf16 v[124:127], v[212:215], a[236:239], v[124:127]
    v_max_f32 v173, 0, v173
    s_waitcnt lgkmcnt(2)
    s_waitcnt vmcnt(25)
    v_mfma_f32_16x16x32_bf16 v[32:35], v[192:195], a[240:243], v[32:35]
    ds_read_b128 v[208:211], v248 offset:14336
    v_cvt_pk_bf16_f32 v179, v172, v173
    v_mfma_f32_16x16x32_bf16 v[36:39], v[192:195], a[244:247], v[36:39]
    ds_read_b128 v[212:215], v248 offset:15360
    s_waitcnt vmcnt(23)
    v_mfma_f32_16x16x32_bf16 v[40:43], v[192:195], a[248:251], v[40:43]
    v_lshlrev_b32 v172, 16, v179
    v_and_b32 v173, 0xffff0000, v179
    v_mfma_f32_16x16x32_bf16 v[44:47], v[192:195], a[252:255], v[44:47]
    v_sub_f32 v227, 0, v172
    v_add_f32 v173, 0x3727c5ac, v173
    v_mfma_f32_16x16x32_bf16 v[48:51], v[196:199], a[240:243], v[48:51]
    v_cvt_pk_bf16_f32 v173, v173, v173
    v_lshlrev_b32 v173, 16, v173
    v_mfma_f32_16x16x32_bf16 v[52:55], v[196:199], a[244:247], v[52:55]
    v_sqrt_f32 v173, v173
    v_mfma_f32_16x16x32_bf16 v[56:59], v[196:199], a[248:251], v[56:59]
    v_cvt_pk_bf16_f32 v173, v173, v173
    v_lshlrev_b32 v173, 16, v173
    v_mfma_f32_16x16x32_bf16 v[60:63], v[196:199], a[252:255], v[60:63]
    s_waitcnt lgkmcnt(2)
    v_mfma_f32_16x16x32_bf16 v[64:67], v[200:203], a[240:243], v[64:67]
    s_waitcnt vmcnt(20)
    s_barrier
    v_mfma_f32_16x16x32_bf16 v[68:71], v[200:203], a[244:247], v[68:71]
    ds_read_b128 v[192:195], v248 offset:16384
    v_mfma_f32_16x16x32_bf16 v[72:75], v[200:203], a[248:251], v[72:75]
    ds_read_b128 v[196:199], v248 offset:17408
    v_mfma_f32_16x16x32_bf16 v[76:79], v[200:203], a[252:255], v[76:79]
    s_add_u32 m0, s31, 77824
    s_add_u32 s40, s44, 159744
    buffer_load_dwordx4 v250, s[12:15], s40 offen lds
    v_mfma_f32_16x16x32_bf16 v[80:83], v[204:207], a[240:243], v[80:83]
    s_add_u32 m0, s31, 81920
    s_add_u32 s40, s44, 163840
    buffer_load_dwordx4 v250, s[12:15], s40 offen lds
    v_mfma_f32_16x16x32_bf16 v[84:87], v[204:207], a[244:247], v[84:87]
    s_add_u32 m0, s31, 86016
    s_add_u32 s40, s44, 167936
    buffer_load_dwordx4 v250, s[12:15], s40 offen lds
    v_mfma_f32_16x16x32_bf16 v[88:91], v[204:207], a[248:251], v[88:91]
    v_rcp_f32 v173, v173
    v_mfma_f32_16x16x32_bf16 v[92:95], v[204:207], a[252:255], v[92:95]
    v_mul_f32 v231, 0xbfb8aa3b, v173
    s_waitcnt lgkmcnt(2)
    v_mfma_f32_16x16x32_bf16 v[96:99], v[208:211], a[240:243], v[96:99]
    ds_read_b128 v[200:203], v248 offset:20480
    v_mfma_f32_16x16x32_bf16 v[100:103], v[208:211], a[244:247], v[100:103]
    ds_read_b128 v[204:207], v248 offset:21504
    v_mfma_f32_16x16x32_bf16 v[104:107], v[208:211], a[248:251], v[104:107]
    v_lshrrev_b32 v190, 8, v248
    v_bfe_u32 v191, v248, 6, 2
    v_mfma_f32_16x16x32_bf16 v[108:111], v[208:211], a[252:255], v[108:111]
    v_mfma_f32_16x16x32_bf16 v[112:115], v[212:215], a[240:243], v[112:115]
    v_mfma_f32_16x16x32_bf16 v[116:119], v[212:215], a[244:247], v[116:119]
    v_lshl_add_u32 v190, v190, 3, v191
    v_mul_u32_u24 v190, 1152, v190
    v_mfma_f32_16x16x32_bf16 v[120:123], v[212:215], a[248:251], v[120:123]
    v_mfma_f32_16x16x32_bf16 v[124:127], v[212:215], a[252:255], v[124:127]
    s_waitcnt lgkmcnt(2)
    s_waitcnt vmcnt(21)
    v_mfma_f32_16x16x32_bf16 v[32:35], v[192:195], v[0:3], v[32:35]
    ds_read_b128 v[208:211], v248 offset:24576
    v_add_u32 v190, s101, v190
    v_mfma_f32_16x16x32_bf16 v[36:39], v[192:195], v[4:7], v[36:39]
    ds_read_b128 v[212:215], v248 offset:25600
    s_waitcnt vmcnt(19)
    v_mfma_f32_16x16x32_bf16 v[40:43], v[192:195], v[8:11], v[40:43]
    v_mfma_f32_16x16x32_bf16 v[44:47], v[192:195], v[12:15], v[44:47]
    v_bfe_u32 v191, v248, 4, 2
    v_lshl_add_u32 v188, v191, 4, v190
    v_mfma_f32_16x16x32_bf16 v[48:51], v[196:199], v[0:3], v[48:51]
    v_mfma_f32_16x16x32_bf16 v[52:55], v[196:199], v[4:7], v[52:55]
    v_mfma_f32_16x16x32_bf16 v[56:59], v[196:199], v[8:11], v[56:59]
    v_lshl_add_u32 v189, v191, 3, v190
    v_mfma_f32_16x16x32_bf16 v[60:63], v[196:199], v[12:15], v[60:63]
    s_waitcnt lgkmcnt(2)
    v_mfma_f32_16x16x32_bf16 v[64:67], v[200:203], v[0:3], v[64:67]
    ds_read_b128 v[192:195], v248 offset:18432
    v_mfma_f32_16x16x32_bf16 v[68:71], v[200:203], v[4:7], v[68:71]
    ds_read_b128 v[196:199], v248 offset:19456
    v_mfma_f32_16x16x32_bf16 v[72:75], v[200:203], v[8:11], v[72:75]
    v_mfma_f32_16x16x32_bf16 v[76:79], v[200:203], v[12:15], v[76:79]
    v_mfma_f32_16x16x32_bf16 v[80:83], v[204:207], v[0:3], v[80:83]
    v_mfma_f32_16x16x32_bf16 v[84:87], v[204:207], v[4:7], v[84:87]
    v_mfma_f32_16x16x32_bf16 v[88:91], v[204:207], v[8:11], v[88:91]
    v_mfma_f32_16x16x32_bf16 v[92:95], v[204:207], v[12:15], v[92:95]
    s_waitcnt lgkmcnt(2)
    v_mfma_f32_16x16x32_bf16 v[96:99], v[208:211], v[0:3], v[96:99]
    ds_read_b128 v[200:203], v248 offset:22528
    v_mfma_f32_16x16x32_bf16 v[100:103], v[208:211], v[4:7], v[100:103]
    ds_read_b128 v[204:207], v248 offset:23552
    v_mfma_f32_16x16x32_bf16 v[104:107], v[208:211], v[8:11], v[104:107]
    v_mfma_f32_16x16x32_bf16 v[108:111], v[208:211], v[12:15], v[108:111]
    v_mfma_f32_16x16x32_bf16 v[112:115], v[212:215], v[0:3], v[112:115]
    v_mfma_f32_16x16x32_bf16 v[116:119], v[212:215], v[4:7], v[116:119]
    v_mfma_f32_16x16x32_bf16 v[120:123], v[212:215], v[8:11], v[120:123]
    v_mfma_f32_16x16x32_bf16 v[124:127], v[212:215], v[12:15], v[124:127]
    s_waitcnt lgkmcnt(2)
    s_waitcnt vmcnt(17)
    v_mfma_f32_16x16x32_bf16 v[32:35], v[192:195], v[16:19], v[32:35]
    ds_read_b128 v[208:211], v248 offset:26624
    v_mfma_f32_16x16x32_bf16 v[36:39], v[192:195], v[20:23], v[36:39]
    ds_read_b128 v[212:215], v248 offset:27648
    s_waitcnt vmcnt(15)
    v_mfma_f32_16x16x32_bf16 v[40:43], v[192:195], v[24:27], v[40:43]
    v_mfma_f32_16x16x32_bf16 v[44:47], v[192:195], v[28:31], v[44:47]
    v_mfma_f32_16x16x32_bf16 v[48:51], v[196:199], v[16:19], v[48:51]
    v_mfma_f32_16x16x32_bf16 v[52:55], v[196:199], v[20:23], v[52:55]
    v_mfma_f32_16x16x32_bf16 v[56:59], v[196:199], v[24:27], v[56:59]
    v_mfma_f32_16x16x32_bf16 v[60:63], v[196:199], v[28:31], v[60:63]
    s_waitcnt lgkmcnt(2)
    v_mfma_f32_16x16x32_bf16 v[64:67], v[200:203], v[16:19], v[64:67]
    s_waitcnt vmcnt(9)
    s_barrier
    v_mfma_f32_16x16x32_bf16 v[68:71], v[200:203], v[20:23], v[68:71]
    ds_read_b128 v[192:195], v248 offset:28672
    ds_read_b128 v[216:219], v251 offset:0
    v_mfma_f32_16x16x32_bf16 v[72:75], v[200:203], v[24:27], v[72:75]
    ds_read_b128 v[196:199], v248 offset:29696
    ds_read_b128 v[220:223], v251 offset:64
    v_mfma_f32_16x16x32_bf16 v[76:79], v[200:203], v[28:31], v[76:79]
    s_add_u32 m0, s31, 4096
    s_add_u32 s40, s44, 172032
    buffer_load_dwordx4 v250, s[12:15], s40 offen lds
    v_mfma_f32_16x16x32_bf16 v[80:83], v[204:207], v[16:19], v[80:83]
    s_add_u32 m0, s31, 8192
    s_add_u32 s40, s44, 176128
    buffer_load_dwordx4 v250, s[12:15], s40 offen lds
    v_mfma_f32_16x16x32_bf16 v[84:87], v[204:207], v[20:23], v[84:87]
    s_add_u32 m0, s31, 12288
    s_add_u32 s40, s44, 180224
    buffer_load_dwordx4 v250, s[12:15], s40 offen lds
    v_mfma_f32_16x16x32_bf16 v[88:91], v[204:207], v[24:27], v[88:91]
    s_waitcnt lgkmcnt(0)
    v_fmac_f32 v32, v224, v216
    v_mfma_f32_16x16x32_bf16 v[92:95], v[204:207], v[28:31], v[92:95]
    v_fmac_f32 v33, v224, v217
    v_mfma_f32_16x16x32_bf16 v[96:99], v[208:211], v[16:19], v[96:99]
    ds_read_b128 v[200:203], v248 offset:30720
    v_fmac_f32 v34, v224, v218
    v_mfma_f32_16x16x32_bf16 v[100:103], v[208:211], v[20:23], v[100:103]
    ds_read_b128 v[204:207], v248 offset:31744
    v_fmac_f32 v35, v224, v219
    v_mfma_f32_16x16x32_bf16 v[104:107], v[208:211], v[24:27], v[104:107]
    v_mul_f32 v32, v228, v32
    v_mul_f32 v33, v228, v33
    v_mfma_f32_16x16x32_bf16 v[108:111], v[208:211], v[28:31], v[108:111]
    v_mul_f32 v34, v228, v34
    v_mul_f32 v35, v228, v35
    v_mfma_f32_16x16x32_bf16 v[112:115], v[212:215], v[16:19], v[112:115]
    v_exp_f32 v32, v32
    v_mfma_f32_16x16x32_bf16 v[116:119], v[212:215], v[20:23], v[116:119]
    v_exp_f32 v33, v33
    v_mfma_f32_16x16x32_bf16 v[120:123], v[212:215], v[24:27], v[120:123]
    v_exp_f32 v34, v34
    v_mfma_f32_16x16x32_bf16 v[124:127], v[212:215], v[28:31], v[124:127]
    v_mfma_f32_16x16x32_bf16 v[128:131], v[192:195], a[0:3], 0
    ds_read_b128 v[208:211], v248 offset:32768
    v_mfma_f32_16x16x32_bf16 v[132:135], v[192:195], a[4:7], 0
    ds_read_b128 v[212:215], v248 offset:33792
    v_mfma_f32_16x16x32_bf16 v[136:139], v[192:195], a[8:11], 0
    v_exp_f32 v35, v35
    v_mfma_f32_16x16x32_bf16 v[140:143], v[192:195], a[12:15], 0
    v_fmac_f32 v48, v224, v220
    v_fmac_f32 v49, v224, v221
    v_mfma_f32_16x16x32_bf16 v[144:147], v[196:199], a[0:3], 0
    v_fmac_f32 v50, v224, v222
    v_fmac_f32 v51, v224, v223
    v_mfma_f32_16x16x32_bf16 v[148:151], v[196:199], a[4:7], 0
    v_add_f32 v32, 1.0, v32
    v_add_f32 v33, 1.0, v33
    v_mfma_f32_16x16x32_bf16 v[152:155], v[196:199], a[8:11], 0
    v_add_f32 v34, 1.0, v34
    v_add_f32 v35, 1.0, v35
    v_mfma_f32_16x16x32_bf16 v[156:159], v[196:199], a[12:15], 0
    s_waitcnt lgkmcnt(2)
    v_mfma_f32_16x16x32_bf16 v[128:131], v[200:203], a[16:19], v[128:131]
    ds_read_b128 v[192:195], v248 offset:34816
    v_mfma_f32_16x16x32_bf16 v[132:135], v[200:203], a[20:23], v[132:135]
    ds_read_b128 v[196:199], v248 offset:35840
    v_mfma_f32_16x16x32_bf16 v[136:139], v[200:203], a[24:27], v[136:139]
    v_rcp_f32 v32, v32
    v_mfma_f32_16x16x32_bf16 v[140:143], v[200:203], a[28:31], v[140:143]
    v_rcp_f32 v33, v33
    v_mfma_f32_16x16x32_bf16 v[144:147], v[204:207], a[16:19], v[144:147]
    v_rcp_f32 v34, v34
    v_mfma_f32_16x16x32_bf16 v[148:151], v[204:207], a[20:23], v[148:151]
    v_rcp_f32 v35, v35
    v_mfma_f32_16x16x32_bf16 v[152:155], v[204:207], a[24:27], v[152:155]
    v_mul_f32 v48, v48, v32
    v_mul_f32 v49, v49, v33
    v_mfma_f32_16x16x32_bf16 v[156:159], v[204:207], a[28:31], v[156:159]
    v_mul_f32 v50, v50, v34
    s_waitcnt lgkmcnt(2)
    v_mfma_f32_16x16x32_bf16 v[128:131], v[208:211], a[32:35], v[128:131]
    ds_read_b128 v[200:203], v248 offset:36864
    v_mul_f32 v51, v51, v35
    v_mfma_f32_16x16x32_bf16 v[132:135], v[208:211], a[36:39], v[132:135]
    ds_read_b128 v[204:207], v248 offset:37888
    v_cvt_pk_bf16_f32 v232, v48, v49
    v_mfma_f32_16x16x32_bf16 v[136:139], v[208:211], a[40:43], v[136:139]
    s_add_u32 m0, s31, 126976
    s_add_u32 s47, s56, 0
    buffer_load_dwordx4 v250, s[92:95], s47 offen lds
    v_mfma_f32_16x16x32_bf16 v[140:143], v[208:211], a[44:47], v[140:143]
    v_cvt_pk_bf16_f32 v233, v50, v51
    v_fmac_f32 v36, v225, v216
    v_mfma_f32_16x16x32_bf16 v[144:147], v[212:215], a[32:35], v[144:147]
    v_fmac_f32 v37, v225, v217
    v_fmac_f32 v38, v225, v218
    v_mfma_f32_16x16x32_bf16 v[148:151], v[212:215], a[36:39], v[148:151]
    s_add_u32 m0, s31, 131072
    s_add_u32 s47, s56, 4096
    buffer_load_dwordx4 v250, s[92:95], s47 offen lds
    v_mfma_f32_16x16x32_bf16 v[152:155], v[212:215], a[40:43], v[152:155]
    v_fmac_f32 v39, v225, v219
    v_mul_f32 v36, v229, v36
    v_mfma_f32_16x16x32_bf16 v[156:159], v[212:215], a[44:47], v[156:159]
    v_mul_f32 v37, v229, v37
    s_waitcnt lgkmcnt(2)
    v_mfma_f32_16x16x32_bf16 v[128:131], v[192:195], a[48:51], v[128:131]
    ds_read_b128 v[208:211], v248 offset:38912
    v_mul_f32 v38, v229, v38
    v_mfma_f32_16x16x32_bf16 v[132:135], v[192:195], a[52:55], v[132:135]
    ds_read_b128 v[212:215], v248 offset:39936
    v_mul_f32 v39, v229, v39
    v_mfma_f32_16x16x32_bf16 v[136:139], v[192:195], a[56:59], v[136:139]
    v_exp_f32 v36, v36
    v_mfma_f32_16x16x32_bf16 v[140:143], v[192:195], a[60:63], v[140:143]
    s_add_u32 m0, s31, 135168
    s_add_u32 s47, s56, 8192
    buffer_load_dwordx4 v250, s[92:95], s47 offen lds
    v_mfma_f32_16x16x32_bf16 v[144:147], v[196:199], a[48:51], v[144:147]
    v_exp_f32 v37, v37
    v_mfma_f32_16x16x32_bf16 v[148:151], v[196:199], a[52:55], v[148:151]
    v_exp_f32 v38, v38
    v_mfma_f32_16x16x32_bf16 v[152:155], v[196:199], a[56:59], v[152:155]
    s_add_u32 m0, s31, 139264
    s_add_u32 s47, s56, 12288
    buffer_load_dwordx4 v250, s[92:95], s47 offen lds
    v_mfma_f32_16x16x32_bf16 v[156:159], v[196:199], a[60:63], v[156:159]
    s_waitcnt lgkmcnt(2)
    v_mfma_f32_16x16x32_bf16 v[128:131], v[200:203], a[64:67], v[128:131]
    ds_read_b128 v[192:195], v248 offset:40960
    v_mfma_f32_16x16x32_bf16 v[132:135], v[200:203], a[68:71], v[132:135]
    ds_read_b128 v[196:199], v248 offset:41984
    v_mfma_f32_16x16x32_bf16 v[136:139], v[200:203], a[72:75], v[136:139]
    v_exp_f32 v39, v39
    v_mfma_f32_16x16x32_bf16 v[140:143], v[200:203], a[76:79], v[140:143]
    v_fmac_f32 v52, v225, v220
    v_fmac_f32 v53, v225, v221
    v_mfma_f32_16x16x32_bf16 v[144:147], v[204:207], a[64:67], v[144:147]
    s_add_u32 m0, s31, 143360
    s_add_u32 s47, s56, 16384
    buffer_load_dwordx4 v250, s[92:95], s47 offen lds
    v_mfma_f32_16x16x32_bf16 v[148:151], v[204:207], a[68:71], v[148:151]
    v_fmac_f32 v54, v225, v222
    v_fmac_f32 v55, v225, v223
    v_mfma_f32_16x16x32_bf16 v[152:155], v[204:207], a[72:75], v[152:155]
    v_add_f32 v36, 1.0, v36
    v_add_f32 v37, 1.0, v37
    v_mfma_f32_16x16x32_bf16 v[156:159], v[204:207], a[76:79], v[156:159]
    v_add_f32 v38, 1.0, v38
    s_waitcnt lgkmcnt(2)
    v_mfma_f32_16x16x32_bf16 v[128:131], v[208:211], a[80:83], v[128:131]
    ds_read_b128 v[200:203], v248 offset:43008
    v_add_f32 v39, 1.0, v39
    v_mfma_f32_16x16x32_bf16 v[132:135], v[208:211], a[84:87], v[132:135]
    ds_read_b128 v[204:207], v248 offset:44032
    v_mfma_f32_16x16x32_bf16 v[136:139], v[208:211], a[88:91], v[136:139]
    s_add_u32 m0, s31, 147456
    s_add_u32 s47, s56, 20480
    buffer_load_dwordx4 v250, s[92:95], s47 offen lds
    v_mfma_f32_16x16x32_bf16 v[140:143], v[208:211], a[92:95], v[140:143]
    v_rcp_f32 v36, v36
    v_mfma_f32_16x16x32_bf16 v[144:147], v[212:215], a[80:83], v[144:147]
    v_rcp_f32 v37, v37
    v_mfma_f32_16x16x32_bf16 v[148:151], v[212:215], a[84:87], v[148:151]
    s_add_u32 m0, s31, 151552
    s_add_u32 s47, s56, 24576
    buffer_load_dwordx4 v250, s[92:95], s47 offen lds
    v_mfma_f32_16x16x32_bf16 v[152:155], v[212:215], a[88:91], v[152:155]
    v_rcp_f32 v38, v38
    v_mfma_f32_16x16x32_bf16 v[156:159], v[212:215], a[92:95], v[156:159]
    s_waitcnt lgkmcnt(2)
    v_mfma_f32_16x16x32_bf16 v[128:131], v[192:195], a[96:99], v[128:131]
    ds_read_b128 v[208:211], v248 offset:45056
    v_mfma_f32_16x16x32_bf16 v[132:135], v[192:195], a[100:103], v[132:135]
    ds_read_b128 v[212:215], v248 offset:46080
    v_mfma_f32_16x16x32_bf16 v[136:139], v[192:195], a[104:107], v[136:139]
    v_rcp_f32 v39, v39
    v_mfma_f32_16x16x32_bf16 v[140:143], v[192:195], a[108:111], v[140:143]
    s_add_u32 m0, s31, 155648
    s_add_u32 s47, s56, 28672
    buffer_load_dwordx4 v250, s[92:95], s47 offen lds
    v_mfma_f32_16x16x32_bf16 v[144:147], v[196:199], a[96:99], v[144:147]
    v_mul_f32 v52, v52, v36
    v_mul_f32 v53, v53, v37
    v_mfma_f32_16x16x32_bf16 v[148:151], v[196:199], a[100:103], v[148:151]
    v_mul_f32 v54, v54, v38
    v_mul_f32 v55, v55, v39
    v_mfma_f32_16x16x32_bf16 v[152:155], v[196:199], a[104:107], v[152:155]
    s_add_u32 m0, s31, 159744
    s_add_u32 s47, s56, 32768
    buffer_load_dwordx4 v250, s[92:95], s47 offen lds
    v_mfma_f32_16x16x32_bf16 v[156:159], v[196:199], a[108:111], v[156:159]
    v_cvt_pk_bf16_f32 v236, v52, v53
    s_waitcnt lgkmcnt(2)
    v_mfma_f32_16x16x32_bf16 v[128:131], v[200:203], a[112:115], v[128:131]
    ds_read_b128 v[192:195], v248 offset:47104
    v_cvt_pk_bf16_f32 v237, v54, v55
    v_mfma_f32_16x16x32_bf16 v[132:135], v[200:203], a[116:119], v[132:135]
    ds_read_b128 v[196:199], v248 offset:48128
    v_fmac_f32 v40, v226, v216
    v_mfma_f32_16x16x32_bf16 v[136:139], v[200:203], a[120:123], v[136:139]
    v_fmac_f32 v41, v226, v217
    v_fmac_f32 v42, v226, v218
    v_mfma_f32_16x16x32_bf16 v[140:143], v[200:203], a[124:127], v[140:143]
    v_fmac_f32 v43, v226, v219
    v_mul_f32 v40, v230, v40
    v_mfma_f32_16x16x32_bf16 v[144:147], v[204:207], a[112:115], v[144:147]
    v_mul_f32 v41, v230, v41
    v_mul_f32 v42, v230, v42
    v_mfma_f32_16x16x32_bf16 v[148:151], v[204:207], a[116:119], v[148:151]
    v_mul_f32 v43, v230, v43
    v_mfma_f32_16x16x32_bf16 v[152:155], v[204:207], a[120:123], v[152:155]
    v_exp_f32 v40, v40
    v_mfma_f32_16x16x32_bf16 v[156:159], v[204:207], a[124:127], v[156:159]
    s_waitcnt lgkmcnt(2)
    v_mfma_f32_16x16x32_bf16 v[128:131], v[208:211], a[128:131], v[128:131]
    ds_read_b128 v[200:203], v248 offset:49152
    v_mfma_f32_16x16x32_bf16 v[132:135], v[208:211], a[132:135], v[132:135]
    ds_read_b128 v[204:207], v248 offset:50176
    v_mfma_f32_16x16x32_bf16 v[136:139], v[208:211], a[136:139], v[136:139]
    v_exp_f32 v41, v41
    v_mfma_f32_16x16x32_bf16 v[140:143], v[208:211], a[140:143], v[140:143]
    v_exp_f32 v42, v42
    v_mfma_f32_16x16x32_bf16 v[144:147], v[212:215], a[128:131], v[144:147]
    v_exp_f32 v43, v43
    v_mfma_f32_16x16x32_bf16 v[148:151], v[212:215], a[132:135], v[148:151]
    v_fmac_f32 v56, v226, v220
    v_fmac_f32 v57, v226, v221
    v_mfma_f32_16x16x32_bf16 v[152:155], v[212:215], a[136:139], v[152:155]
    v_fmac_f32 v58, v226, v222
    v_fmac_f32 v59, v226, v223
    v_mfma_f32_16x16x32_bf16 v[156:159], v[212:215], a[140:143], v[156:159]
    v_add_f32 v40, 1.0, v40
    s_waitcnt lgkmcnt(2)
    v_mfma_f32_16x16x32_bf16 v[128:131], v[192:195], a[144:147], v[128:131]
    ds_read_b128 v[208:211], v248 offset:51200
    v_add_f32 v41, 1.0, v41
    v_mfma_f32_16x16x32_bf16 v[132:135], v[192:195], a[148:151], v[132:135]
    ds_read_b128 v[212:215], v248 offset:52224
    v_add_f32 v42, 1.0, v42
    v_mfma_f32_16x16x32_bf16 v[136:139], v[192:195], a[152:155], v[136:139]
    v_add_f32 v43, 1.0, v43
    v_mfma_f32_16x16x32_bf16 v[140:143], v[192:195], a[156:159], v[140:143]
    v_rcp_f32 v40, v40
    v_mfma_f32_16x16x32_bf16 v[144:147], v[196:199], a[144:147], v[144:147]
    v_rcp_f32 v41, v41
    v_mfma_f32_16x16x32_bf16 v[148:151], v[196:199], a[148:151], v[148:151]
    v_rcp_f32 v42, v42
    v_mfma_f32_16x16x32_bf16 v[152:155], v[196:199], a[152:155], v[152:155]
    v_rcp_f32 v43, v43
    v_mfma_f32_16x16x32_bf16 v[156:159], v[196:199], a[156:159], v[156:159]
    v_mul_f32 v56, v56, v40
    s_waitcnt lgkmcnt(2)
    v_mfma_f32_16x16x32_bf16 v[128:131], v[200:203], a[160:163], v[128:131]
    s_waitcnt vmcnt(15)
    s_barrier
    v_mfma_f32_16x16x32_bf16 v[132:135], v[200:203], a[164:167], v[132:135]
    ds_read_b128 v[192:195], v248 offset:53248
    v_mul_f32 v57, v57, v41
    v_mfma_f32_16x16x32_bf16 v[136:139], v[200:203], a[168:171], v[136:139]
    ds_read_b128 v[196:199], v248 offset:54272
    v_mul_f32 v58, v58, v42
    v_mfma_f32_16x16x32_bf16 v[140:143], v[200:203], a[172:175], v[140:143]
    s_add_u32 m0, s31, 16384
    s_add_u32 s40, s44, 184320
    buffer_load_dwordx4 v250, s[12:15], s40 offen lds
    v_mfma_f32_16x16x32_bf16 v[144:147], v[204:207], a[160:163], v[144:147]
    s_add_u32 m0, s31, 20480
    s_add_u32 s40, s44, 188416
    buffer_load_dwordx4 v250, s[12:15], s40 offen lds
    v_mfma_f32_16x16x32_bf16 v[148:151], v[204:207], a[164:167], v[148:151]
    s_add_u32 m0, s31, 24576
    s_add_u32 s40, s44, 192512
    buffer_load_dwordx4 v250, s[12:15], s40 offen lds
    v_mfma_f32_16x16x32_bf16 v[152:155], v[204:207], a[168:171], v[152:155]
    v_mul_f32 v59, v59, v43
    v_cvt_pk_bf16_f32 v240, v56, v57
    v_mfma_f32_16x16x32_bf16 v[156:159], v[204:207], a[172:175], v[156:159]
    v_cvt_pk_bf16_f32 v241, v58, v59
    s_waitcnt lgkmcnt(2)
    v_mfma_f32_16x16x32_bf16 v[128:131], v[208:211], a[176:179], v[128:131]
    ds_read_b128 v[200:203], v248 offset:55296
    v_fmac_f32 v44, v227, v216
    v_mfma_f32_16x16x32_bf16 v[132:135], v[208:211], a[180:183], v[132:135]
    ds_read_b128 v[204:207], v248 offset:56320
    v_fmac_f32 v45, v227, v217
    v_mfma_f32_16x16x32_bf16 v[136:139], v[208:211], a[184:187], v[136:139]
    v_fmac_f32 v46, v227, v218
    v_fmac_f32 v47, v227, v219
    v_mfma_f32_16x16x32_bf16 v[140:143], v[208:211], a[188:191], v[140:143]
    v_mul_f32 v44, v231, v44
    v_mul_f32 v45, v231, v45
    v_mfma_f32_16x16x32_bf16 v[144:147], v[212:215], a[176:179], v[144:147]
    v_mul_f32 v46, v231, v46
    v_mul_f32 v47, v231, v47
    v_mfma_f32_16x16x32_bf16 v[148:151], v[212:215], a[180:183], v[148:151]
    v_exp_f32 v44, v44
    v_mfma_f32_16x16x32_bf16 v[152:155], v[212:215], a[184:187], v[152:155]
    v_exp_f32 v45, v45
    v_mfma_f32_16x16x32_bf16 v[156:159], v[212:215], a[188:191], v[156:159]
    s_waitcnt lgkmcnt(2)
    v_mfma_f32_16x16x32_bf16 v[128:131], v[192:195], a[192:195], v[128:131]
    ds_read_b128 v[208:211], v248 offset:57344
    v_mfma_f32_16x16x32_bf16 v[132:135], v[192:195], a[196:199], v[132:135]
    ds_read_b128 v[212:215], v248 offset:58368
    v_mfma_f32_16x16x32_bf16 v[136:139], v[192:195], a[200:203], v[136:139]
    v_exp_f32 v46, v46
    v_mfma_f32_16x16x32_bf16 v[140:143], v[192:195], a[204:207], v[140:143]
    v_exp_f32 v47, v47
    v_mfma_f32_16x16x32_bf16 v[144:147], v[196:199], a[192:195], v[144:147]
    v_fmac_f32 v60, v227, v220
    v_fmac_f32 v61, v227, v221
    v_mfma_f32_16x16x32_bf16 v[148:151], v[196:199], a[196:199], v[148:151]
    v_fmac_f32 v62, v227, v222
    v_fmac_f32 v63, v227, v223
    v_mfma_f32_16x16x32_bf16 v[152:155], v[196:199], a[200:203], v[152:155]
    v_add_f32 v44, 1.0, v44
    v_add_f32 v45, 1.0, v45
    v_mfma_f32_16x16x32_bf16 v[156:159], v[196:199], a[204:207], v[156:159]
    v_add_f32 v46, 1.0, v46
    s_waitcnt lgkmcnt(2)
    v_mfma_f32_16x16x32_bf16 v[128:131], v[200:203], a[208:211], v[128:131]
    ds_read_b128 v[192:195], v248 offset:59392
    v_add_f32 v47, 1.0, v47
    v_mfma_f32_16x16x32_bf16 v[132:135], v[200:203], a[212:215], v[132:135]
    ds_read_b128 v[196:199], v248 offset:60416
    v_mfma_f32_16x16x32_bf16 v[136:139], v[200:203], a[216:219], v[136:139]
    v_rcp_f32 v44, v44
    v_mfma_f32_16x16x32_bf16 v[140:143], v[200:203], a[220:223], v[140:143]
    v_rcp_f32 v45, v45
    v_mfma_f32_16x16x32_bf16 v[144:147], v[204:207], a[208:211], v[144:147]
    v_rcp_f32 v46, v46
    v_mfma_f32_16x16x32_bf16 v[148:151], v[204:207], a[212:215], v[148:151]
    v_rcp_f32 v47, v47
    v_mfma_f32_16x16x32_bf16 v[152:155], v[204:207], a[216:219], v[152:155]
    v_mul_f32 v60, v60, v44
    v_mul_f32 v61, v61, v45
    v_mfma_f32_16x16x32_bf16 v[156:159], v[204:207], a[220:223], v[156:159]
    v_mul_f32 v62, v62, v46
    s_waitcnt lgkmcnt(2)
    v_mfma_f32_16x16x32_bf16 v[128:131], v[208:211], a[224:227], v[128:131]
    ds_read_b128 v[200:203], v248 offset:61440
    v_mul_f32 v63, v63, v47
    v_mfma_f32_16x16x32_bf16 v[132:135], v[208:211], a[228:231], v[132:135]
    ds_read_b128 v[204:207], v248 offset:62464
    v_cvt_pk_bf16_f32 v244, v60, v61
    v_mfma_f32_16x16x32_bf16 v[136:139], v[208:211], a[232:235], v[136:139]
    v_cvt_pk_bf16_f32 v245, v62, v63
    ds_read_b128 v[216:219], v251 offset:128
    v_mfma_f32_16x16x32_bf16 v[140:143], v[208:211], a[236:239], v[140:143]
    ds_read_b128 v[220:223], v251 offset:192
    s_waitcnt lgkmcnt(0)
    v_mfma_f32_16x16x32_bf16 v[144:147], v[212:215], a[224:227], v[144:147]
    v_fmac_f32 v64, v224, v216
    v_fmac_f32 v65, v224, v217
    v_mfma_f32_16x16x32_bf16 v[148:151], v[212:215], a[228:231], v[148:151]
    v_fmac_f32 v66, v224, v218
    v_fmac_f32 v67, v224, v219
    v_mfma_f32_16x16x32_bf16 v[152:155], v[212:215], a[232:235], v[152:155]
    v_mul_f32 v64, v228, v64
    v_mul_f32 v65, v228, v65
    v_mfma_f32_16x16x32_bf16 v[156:159], v[212:215], a[236:239], v[156:159]
    v_mul_f32 v66, v228, v66
    v_mfma_f32_16x16x32_bf16 v[128:131], v[192:195], a[240:243], v[128:131]
    ds_read_b128 v[208:211], v248 offset:63488
    v_mul_f32 v67, v228, v67
    v_mfma_f32_16x16x32_bf16 v[132:135], v[192:195], a[244:247], v[132:135]
    ds_read_b128 v[212:215], v248 offset:64512
    v_mfma_f32_16x16x32_bf16 v[136:139], v[192:195], a[248:251], v[136:139]
    v_exp_f32 v64, v64
    v_mfma_f32_16x16x32_bf16 v[140:143], v[192:195], a[252:255], v[140:143]
    v_exp_f32 v65, v65
    v_mfma_f32_16x16x32_bf16 v[144:147], v[196:199], a[240:243], v[144:147]
    v_exp_f32 v66, v66
    v_mfma_f32_16x16x32_bf16 v[148:151], v[196:199], a[244:247], v[148:151]
    v_exp_f32 v67, v67
    v_mfma_f32_16x16x32_bf16 v[152:155], v[196:199], a[248:251], v[152:155]
    v_fmac_f32 v80, v224, v220
    v_fmac_f32 v81, v224, v221
    v_mfma_f32_16x16x32_bf16 v[156:159], v[196:199], a[252:255], v[156:159]
    v_fmac_f32 v82, v224, v222
    v_mfma_f32_16x16x32_bf16 v[128:131], v[200:203], v[0:3], v[128:131]
    ds_read_b128 v[192:195], v249 offset:0
    v_fmac_f32 v83, v224, v223
    v_mfma_f32_16x16x32_bf16 v[132:135], v[200:203], v[4:7], v[132:135]
    ds_read_b128 v[196:199], v249 offset:1024
    v_add_f32 v64, 1.0, v64
    v_mfma_f32_16x16x32_bf16 v[136:139], v[200:203], v[8:11], v[136:139]
    v_add_f32 v65, 1.0, v65
    v_add_f32 v66, 1.0, v66
    v_mfma_f32_16x16x32_bf16 v[140:143], v[200:203], v[12:15], v[140:143]
    v_add_f32 v67, 1.0, v67
    v_mfma_f32_16x16x32_bf16 v[144:147], v[204:207], v[0:3], v[144:147]
    v_rcp_f32 v64, v64
    v_mfma_f32_16x16x32_bf16 v[148:151], v[204:207], v[4:7], v[148:151]
    v_rcp_f32 v65, v65
    v_mfma_f32_16x16x32_bf16 v[152:155], v[204:207], v[8:11], v[152:155]
    v_rcp_f32 v66, v66
    v_mfma_f32_16x16x32_bf16 v[156:159], v[204:207], v[12:15], v[156:159]
    s_waitcnt lgkmcnt(2)
    v_mfma_f32_16x16x32_bf16 v[128:131], v[208:211], v[16:19], v[128:131]
    ds_read_b128 v[200:203], v249 offset:2048
    v_mfma_f32_16x16x32_bf16 v[132:135], v[208:211], v[20:23], v[132:135]
    ds_read_b128 v[204:207], v249 offset:3072
    v_mfma_f32_16x16x32_bf16 v[136:139], v[208:211], v[24:27], v[136:139]
    v_rcp_f32 v67, v67
    v_mfma_f32_16x16x32_bf16 v[140:143], v[208:211], v[28:31], v[140:143]
    v_mul_f32 v80, v80, v64
    v_mul_f32 v81, v81, v65
    v_mfma_f32_16x16x32_bf16 v[144:147], v[212:215], v[16:19], v[144:147]
    v_mul_f32 v82, v82, v66
    v_mul_f32 v83, v83, v67
    v_mfma_f32_16x16x32_bf16 v[148:151], v[212:215], v[20:23], v[148:151]
    v_cvt_pk_bf16_f32 v234, v80, v81
    v_cvt_pk_bf16_f32 v235, v82, v83
    v_mfma_f32_16x16x32_bf16 v[152:155], v[212:215], v[24:27], v[152:155]
    s_add_u32 s42, s45, 0
    buffer_store_dwordx4 v[232:235], v252, s[16:19], s42 offen offset:0 sc1
    v_mfma_f32_16x16x32_bf16 v[156:159], v[212:215], v[28:31], v[156:159]
    v_fmac_f32 v68, v225, v216
    s_waitcnt lgkmcnt(2)
    v_mfma_f32_16x16x32_bf16 v[32:35], v[192:195], a[0:3], 0
    ds_read_b128 v[208:211], v249 offset:4096
    v_fmac_f32 v69, v225, v217
    v_mfma_f32_16x16x32_bf16 v[36:39], v[192:195], a[4:7], 0
    ds_read_b128 v[212:215], v249 offset:5120
    v_fmac_f32 v70, v225, v218
    v_mfma_f32_16x16x32_bf16 v[40:43], v[192:195], a[8:11], 0
    v_fmac_f32 v71, v225, v219
    v_mul_f32 v68, v229, v68
    v_mfma_f32_16x16x32_bf16 v[44:47], v[192:195], a[12:15], 0
    v_mul_f32 v69, v229, v69
    v_mul_f32 v70, v229, v70
    v_mfma_f32_16x16x32_bf16 v[48:51], v[196:199], a[0:3], 0
    v_mul_f32 v71, v229, v71
    v_mfma_f32_16x16x32_bf16 v[52:55], v[196:199], a[4:7], 0
    v_exp_f32 v68, v68
    v_mfma_f32_16x16x32_bf16 v[56:59], v[196:199], a[8:11], 0
    v_exp_f32 v69, v69
    v_mfma_f32_16x16x32_bf16 v[60:63], v[196:199], a[12:15], 0
    s_waitcnt lgkmcnt(2)
    v_mfma_f32_16x16x32_bf16 v[32:35], v[200:203], a[16:19], v[32:35]
    ds_read_b128 v[192:195], v249 offset:6144
    v_mfma_f32_16x16x32_bf16 v[36:39], v[200:203], a[20:23], v[36:39]
    ds_read_b128 v[196:199], v249 offset:7168
    v_mfma_f32_16x16x32_bf16 v[40:43], v[200:203], a[24:27], v[40:43]
    v_exp_f32 v70, v70
    v_mfma_f32_16x16x32_bf16 v[44:47], v[200:203], a[28:31], v[44:47]
    v_exp_f32 v71, v71
    v_mfma_f32_16x16x32_bf16 v[48:51], v[204:207], a[16:19], v[48:51]
    v_fmac_f32 v84, v225, v220
    v_fmac_f32 v85, v225, v221
    v_mfma_f32_16x16x32_bf16 v[52:55], v[204:207], a[20:23], v[52:55]
    v_fmac_f32 v86, v225, v222
    v_fmac_f32 v87, v225, v223
    v_mfma_f32_16x16x32_bf16 v[56:59], v[204:207], a[24:27], v[56:59]
    v_add_f32 v68, 1.0, v68
    v_add_f32 v69, 1.0, v69
    v_mfma_f32_16x16x32_bf16 v[60:63], v[204:207], a[28:31], v[60:63]
    v_add_f32 v70, 1.0, v70
    s_waitcnt lgkmcnt(2)
    v_mfma_f32_16x16x32_bf16 v[32:35], v[208:211], a[32:35], v[32:35]
    ds_read_b128 v[200:203], v249 offset:8192
    v_add_f32 v71, 1.0, v71
    v_mfma_f32_16x16x32_bf16 v[36:39], v[208:211], a[36:39], v[36:39]
    ds_read_b128 v[204:207], v249 offset:9216
    v_mfma_f32_16x16x32_bf16 v[40:43], v[208:211], a[40:43], v[40:43]
    v_rcp_f32 v68, v68
    v_mfma_f32_16x16x32_bf16 v[44:47], v[208:211], a[44:47], v[44:47]
    v_rcp_f32 v69, v69
    v_mfma_f32_16x16x32_bf16 v[48:51], v[212:215], a[32:35], v[48:51]
    v_rcp_f32 v70, v70
    v_mfma_f32_16x16x32_bf16 v[52:55], v[212:215], a[36:39], v[52:55]
    v_rcp_f32 v71, v71
    v_mfma_f32_16x16x32_bf16 v[56:59], v[212:215], a[40:43], v[56:59]
    v_mul_f32 v84, v84, v68
    v_mul_f32 v85, v85, v69
    v_mfma_f32_16x16x32_bf16 v[60:63], v[212:215], a[44:47], v[60:63]
    v_mul_f32 v86, v86, v70
    s_waitcnt lgkmcnt(2)
    v_mfma_f32_16x16x32_bf16 v[32:35], v[192:195], a[48:51], v[32:35]
    ds_read_b128 v[208:211], v249 offset:10240
    v_mul_f32 v87, v87, v71
    v_mfma_f32_16x16x32_bf16 v[36:39], v[192:195], a[52:55], v[36:39]
    ds_read_b128 v[212:215], v249 offset:11264
    v_cvt_pk_bf16_f32 v238, v84, v85
    v_mfma_f32_16x16x32_bf16 v[40:43], v[192:195], a[56:59], v[40:43]
    v_cvt_pk_bf16_f32 v239, v86, v87
    buffer_store_dwordx4 v[236:239], v252, s[16:19], s42 offen offset:1024 sc1
    v_mfma_f32_16x16x32_bf16 v[44:47], v[192:195], a[60:63], v[44:47]
    v_fmac_f32 v72, v226, v216
    v_fmac_f32 v73, v226, v217
    v_mfma_f32_16x16x32_bf16 v[48:51], v[196:199], a[48:51], v[48:51]
    v_fmac_f32 v74, v226, v218
    v_fmac_f32 v75, v226, v219
    v_mfma_f32_16x16x32_bf16 v[52:55], v[196:199], a[52:55], v[52:55]
    v_mul_f32 v72, v230, v72
    v_mul_f32 v73, v230, v73
    v_mfma_f32_16x16x32_bf16 v[56:59], v[196:199], a[56:59], v[56:59]
    v_mul_f32 v74, v230, v74
    v_mul_f32 v75, v230, v75
    v_mfma_f32_16x16x32_bf16 v[60:63], v[196:199], a[60:63], v[60:63]
    s_waitcnt lgkmcnt(2)
    v_mfma_f32_16x16x32_bf16 v[32:35], v[200:203], a[64:67], v[32:35]
    s_waitcnt vmcnt(14)
    s_barrier
    v_mfma_f32_16x16x32_bf16 v[36:39], v[200:203], a[68:71], v[36:39]
    ds_read_b128 v[192:195], v249 offset:12288
    v_mfma_f32_16x16x32_bf16 v[40:43], v[200:203], a[72:75], v[40:43]
    ds_read_b128 v[196:199], v249 offset:13312
    v_mfma_f32_16x16x32_bf16 v[44:47], v[200:203], a[76:79], v[44:47]
    s_add_u32 m0, s31, 28672
    s_add_u32 s40, s44, 196608
    buffer_load_dwordx4 v250, s[12:15], s40 offen lds
    v_mfma_f32_16x16x32_bf16 v[48:51], v[204:207], a[64:67], v[48:51]
    s_add_u32 m0, s31, 32768
    s_add_u32 s40, s44, 200704
    buffer_load_dwordx4 v250, s[12:15], s40 offen lds
    v_mfma_f32_16x16x32_bf16 v[52:55], v[204:207], a[68:71], v[52:55]
    s_add_u32 m0, s31, 36864
    s_add_u32 s40, s44, 204800
    buffer_load_dwordx4 v250, s[12:15], s40 offen lds
    v_mfma_f32_16x16x32_bf16 v[56:59], v[204:207], a[72:75], v[56:59]
    s_add_u32 m0, s31, 40960
    s_add_u32 s40, s44, 208896
    buffer_load_dwordx4 v250, s[12:15], s40 offen lds
    v_mfma_f32_16x16x32_bf16 v[60:63], v[204:207], a[76:79], v[60:63]
    s_waitcnt lgkmcnt(2)
    v_mfma_f32_16x16x32_bf16 v[32:35], v[208:211], a[80:83], v[32:35]
    ds_read_b128 v[200:203], v249 offset:14336
    v_mfma_f32_16x16x32_bf16 v[36:39], v[208:211], a[84:87], v[36:39]
    ds_read_b128 v[204:207], v249 offset:15360
    v_mfma_f32_16x16x32_bf16 v[40:43], v[208:211], a[88:91], v[40:43]
    s_add_u32 m0, s31, 45056
    s_add_u32 s40, s44, 212992
    buffer_load_dwordx4 v250, s[12:15], s40 offen lds
    v_mfma_f32_16x16x32_bf16 v[44:47], v[208:211], a[92:95], v[44:47]
    s_add_u32 m0, s31, 49152
    s_add_u32 s40, s44, 217088
    buffer_load_dwordx4 v250, s[12:15], s40 offen lds
    v_mfma_f32_16x16x32_bf16 v[48:51], v[212:215], a[80:83], v[48:51]
    v_exp_f32 v72, v72
    v_mfma_f32_16x16x32_bf16 v[52:55], v[212:215], a[84:87], v[52:55]
    v_exp_f32 v73, v73
    v_mfma_f32_16x16x32_bf16 v[56:59], v[212:215], a[88:91], v[56:59]
    v_exp_f32 v74, v74
    v_mfma_f32_16x16x32_bf16 v[60:63], v[212:215], a[92:95], v[60:63]
    s_waitcnt lgkmcnt(2)
    v_mfma_f32_16x16x32_bf16 v[32:35], v[192:195], a[96:99], v[32:35]
    ds_read_b128 v[208:211], v249 offset:16384
    v_mfma_f32_16x16x32_bf16 v[36:39], v[192:195], a[100:103], v[36:39]
    ds_read_b128 v[212:215], v249 offset:17408
    v_mfma_f32_16x16x32_bf16 v[40:43], v[192:195], a[104:107], v[40:43]
    v_exp_f32 v75, v75
    v_mfma_f32_16x16x32_bf16 v[44:47], v[192:195], a[108:111], v[44:47]
    v_fmac_f32 v88, v226, v220
    v_fmac_f32 v89, v226, v221
    v_mfma_f32_16x16x32_bf16 v[48:51], v[196:199], a[96:99], v[48:51]
    v_fmac_f32 v90, v226, v222
    v_fmac_f32 v91, v226, v223
    v_mfma_f32_16x16x32_bf16 v[52:55], v[196:199], a[100:103], v[52:55]
    v_add_f32 v72, 1.0, v72
    v_add_f32 v73, 1.0, v73
    v_mfma_f32_16x16x32_bf16 v[56:59], v[196:199], a[104:107], v[56:59]
    v_add_f32 v74, 1.0, v74
    v_add_f32 v75, 1.0, v75
    v_mfma_f32_16x16x32_bf16 v[60:63], v[196:199], a[108:111], v[60:63]
    s_waitcnt lgkmcnt(2)
    v_mfma_f32_16x16x32_bf16 v[32:35], v[200:203], a[112:115], v[32:35]
    ds_read_b128 v[192:195], v249 offset:18432
    v_mfma_f32_16x16x32_bf16 v[36:39], v[200:203], a[116:119], v[36:39]
    ds_read_b128 v[196:199], v249 offset:19456
    v_mfma_f32_16x16x32_bf16 v[40:43], v[200:203], a[120:123], v[40:43]
    v_rcp_f32 v72, v72
    v_mfma_f32_16x16x32_bf16 v[44:47], v[200:203], a[124:127], v[44:47]
    v_rcp_f32 v73, v73
    v_mfma_f32_16x16x32_bf16 v[48:51], v[204:207], a[112:115], v[48:51]
    v_rcp_f32 v74, v74
    v_mfma_f32_16x16x32_bf16 v[52:55], v[204:207], a[116:119], v[52:55]
    v_rcp_f32 v75, v75
    v_mfma_f32_16x16x32_bf16 v[56:59], v[204:207], a[120:123], v[56:59]
    v_mul_f32 v88, v88, v72
    v_mul_f32 v89, v89, v73
    v_mfma_f32_16x16x32_bf16 v[60:63], v[204:207], a[124:127], v[60:63]
    v_mul_f32 v90, v90, v74
    s_waitcnt lgkmcnt(2)
    v_mfma_f32_16x16x32_bf16 v[32:35], v[208:211], a[128:131], v[32:35]
    ds_read_b128 v[200:203], v249 offset:20480
    v_mul_f32 v91, v91, v75
    v_mfma_f32_16x16x32_bf16 v[36:39], v[208:211], a[132:135], v[36:39]
    ds_read_b128 v[204:207], v249 offset:21504
    v_lshrrev_b32 v175, 4, v248
    s_lshr_b32 s33, s2, 3
    s_getpc_b64 s[34:35]
L_fk_kernelr_pc:
    s_add_u32 s34, s34, L_fk_kernelr_pc-L_fk_kernelr_pc
    s_addc_u32 s35, s35, 0
    s_mul_i32 s36, s33, ((L_fk_kernel_end-L_fk_kernelr_pc+4095)/4096)*128
    v_lshlrev_b32 v174, 7, v175
    v_min_u32 v174, ((L_fk_kernel_end-L_fk_kernelr_pc+4095)/4096-1)*128, v174
    v_add_u32 v174, s36, v174
    v_min_u32 v174, L_fk_kernel_end-L_fk_kernelr_pc-4, v174
    global_load_dword v173, v174, s[34:35]
    s_bfe_u32 s58, s2, 0x20001
    v_mfma_f32_16x16x32_bf16 v[40:43], v[208:211], a[136:139], v[40:43]
    v_cvt_pk_bf16_f32 v242, v88, v89
    v_cvt_pk_bf16_f32 v243, v90, v91
    v_mfma_f32_16x16x32_bf16 v[44:47], v[208:211], a[140:143], v[44:47]
    buffer_store_dwordx4 v[240:243], v253, s[16:19], s42 offen offset:0 sc1
    v_fmac_f32 v76, v227, v216
    v_mfma_f32_16x16x32_bf16 v[48:51], v[212:215], a[128:131], v[48:51]
    s_and_b32 s28, s2, 1
    s_lshl_b32 s28, s28, 3
    v_mfma_f32_16x16x32_bf16 v[52:55], v[212:215], a[132:135], v[52:55]
    v_fmac_f32 v77, v227, v217
    v_fmac_f32 v78, v227, v218
    v_mfma_f32_16x16x32_bf16 v[56:59], v[212:215], a[136:139], v[56:59]
    v_fmac_f32 v79, v227, v219
    v_mul_f32 v76, v231, v76
    v_mfma_f32_16x16x32_bf16 v[60:63], v[212:215], a[140:143], v[60:63]
    s_bfe_u32 s29, s2, 0x30003
    s_waitcnt lgkmcnt(2)
    v_mfma_f32_16x16x32_bf16 v[32:35], v[192:195], a[144:147], v[32:35]
    ds_read_b128 v[208:211], v249 offset:22528
    v_mul_f32 v77, v231, v77
    v_mfma_f32_16x16x32_bf16 v[36:39], v[192:195], a[148:151], v[36:39]
    ds_read_b128 v[212:215], v249 offset:23552
    v_mul_f32 v78, v231, v78
    v_mfma_f32_16x16x32_bf16 v[40:43], v[192:195], a[152:155], v[40:43]
    s_add_u32 s28, s28, s29
    s_bfe_u32 s29, s2, 0x20006
    v_mfma_f32_16x16x32_bf16 v[44:47], v[192:195], a[156:159], v[44:47]
    v_mul_f32 v79, v231, v79
    v_mfma_f32_16x16x32_bf16 v[48:51], v[196:199], a[144:147], v[48:51]
    v_exp_f32 v76, v76
    v_mfma_f32_16x16x32_bf16 v[52:55], v[196:199], a[148:151], v[52:55]
    s_mul_i32 s34, s58, 36
    s_lshl_b32 s35, s28, 1
    s_lshr_b32 s33, s30, 1
    s_add_u32 s35, s35, s33
    s_mul_i32 s35, s35, 144
    s_add_u32 s35, s35, s34
    s_lshl_b32 s35, s35, 12
    s_add_u32 s35, s35, 33554432
    s_add_u32 s8, s4, s35
    s_addc_u32 s9, s5, 0
    s_mov_b32 s10, 147456
    s_mov_b32 s11, 0x20000
    v_mfma_f32_16x16x32_bf16 v[56:59], v[196:199], a[152:155], v[56:59]
    v_exp_f32 v77, v77
    v_mfma_f32_16x16x32_bf16 v[60:63], v[196:199], a[156:159], v[60:63]
    s_and_b32 s33, s30, 1
    s_waitcnt lgkmcnt(2)
    v_mfma_f32_16x16x32_bf16 v[32:35], v[200:203], a[160:163], v[32:35]
    ds_read_b128 v[192:195], v248 offset:4096
    s_lshl_b32 s33, s33, 11
    v_mfma_f32_16x16x32_bf16 v[36:39], v[200:203], a[164:167], v[36:39]
    ds_read_b128 v[196:199], v248 offset:5120
    v_add_u32 v164, s33, v248
    v_mfma_f32_16x16x32_bf16 v[40:43], v[200:203], a[168:171], v[40:43]
    v_exp_f32 v78, v78
    v_mfma_f32_16x16x32_bf16 v[44:47], v[200:203], a[172:175], v[44:47]
    s_lshl_b32 s33, s28, 1
    s_lshr_b32 s34, s30, 1
    v_mfma_f32_16x16x32_bf16 v[48:51], v[204:207], a[160:163], v[48:51]
    v_exp_f32 v79, v79
    v_mfma_f32_16x16x32_bf16 v[52:55], v[204:207], a[164:167], v[52:55]
    v_fmac_f32 v92, v227, v220
    v_fmac_f32 v93, v227, v221
    v_mfma_f32_16x16x32_bf16 v[56:59], v[204:207], a[168:171], v[56:59]
    s_add_u32 s33, s33, s34
    s_lshl_b32 s33, s33, 5
    v_mfma_f32_16x16x32_bf16 v[60:63], v[204:207], a[172:175], v[60:63]
    v_fmac_f32 v94, v227, v222
    s_waitcnt lgkmcnt(2)
    v_mfma_f32_16x16x32_bf16 v[32:35], v[208:211], a[176:179], v[32:35]
    ds_read_b128 v[200:203], v248 offset:6144
    v_fmac_f32 v95, v227, v223
    v_mfma_f32_16x16x32_bf16 v[36:39], v[208:211], a[180:183], v[36:39]
    ds_read_b128 v[204:207], v248 offset:7168
    s_lshl_b32 s34, s58, 3
    v_mfma_f32_16x16x32_bf16 v[40:43], v[208:211], a[184:187], v[40:43]
    v_add_f32 v76, 1.0, v76
    v_add_f32 v77, 1.0, v77
    v_mfma_f32_16x16x32_bf16 v[44:47], v[208:211], a[188:191], v[44:47]
    v_add_f32 v78, 1.0, v78
    v_add_f32 v79, 1.0, v79
    v_mfma_f32_16x16x32_bf16 v[48:51], v[212:215], a[176:179], v[48:51]
    s_add_u32 s33, s33, s34
    v_bfe_u32 v170, v248, 4, 3
    v_mfma_f32_16x16x32_bf16 v[52:55], v[212:215], a[180:183], v[52:55]
    v_rcp_f32 v76, v76
    v_mfma_f32_16x16x32_bf16 v[56:59], v[212:215], a[184:187], v[56:59]
    v_rcp_f32 v77, v77
    v_mfma_f32_16x16x32_bf16 v[60:63], v[212:215], a[188:191], v[60:63]
    v_add_u32 v170, s33, v170
    s_waitcnt lgkmcnt(2)
    v_mfma_f32_16x16x32_bf16 v[32:35], v[192:195], a[192:195], v[32:35]
    ds_read_b128 v[208:211], v248 offset:8192
    v_lshlrev_b32 v170, 2, v170
    v_mfma_f32_16x16x32_bf16 v[36:39], v[192:195], a[196:199], v[36:39]
    ds_read_b128 v[212:215], v248 offset:9216
    buffer_load_dword v171, v170, s[48:51], 0 offen sc1
    v_mfma_f32_16x16x32_bf16 v[40:43], v[192:195], a[200:203], v[40:43]
    s_mul_i32 s33, s29, 144
    s_mul_i32 s34, s58, 36
    s_add_u32 s33, s33, s34
    s_mul_i32 s33, s33, 9216
    s_add_u32 s33, s33, 12582912
    s_add_u32 s52, s4, s33
    s_addc_u32 s53, s5, 0
    s_mov_b32 s54, 331776
    s_mov_b32 s55, 0x20000
    v_mfma_f32_16x16x32_bf16 v[44:47], v[192:195], a[204:207], v[44:47]
    v_rcp_f32 v78, v78
    v_mfma_f32_16x16x32_bf16 v[48:51], v[196:199], a[192:195], v[48:51]
    v_rcp_f32 v79, v79
    v_mfma_f32_16x16x32_bf16 v[52:55], v[196:199], a[196:199], v[52:55]
    s_mul_i32 s33, s29, 144
    s_mul_i32 s34, s58, 36
    v_mfma_f32_16x16x32_bf16 v[56:59], v[196:199], a[200:203], v[56:59]
    v_mul_f32 v92, v92, v76
    v_mul_f32 v93, v93, v77
    v_mfma_f32_16x16x32_bf16 v[60:63], v[196:199], a[204:207], v[60:63]
    v_mul_f32 v94, v94, v78
    s_waitcnt lgkmcnt(2)
    v_mfma_f32_16x16x32_bf16 v[32:35], v[200:203], a[208:211], v[32:35]
    ds_read_b128 v[192:195], v248 offset:10240
    s_add_u32 s33, s33, s34
    v_mfma_f32_16x16x32_bf16 v[36:39], v[200:203], a[212:215], v[36:39]
    ds_read_b128 v[196:199], v248 offset:11264
    v_mul_f32 v95, v95, v79
    v_mfma_f32_16x16x32_bf16 v[40:43], v[200:203], a[216:219], v[40:43]
    v_cvt_pk_bf16_f32 v246, v92, v93
    v_cvt_pk_bf16_f32 v247, v94, v95
    v_mfma_f32_16x16x32_bf16 v[44:47], v[200:203], a[220:223], v[44:47]
    s_add_u32 s33, s33, 3072
    v_lshrrev_b32 v168, 4, v248
    v_mfma_f32_16x16x32_bf16 v[48:51], v[204:207], a[208:211], v[48:51]
    buffer_store_dwordx4 v[244:247], v253, s[16:19], s42 offen offset:1024 sc1
    ds_read_b128 v[216:219], v251 offset:256
    v_mfma_f32_16x16x32_bf16 v[52:55], v[204:207], a[212:215], v[52:55]
    ds_read_b128 v[220:223], v251 offset:320
    s_waitcnt lgkmcnt(0)
    v_mfma_f32_16x16x32_bf16 v[56:59], v[204:207], a[216:219], v[56:59]
    v_min_u32 v168, 35, v168
    v_add_u32 v168, s33, v168
    v_mfma_f32_16x16x32_bf16 v[60:63], v[204:207], a[220:223], v[60:63]
    v_fmac_f32 v96, v224, v216
    v_mfma_f32_16x16x32_bf16 v[32:35], v[208:211], a[224:227], v[32:35]
    ds_read_b128 v[200:203], v248 offset:12288
    v_fmac_f32 v97, v224, v217
    v_mfma_f32_16x16x32_bf16 v[36:39], v[208:211], a[228:231], v[36:39]
    ds_read_b128 v[204:207], v248 offset:13312
    v_lshlrev_b32 v168, 2, v168
    v_mfma_f32_16x16x32_bf16 v[40:43], v[208:211], a[232:235], v[40:43]
    v_fmac_f32 v98, v224, v218
    v_fmac_f32 v99, v224, v219
    v_mfma_f32_16x16x32_bf16 v[44:47], v[208:211], a[236:239], v[44:47]
    v_mul_f32 v96, v228, v96
    v_mul_f32 v97, v228, v97
    v_mfma_f32_16x16x32_bf16 v[48:51], v[212:215], a[224:227], v[48:51]
    v_mul_f32 v98, v228, v98
    v_mul_f32 v99, v228, v99
    v_mfma_f32_16x16x32_bf16 v[52:55], v[212:215], a[228:231], v[52:55]
    v_exp_f32 v96, v96
    v_mfma_f32_16x16x32_bf16 v[56:59], v[212:215], a[232:235], v[56:59]
    v_exp_f32 v97, v97
    v_mfma_f32_16x16x32_bf16 v[60:63], v[212:215], a[236:239], v[60:63]
    v_mfma_f32_16x16x32_bf16 v[32:35], v[192:195], a[240:243], v[32:35]
    ds_read_b128 v[208:211], v248 offset:14336
    v_mfma_f32_16x16x32_bf16 v[36:39], v[192:195], a[244:247], v[36:39]
    ds_read_b128 v[212:215], v248 offset:15360
    v_mfma_f32_16x16x32_bf16 v[40:43], v[192:195], a[248:251], v[40:43]
    v_exp_f32 v98, v98
    v_mfma_f32_16x16x32_bf16 v[44:47], v[192:195], a[252:255], v[44:47]
    v_exp_f32 v99, v99
    v_mfma_f32_16x16x32_bf16 v[48:51], v[196:199], a[240:243], v[48:51]
    v_fmac_f32 v112, v224, v220
    v_fmac_f32 v113, v224, v221
    v_mfma_f32_16x16x32_bf16 v[52:55], v[196:199], a[244:247], v[52:55]
    v_fmac_f32 v114, v224, v222
    v_fmac_f32 v115, v224, v223
    v_mfma_f32_16x16x32_bf16 v[56:59], v[196:199], a[248:251], v[56:59]
    v_add_f32 v96, 1.0, v96
    v_add_f32 v97, 1.0, v97
    v_mfma_f32_16x16x32_bf16 v[60:63], v[196:199], a[252:255], v[60:63]
    v_add_f32 v98, 1.0, v98
    s_waitcnt lgkmcnt(2)
    v_mfma_f32_16x16x32_bf16 v[32:35], v[200:203], v[0:3], v[32:35]
    s_waitcnt vmcnt(7)
    s_barrier
    v_mfma_f32_16x16x32_bf16 v[36:39], v[200:203], v[4:7], v[36:39]
    ds_read_b128 v[192:195], v248 offset:16384
    ds_read_b64_tr_b16 v[176:177], v188 offset:0
    v_mfma_f32_16x16x32_bf16 v[40:43], v[200:203], v[8:11], v[40:43]
    ds_read_b128 v[196:199], v248 offset:17408
    v_add_f32 v99, 1.0, v99
    v_mfma_f32_16x16x32_bf16 v[44:47], v[200:203], v[12:15], v[44:47]
    s_add_u32 m0, s31, 53248
    s_add_u32 s40, s44, 221184
    buffer_load_dwordx4 v250, s[12:15], s40 offen lds
    v_mfma_f32_16x16x32_bf16 v[48:51], v[204:207], v[0:3], v[48:51]
    s_add_u32 m0, s31, 57344
    s_add_u32 s40, s44, 225280
    buffer_load_dwordx4 v250, s[12:15], s40 offen lds
    v_mfma_f32_16x16x32_bf16 v[52:55], v[204:207], v[4:7], v[52:55]
    s_add_u32 m0, s31, 61440
    s_add_u32 s40, s44, 229376
    buffer_load_dwordx4 v250, s[12:15], s40 offen lds
    v_mfma_f32_16x16x32_bf16 v[56:59], v[204:207], v[8:11], v[56:59]
    s_add_u32 m0, s31, 65536
    s_add_u32 s40, s44, 233472
    buffer_load_dwordx4 v250, s[12:15], s40 offen lds
    v_mfma_f32_16x16x32_bf16 v[60:63], v[204:207], v[12:15], v[60:63]
    ds_read_b64_tr_b16 v[178:179], v188 offset:4608
    s_waitcnt lgkmcnt(4)
    v_mfma_f32_16x16x32_bf16 v[32:35], v[208:211], v[16:19], v[32:35]
    ds_read_b128 v[200:203], v248 offset:18432
    v_mfma_f32_16x16x32_bf16 v[36:39], v[208:211], v[20:23], v[36:39]
    ds_read_b128 v[204:207], v248 offset:19456
    v_mfma_f32_16x16x32_bf16 v[40:43], v[208:211], v[24:27], v[40:43]
    s_add_u32 m0, s31, 69632
    s_add_u32 s40, s44, 237568
    buffer_load_dwordx4 v250, s[12:15], s40 offen lds
    v_mfma_f32_16x16x32_bf16 v[44:47], v[208:211], v[28:31], v[44:47]
    s_add_u32 m0, s31, 73728
    s_add_u32 s40, s44, 241664
    buffer_load_dwordx4 v250, s[12:15], s40 offen lds
    v_mfma_f32_16x16x32_bf16 v[48:51], v[212:215], v[16:19], v[48:51]
    v_rcp_f32 v96, v96
    v_mfma_f32_16x16x32_bf16 v[52:55], v[212:215], v[20:23], v[52:55]
    ds_read_b64_tr_b16 v[180:181], v188 offset:8
    ds_read_b64_tr_b16 v[182:183], v188 offset:4616
    v_mfma_f32_16x16x32_bf16 v[56:59], v[212:215], v[24:27], v[56:59]
    v_rcp_f32 v97, v97
    v_mfma_f32_16x16x32_bf16 v[60:63], v[212:215], v[28:31], v[60:63]
    s_waitcnt lgkmcnt(5)
    v_mfma_f32_16x16x32_bf16 v[64:67], v[192:195], a[0:3], 0
    ds_read_b128 v[208:211], v248 offset:20480
    ds_read_b64_tr_b16 v[184:185], v188 offset:64
    v_mfma_f32_16x16x32_bf16 v[68:71], v[192:195], a[4:7], 0
    ds_read_b128 v[212:215], v248 offset:21504
    v_mfma_f32_16x16x32_bf16 v[72:75], v[192:195], a[8:11], 0
    v_rcp_f32 v98, v98
    v_mfma_f32_16x16x32_bf16 v[76:79], v[192:195], a[12:15], 0
    ds_read_b64_tr_b16 v[186:187], v188 offset:4672
    s_waitcnt lgkmcnt(8)
    v_mfma_f32_16x16x32_bf16 v[80:83], v[196:199], a[0:3], 0
    v_rcp_f32 v99, v99
    v_mfma_f32_16x16x32_bf16 v[84:87], v[196:199], a[4:7], 0
    v_mul_f32 v112, v112, v96
    v_mul_f32 v113, v113, v97
    v_mfma_f32_16x16x32_bf16 v[88:91], v[196:199], a[8:11], 0
    s_add_u32 s47, s57, 0
    buffer_store_dwordx4 v[176:179], v248, s[96:99], s47 offen sc1
    v_mfma_f32_16x16x32_bf16 v[92:95], v[196:199], a[12:15], 0
    v_mul_f32 v114, v114, v98
    s_waitcnt lgkmcnt(6)
    v_mfma_f32_16x16x32_bf16 v[64:67], v[200:203], a[16:19], v[64:67]
    ds_read_b128 v[192:195], v248 offset:22528
    v_mul_f32 v115, v115, v99
    v_mfma_f32_16x16x32_bf16 v[68:71], v[200:203], a[20:23], v[68:71]
    ds_read_b128 v[196:199], v248 offset:23552
    s_waitcnt lgkmcnt(6)
    v_mfma_f32_16x16x32_bf16 v[72:75], v[200:203], a[24:27], v[72:75]
    v_cvt_pk_bf16_f32 v232, v112, v113
    v_cvt_pk_bf16_f32 v233, v114, v115
    v_mfma_f32_16x16x32_bf16 v[76:79], v[200:203], a[28:31], v[76:79]
    v_fmac_f32 v100, v225, v216
    v_fmac_f32 v101, v225, v217
    v_mfma_f32_16x16x32_bf16 v[80:83], v[204:207], a[16:19], v[80:83]
    s_add_u32 s47, s57, 1024
    buffer_store_dwordx4 v[180:183], v248, s[96:99], s47 offen sc1
    v_mfma_f32_16x16x32_bf16 v[84:87], v[204:207], a[20:23], v[84:87]
    v_fmac_f32 v102, v225, v218
    v_fmac_f32 v103, v225, v219
    v_mfma_f32_16x16x32_bf16 v[88:91], v[204:207], a[24:27], v[88:91]
    v_mul_f32 v100, v229, v100
    v_mul_f32 v101, v229, v101
    v_mfma_f32_16x16x32_bf16 v[92:95], v[204:207], a[28:31], v[92:95]
    s_waitcnt lgkmcnt(2)
    v_mfma_f32_16x16x32_bf16 v[64:67], v[208:211], a[32:35], v[64:67]
    ds_read_b128 v[200:203], v248 offset:24576
    v_mul_f32 v102, v229, v102
    v_mfma_f32_16x16x32_bf16 v[68:71], v[208:211], a[36:39], v[68:71]
    ds_read_b128 v[204:207], v248 offset:25600
    v_mul_f32 v103, v229, v103
    v_mfma_f32_16x16x32_bf16 v[72:75], v[208:211], a[40:43], v[72:75]
    s_add_u32 s47, s57, 2048
    buffer_store_dwordx4 v[184:187], v248, s[96:99], s47 offen sc1
    v_mfma_f32_16x16x32_bf16 v[76:79], v[208:211], a[44:47], v[76:79]
    v_exp_f32 v100, v100
    v_mfma_f32_16x16x32_bf16 v[80:83], v[212:215], a[32:35], v[80:83]
    v_exp_f32 v101, v101
    v_mfma_f32_16x16x32_bf16 v[84:87], v[212:215], a[36:39], v[84:87]
    ds_read_b64_tr_b16 v[176:177], v188 offset:72
    ds_read_b64_tr_b16 v[178:179], v188 offset:4680
    v_mfma_f32_16x16x32_bf16 v[88:91], v[212:215], a[40:43], v[88:91]
    v_exp_f32 v102, v102
    v_mfma_f32_16x16x32_bf16 v[92:95], v[212:215], a[44:47], v[92:95]
    s_waitcnt lgkmcnt(4)
    v_mfma_f32_16x16x32_bf16 v[64:67], v[192:195], a[48:51], v[64:67]
    ds_read_b128 v[208:211], v248 offset:26624
    ds_read_b64_tr_b16 v[180:181], v188 offset:128
    v_mfma_f32_16x16x32_bf16 v[68:71], v[192:195], a[52:55], v[68:71]
    ds_read_b128 v[212:215], v248 offset:27648
    v_mfma_f32_16x16x32_bf16 v[72:75], v[192:195], a[56:59], v[72:75]
    v_exp_f32 v103, v103
    v_mfma_f32_16x16x32_bf16 v[76:79], v[192:195], a[60:63], v[76:79]
    ds_read_b64_tr_b16 v[182:183], v188 offset:4736
    ds_read_b64_tr_b16 v[184:185], v188 offset:136
    v_mfma_f32_16x16x32_bf16 v[80:83], v[196:199], a[48:51], v[80:83]
    v_fmac_f32 v116, v225, v220
    v_fmac_f32 v117, v225, v221
    v_mfma_f32_16x16x32_bf16 v[84:87], v[196:199], a[52:55], v[84:87]
    v_fmac_f32 v118, v225, v222
    v_fmac_f32 v119, v225, v223
    v_mfma_f32_16x16x32_bf16 v[88:91], v[196:199], a[56:59], v[88:91]
    ds_read_b64_tr_b16 v[186:187], v188 offset:4744
    s_waitcnt lgkmcnt(6)
    v_mfma_f32_16x16x32_bf16 v[92:95], v[196:199], a[60:63], v[92:95]
    v_add_f32 v100, 1.0, v100
    v_mfma_f32_16x16x32_bf16 v[64:67], v[200:203], a[64:67], v[64:67]
    ds_read_b128 v[192:195], v248 offset:28672
    v_add_f32 v101, 1.0, v101
    v_mfma_f32_16x16x32_bf16 v[68:71], v[200:203], a[68:71], v[68:71]
    ds_read_b128 v[196:199], v248 offset:29696
    v_add_f32 v102, 1.0, v102
    v_mfma_f32_16x16x32_bf16 v[72:75], v[200:203], a[72:75], v[72:75]
    s_waitcnt vmcnt(9)
    v_mov_b32 v172, 1
    v_mfma_f32_16x16x32_bf16 v[76:79], v[200:203], a[76:79], v[76:79]
    buffer_store_dword v172, off, s[48:51], s59 sc1
    v_add_f32 v103, 1.0, v103
    v_mfma_f32_16x16x32_bf16 v[80:83], v[204:207], a[64:67], v[80:83]
    s_add_u32 s47, s57, 3072
    buffer_store_dwordx4 v[176:179], v248, s[96:99], s47 offen sc1
    v_mfma_f32_16x16x32_bf16 v[84:87], v[204:207], a[68:71], v[84:87]
    v_rcp_f32 v100, v100
    v_mfma_f32_16x16x32_bf16 v[88:91], v[204:207], a[72:75], v[88:91]
    v_rcp_f32 v101, v101
    v_mfma_f32_16x16x32_bf16 v[92:95], v[204:207], a[76:79], v[92:95]
    s_waitcnt lgkmcnt(4)
    v_mfma_f32_16x16x32_bf16 v[64:67], v[208:211], a[80:83], v[64:67]
    ds_read_b128 v[200:203], v248 offset:30720
    v_mfma_f32_16x16x32_bf16 v[68:71], v[208:211], a[84:87], v[68:71]
    ds_read_b128 v[204:207], v248 offset:31744
    v_mfma_f32_16x16x32_bf16 v[72:75], v[208:211], a[88:91], v[72:75]
    s_add_u32 s47, s57, 4096
    buffer_store_dwordx4 v[180:183], v248, s[96:99], s47 offen sc1
    v_mfma_f32_16x16x32_bf16 v[76:79], v[208:211], a[92:95], v[76:79]
    v_rcp_f32 v102, v102
    v_mfma_f32_16x16x32_bf16 v[80:83], v[212:215], a[80:83], v[80:83]
    v_rcp_f32 v103, v103
    v_mfma_f32_16x16x32_bf16 v[84:87], v[212:215], a[84:87], v[84:87]
    s_waitcnt lgkmcnt(4)
    v_mul_f32 v116, v116, v100
    v_mfma_f32_16x16x32_bf16 v[88:91], v[212:215], a[88:91], v[88:91]
    v_mul_f32 v117, v117, v101
    v_mul_f32 v118, v118, v102
    v_mfma_f32_16x16x32_bf16 v[92:95], v[212:215], a[92:95], v[92:95]
    v_mul_f32 v119, v119, v103
    s_waitcnt lgkmcnt(2)
    v_mfma_f32_16x16x32_bf16 v[64:67], v[192:195], a[96:99], v[64:67]
    ds_read_b128 v[208:211], v248 offset:32768
    v_cvt_pk_bf16_f32 v236, v116, v117
    v_mfma_f32_16x16x32_bf16 v[68:71], v[192:195], a[100:103], v[68:71]
    ds_read_b128 v[212:215], v248 offset:33792
    v_cvt_pk_bf16_f32 v237, v118, v119
    v_mfma_f32_16x16x32_bf16 v[72:75], v[192:195], a[104:107], v[72:75]
    v_fmac_f32 v104, v226, v216
    v_fmac_f32 v105, v226, v217
    v_mfma_f32_16x16x32_bf16 v[76:79], v[192:195], a[108:111], v[76:79]
    s_add_u32 s47, s57, 5120
    buffer_store_dwordx4 v[184:187], v248, s[96:99], s47 offen sc1
    v_mfma_f32_16x16x32_bf16 v[80:83], v[196:199], a[96:99], v[80:83]
    v_fmac_f32 v106, v226, v218
    v_fmac_f32 v107, v226, v219
    v_mfma_f32_16x16x32_bf16 v[84:87], v[196:199], a[100:103], v[84:87]
    v_mul_f32 v104, v230, v104
    v_mul_f32 v105, v230, v105
    v_mfma_f32_16x16x32_bf16 v[88:91], v[196:199], a[104:107], v[88:91]
    ds_read_b64_tr_b16 v[176:177], v188 offset:192
    ds_read_b64_tr_b16 v[178:179], v188 offset:4800
    v_mfma_f32_16x16x32_bf16 v[92:95], v[196:199], a[108:111], v[92:95]
    v_mul_f32 v106, v230, v106
    s_waitcnt lgkmcnt(4)
    v_mfma_f32_16x16x32_bf16 v[64:67], v[200:203], a[112:115], v[64:67]
    ds_read_b128 v[192:195], v248 offset:34816
    v_mul_f32 v107, v230, v107
    v_mfma_f32_16x16x32_bf16 v[68:71], v[200:203], a[116:119], v[68:71]
    ds_read_b128 v[196:199], v248 offset:35840
    ds_read_b64_tr_b16 v[180:181], v188 offset:200
    v_mfma_f32_16x16x32_bf16 v[72:75], v[200:203], a[120:123], v[72:75]
    v_exp_f32 v104, v104
    v_mfma_f32_16x16x32_bf16 v[76:79], v[200:203], a[124:127], v[76:79]
    v_exp_f32 v105, v105
    v_mfma_f32_16x16x32_bf16 v[80:83], v[204:207], a[112:115], v[80:83]
    ds_read_b64_tr_b16 v[182:183], v188 offset:4808
    ds_read_b64_tr_b16 v[184:185], v189 offset:256
    v_mfma_f32_16x16x32_bf16 v[84:87], v[204:207], a[116:119], v[84:87]
    v_exp_f32 v106, v106
    v_mfma_f32_16x16x32_bf16 v[88:91], v[204:207], a[120:123], v[88:91]
    v_exp_f32 v107, v107
    v_mfma_f32_16x16x32_bf16 v[92:95], v[204:207], a[124:127], v[92:95]
    ds_read_b64_tr_b16 v[186:187], v189 offset:4864
    s_waitcnt lgkmcnt(8)
    v_mfma_f32_16x16x32_bf16 v[64:67], v[208:211], a[128:131], v[64:67]
    ds_read_b128 v[200:203], v248 offset:36864
    v_fmac_f32 v120, v226, v220
    v_mfma_f32_16x16x32_bf16 v[68:71], v[208:211], a[132:135], v[68:71]
    ds_read_b128 v[204:207], v248 offset:37888
    v_fmac_f32 v121, v226, v221
    v_mfma_f32_16x16x32_bf16 v[72:75], v[208:211], a[136:139], v[72:75]
    s_waitcnt lgkmcnt(8)
    v_fmac_f32 v122, v226, v222
    v_mfma_f32_16x16x32_bf16 v[76:79], v[208:211], a[140:143], v[76:79]
    v_fmac_f32 v123, v226, v223
    v_add_f32 v104, 1.0, v104
    v_mfma_f32_16x16x32_bf16 v[80:83], v[212:215], a[128:131], v[80:83]
    v_add_f32 v105, 1.0, v105
    v_add_f32 v106, 1.0, v106
    v_mfma_f32_16x16x32_bf16 v[84:87], v[212:215], a[132:135], v[84:87]
    s_add_u32 s47, s57, 6144
    buffer_store_dwordx4 v[176:179], v248, s[96:99], s47 offen sc1
    v_mfma_f32_16x16x32_bf16 v[88:91], v[212:215], a[136:139], v[88:91]
    v_add_f32 v107, 1.0, v107
    v_mfma_f32_16x16x32_bf16 v[92:95], v[212:215], a[140:143], v[92:95]
    s_waitcnt lgkmcnt(6)
    v_mfma_f32_16x16x32_bf16 v[64:67], v[192:195], a[144:147], v[64:67]
    ds_read_b128 v[208:211], v248 offset:38912
    s_waitcnt lgkmcnt(5)
    v_mfma_f32_16x16x32_bf16 v[68:71], v[192:195], a[148:151], v[68:71]
    ds_read_b128 v[212:215], v248 offset:39936
    v_mfma_f32_16x16x32_bf16 v[72:75], v[192:195], a[152:155], v[72:75]
    v_rcp_f32 v104, v104
    v_mfma_f32_16x16x32_bf16 v[76:79], v[192:195], a[156:159], v[76:79]
    s_add_u32 s47, s57, 7168
    buffer_store_dwordx4 v[180:183], v248, s[96:99], s47 offen sc1
    v_mfma_f32_16x16x32_bf16 v[80:83], v[196:199], a[144:147], v[80:83]
    v_rcp_f32 v105, v105
    v_mfma_f32_16x16x32_bf16 v[84:87], v[196:199], a[148:151], v[84:87]
    v_rcp_f32 v106, v106
    v_mfma_f32_16x16x32_bf16 v[88:91], v[196:199], a[152:155], v[88:91]
    s_waitcnt lgkmcnt(4)
    v_mfma_f32_16x16x32_bf16 v[92:95], v[196:199], a[156:159], v[92:95]
    s_waitcnt lgkmcnt(2)
    v_mfma_f32_16x16x32_bf16 v[64:67], v[200:203], a[160:163], v[64:67]
    s_waitcnt vmcnt(12)
    s_barrier
    v_mfma_f32_16x16x32_bf16 v[68:71], v[200:203], a[164:167], v[68:71]
    ds_read_b128 v[192:195], v248 offset:40960
    v_mfma_f32_16x16x32_bf16 v[72:75], v[200:203], a[168:171], v[72:75]
    ds_read_b128 v[196:199], v248 offset:41984
    v_mfma_f32_16x16x32_bf16 v[76:79], v[200:203], a[172:175], v[76:79]
    s_add_u32 m0, s31, 77824
    s_add_u32 s40, s44, 245760
    buffer_load_dwordx4 v250, s[12:15], s40 offen lds
    v_mfma_f32_16x16x32_bf16 v[80:83], v[204:207], a[160:163], v[80:83]
    s_add_u32 m0, s31, 81920
    s_add_u32 s40, s44, 249856
    buffer_load_dwordx4 v250, s[12:15], s40 offen lds
    v_mfma_f32_16x16x32_bf16 v[84:87], v[204:207], a[164:167], v[84:87]
    s_add_u32 m0, s31, 86016
    s_add_u32 s40, s44, 253952
    buffer_load_dwordx4 v250, s[12:15], s40 offen lds
    v_mfma_f32_16x16x32_bf16 v[88:91], v[204:207], a[168:171], v[88:91]
    s_add_u32 m0, s31, 4096
    s_add_u32 s40, s44, 258048
    buffer_load_dwordx4 v250, s[12:15], s40 offen lds
    v_mfma_f32_16x16x32_bf16 v[92:95], v[204:207], a[172:175], v[92:95]
    s_waitcnt lgkmcnt(2)
    v_mfma_f32_16x16x32_bf16 v[64:67], v[208:211], a[176:179], v[64:67]
    ds_read_b128 v[200:203], v248 offset:43008
    v_mfma_f32_16x16x32_bf16 v[68:71], v[208:211], a[180:183], v[68:71]
    ds_read_b128 v[204:207], v248 offset:44032
    v_mfma_f32_16x16x32_bf16 v[72:75], v[208:211], a[184:187], v[72:75]
    s_add_u32 m0, s31, 8192
    s_add_u32 s40, s44, 262144
    buffer_load_dwordx4 v250, s[12:15], s40 offen lds
    v_mfma_f32_16x16x32_bf16 v[76:79], v[208:211], a[188:191], v[76:79]
    s_add_u32 m0, s31, 12288
    s_add_u32 s40, s44, 266240
    buffer_load_dwordx4 v250, s[12:15], s40 offen lds
    v_mfma_f32_16x16x32_bf16 v[80:83], v[212:215], a[176:179], v[80:83]
    v_rcp_f32 v107, v107
    v_mfma_f32_16x16x32_bf16 v[84:87], v[212:215], a[180:183], v[84:87]
    s_add_u32 s47, s57, 8192
    buffer_store_dwordx4 v[184:187], v248, s[96:99], s47 offen sc1
    v_mfma_f32_16x16x32_bf16 v[88:91], v[212:215], a[184:187], v[88:91]
    v_mul_f32 v120, v120, v104
    v_mul_f32 v121, v121, v105
    v_mfma_f32_16x16x32_bf16 v[92:95], v[212:215], a[188:191], v[92:95]
    v_mul_f32 v122, v122, v106
    s_waitcnt lgkmcnt(2)
    v_mfma_f32_16x16x32_bf16 v[64:67], v[192:195], a[192:195], v[64:67]
    ds_read_b128 v[208:211], v248 offset:45056
    v_mul_f32 v123, v123, v107
    v_mfma_f32_16x16x32_bf16 v[68:71], v[192:195], a[196:199], v[68:71]
    ds_read_b128 v[212:215], v248 offset:46080
    v_cvt_pk_bf16_f32 v240, v120, v121
    v_mfma_f32_16x16x32_bf16 v[72:75], v[192:195], a[200:203], v[72:75]
    v_cvt_pk_bf16_f32 v241, v122, v123
    v_fmac_f32 v108, v227, v216
    v_mfma_f32_16x16x32_bf16 v[76:79], v[192:195], a[204:207], v[76:79]
    v_fmac_f32 v109, v227, v217
    v_fmac_f32 v110, v227, v218
    v_mfma_f32_16x16x32_bf16 v[80:83], v[196:199], a[192:195], v[80:83]
    v_fmac_f32 v111, v227, v219
    v_mul_f32 v108, v231, v108
    v_mfma_f32_16x16x32_bf16 v[84:87], v[196:199], a[196:199], v[84:87]
    v_mul_f32 v109, v231, v109
    v_mul_f32 v110, v231, v110
    v_mfma_f32_16x16x32_bf16 v[88:91], v[196:199], a[200:203], v[88:91]
    v_mul_f32 v111, v231, v111
    v_mfma_f32_16x16x32_bf16 v[92:95], v[196:199], a[204:207], v[92:95]
    s_waitcnt lgkmcnt(2)
    v_mfma_f32_16x16x32_bf16 v[64:67], v[200:203], a[208:211], v[64:67]
    ds_read_b128 v[192:195], v248 offset:47104
    v_mfma_f32_16x16x32_bf16 v[68:71], v[200:203], a[212:215], v[68:71]
    ds_read_b128 v[196:199], v248 offset:48128
    v_mfma_f32_16x16x32_bf16 v[72:75], v[200:203], a[216:219], v[72:75]
    v_exp_f32 v108, v108
    v_mfma_f32_16x16x32_bf16 v[76:79], v[200:203], a[220:223], v[76:79]
    v_exp_f32 v109, v109
    v_mfma_f32_16x16x32_bf16 v[80:83], v[204:207], a[208:211], v[80:83]
    v_exp_f32 v110, v110
    v_mfma_f32_16x16x32_bf16 v[84:87], v[204:207], a[212:215], v[84:87]
    v_exp_f32 v111, v111
    v_mfma_f32_16x16x32_bf16 v[88:91], v[204:207], a[216:219], v[88:91]
    v_fmac_f32 v124, v227, v220
    v_fmac_f32 v125, v227, v221
    v_mfma_f32_16x16x32_bf16 v[92:95], v[204:207], a[220:223], v[92:95]
    v_fmac_f32 v126, v227, v222
    s_waitcnt lgkmcnt(2)
    v_mfma_f32_16x16x32_bf16 v[64:67], v[208:211], a[224:227], v[64:67]
    ds_read_b128 v[200:203], v248 offset:49152
    v_fmac_f32 v127, v227, v223
    v_mfma_f32_16x16x32_bf16 v[68:71], v[208:211], a[228:231], v[68:71]
    ds_read_b128 v[204:207], v248 offset:50176
    v_add_f32 v108, 1.0, v108
    v_mfma_f32_16x16x32_bf16 v[72:75], v[208:211], a[232:235], v[72:75]
    v_add_f32 v109, 1.0, v109
    v_add_f32 v110, 1.0, v110
    v_mfma_f32_16x16x32_bf16 v[76:79], v[208:211], a[236:239], v[76:79]
    v_add_f32 v111, 1.0, v111
    v_mfma_f32_16x16x32_bf16 v[80:83], v[212:215], a[224:227], v[80:83]
    v_rcp_f32 v108, v108
    v_mfma_f32_16x16x32_bf16 v[84:87], v[212:215], a[228:231], v[84:87]
    v_rcp_f32 v109, v109
    v_mfma_f32_16x16x32_bf16 v[88:91], v[212:215], a[232:235], v[88:91]
    v_rcp_f32 v110, v110
    v_mfma_f32_16x16x32_bf16 v[92:95], v[212:215], a[236:239], v[92:95]
    s_waitcnt lgkmcnt(2)
    v_mfma_f32_16x16x32_bf16 v[64:67], v[192:195], a[240:243], v[64:67]
    ds_read_b128 v[208:211], v248 offset:51200
    v_mfma_f32_16x16x32_bf16 v[68:71], v[192:195], a[244:247], v[68:71]
    ds_read_b128 v[212:215], v248 offset:52224
    v_mfma_f32_16x16x32_bf16 v[72:75], v[192:195], a[248:251], v[72:75]
    v_rcp_f32 v111, v111
    v_mfma_f32_16x16x32_bf16 v[76:79], v[192:195], a[252:255], v[76:79]
    v_mul_f32 v124, v124, v108
    v_mul_f32 v125, v125, v109
    v_mfma_f32_16x16x32_bf16 v[80:83], v[196:199], a[240:243], v[80:83]
    v_mul_f32 v126, v126, v110
    v_mul_f32 v127, v127, v111
    v_mfma_f32_16x16x32_bf16 v[84:87], v[196:199], a[244:247], v[84:87]
    v_cvt_pk_bf16_f32 v244, v124, v125
    v_cvt_pk_bf16_f32 v245, v126, v127
    v_mfma_f32_16x16x32_bf16 v[88:91], v[196:199], a[248:251], v[88:91]
    ds_read_b128 v[216:219], v251 offset:384
    ds_read_b128 v[220:223], v251 offset:448
    v_mfma_f32_16x16x32_bf16 v[92:95], v[196:199], a[252:255], v[92:95]
    s_waitcnt lgkmcnt(0)
    v_mfma_f32_16x16x32_bf16 v[64:67], v[200:203], v[0:3], v[64:67]
    ds_read_b128 v[192:195], v248 offset:53248
    v_fmac_f32 v128, v224, v216
    v_mfma_f32_16x16x32_bf16 v[68:71], v[200:203], v[4:7], v[68:71]
    ds_read_b128 v[196:199], v248 offset:54272
    v_fmac_f32 v129, v224, v217
    v_mfma_f32_16x16x32_bf16 v[72:75], v[200:203], v[8:11], v[72:75]
    v_fmac_f32 v130, v224, v218
    v_fmac_f32 v131, v224, v219
    v_mfma_f32_16x16x32_bf16 v[76:79], v[200:203], v[12:15], v[76:79]
    v_mul_f32 v128, v228, v128
    v_mul_f32 v129, v228, v129
    v_mfma_f32_16x16x32_bf16 v[80:83], v[204:207], v[0:3], v[80:83]
    v_mul_f32 v130, v228, v130
    v_mul_f32 v131, v228, v131
    v_mfma_f32_16x16x32_bf16 v[84:87], v[204:207], v[4:7], v[84:87]
    v_exp_f32 v128, v128
    v_mfma_f32_16x16x32_bf16 v[88:91], v[204:207], v[8:11], v[88:91]
    v_exp_f32 v129, v129
    v_mfma_f32_16x16x32_bf16 v[92:95], v[204:207], v[12:15], v[92:95]
    v_mfma_f32_16x16x32_bf16 v[64:67], v[208:211], v[16:19], v[64:67]
    ds_read_b128 v[200:203], v248 offset:55296
    v_mfma_f32_16x16x32_bf16 v[68:71], v[208:211], v[20:23], v[68:71]
    ds_read_b128 v[204:207], v248 offset:56320
    v_mfma_f32_16x16x32_bf16 v[72:75], v[208:211], v[24:27], v[72:75]
    v_exp_f32 v130, v130
    v_mfma_f32_16x16x32_bf16 v[76:79], v[208:211], v[28:31], v[76:79]
    v_exp_f32 v131, v131
    v_mfma_f32_16x16x32_bf16 v[80:83], v[212:215], v[16:19], v[80:83]
    v_fmac_f32 v144, v224, v220
    v_fmac_f32 v145, v224, v221
    v_mfma_f32_16x16x32_bf16 v[84:87], v[212:215], v[20:23], v[84:87]
    v_fmac_f32 v146, v224, v222
    v_fmac_f32 v147, v224, v223
    v_mfma_f32_16x16x32_bf16 v[88:91], v[212:215], v[24:27], v[88:91]
    v_add_f32 v128, 1.0, v128
    v_add_f32 v129, 1.0, v129
    v_mfma_f32_16x16x32_bf16 v[92:95], v[212:215], v[28:31], v[92:95]
    v_add_f32 v130, 1.0, v130
    s_waitcnt lgkmcnt(2)
    v_mfma_f32_16x16x32_bf16 v[96:99], v[192:195], a[0:3], 0
    ds_read_b128 v[208:211], v248 offset:57344
    v_add_f32 v131, 1.0, v131
    v_mfma_f32_16x16x32_bf16 v[100:103], v[192:195], a[4:7], 0
    ds_read_b128 v[212:215], v248 offset:58368
    v_mfma_f32_16x16x32_bf16 v[104:107], v[192:195], a[8:11], 0
    v_rcp_f32 v128, v128
    v_mfma_f32_16x16x32_bf16 v[108:111], v[192:195], a[12:15], 0
    v_rcp_f32 v129, v129
    v_mfma_f32_16x16x32_bf16 v[112:115], v[196:199], a[0:3], 0
    v_rcp_f32 v130, v130
    v_mfma_f32_16x16x32_bf16 v[116:119], v[196:199], a[4:7], 0
    v_rcp_f32 v131, v131
    v_mfma_f32_16x16x32_bf16 v[120:123], v[196:199], a[8:11], 0
    v_mul_f32 v144, v144, v128
    v_mul_f32 v145, v145, v129
    v_mfma_f32_16x16x32_bf16 v[124:127], v[196:199], a[12:15], 0
    v_mul_f32 v146, v146, v130
    s_waitcnt lgkmcnt(2)
    v_mfma_f32_16x16x32_bf16 v[96:99], v[200:203], a[16:19], v[96:99]
    ds_read_b128 v[192:195], v248 offset:59392
    v_mul_f32 v147, v147, v131
    v_mfma_f32_16x16x32_bf16 v[100:103], v[200:203], a[20:23], v[100:103]
    ds_read_b128 v[196:199], v248 offset:60416
    v_cvt_pk_bf16_f32 v234, v144, v145
    v_mfma_f32_16x16x32_bf16 v[104:107], v[200:203], a[24:27], v[104:107]
    v_cvt_pk_bf16_f32 v235, v146, v147
    s_add_u32 s42, s45, 4096
    v_mfma_f32_16x16x32_bf16 v[108:111], v[200:203], a[28:31], v[108:111]
    buffer_store_dwordx4 v[232:235], v252, s[16:19], s42 offen offset:0 sc1
    v_fmac_f32 v132, v225, v216
    v_mfma_f32_16x16x32_bf16 v[112:115], v[204:207], a[16:19], v[112:115]
    s_waitcnt vmcnt(1)
    v_mov_b32 v190, 1
    v_mfma_f32_16x16x32_bf16 v[116:119], v[204:207], a[20:23], v[116:119]
    v_fmac_f32 v133, v225, v217
    v_fmac_f32 v134, v225, v218
    v_mfma_f32_16x16x32_bf16 v[120:123], v[204:207], a[24:27], v[120:123]
    v_fmac_f32 v135, v225, v219
    v_mul_f32 v132, v229, v132
    v_mfma_f32_16x16x32_bf16 v[124:127], v[204:207], a[28:31], v[124:127]
    buffer_store_dword v190, off, s[96:99], s100 sc1
    s_waitcnt lgkmcnt(2)
    v_mfma_f32_16x16x32_bf16 v[96:99], v[208:211], a[32:35], v[96:99]
    ds_read_b128 v[200:203], v248 offset:61440
    v_mul_f32 v133, v229, v133
    v_mfma_f32_16x16x32_bf16 v[100:103], v[208:211], a[36:39], v[100:103]
    ds_read_b128 v[204:207], v248 offset:62464
    v_mul_f32 v134, v229, v134
    v_mfma_f32_16x16x32_bf16 v[104:107], v[208:211], a[40:43], v[104:107]
    v_mul_f32 v135, v229, v135
    v_mfma_f32_16x16x32_bf16 v[108:111], v[208:211], a[44:47], v[108:111]
    v_exp_f32 v132, v132
    v_mfma_f32_16x16x32_bf16 v[112:115], v[212:215], a[32:35], v[112:115]
    v_exp_f32 v133, v133
    v_mfma_f32_16x16x32_bf16 v[116:119], v[212:215], a[36:39], v[116:119]
    v_exp_f32 v134, v134
    v_mfma_f32_16x16x32_bf16 v[120:123], v[212:215], a[40:43], v[120:123]
    v_exp_f32 v135, v135
    v_mfma_f32_16x16x32_bf16 v[124:127], v[212:215], a[44:47], v[124:127]
    v_fmac_f32 v148, v225, v220
    s_waitcnt lgkmcnt(2)
    v_mfma_f32_16x16x32_bf16 v[96:99], v[192:195], a[48:51], v[96:99]
    ds_read_b128 v[208:211], v248 offset:63488
    v_fmac_f32 v149, v225, v221
    v_mfma_f32_16x16x32_bf16 v[100:103], v[192:195], a[52:55], v[100:103]
    ds_read_b128 v[212:215], v248 offset:64512
    v_fmac_f32 v150, v225, v222
    v_mfma_f32_16x16x32_bf16 v[104:107], v[192:195], a[56:59], v[104:107]
    v_fmac_f32 v151, v225, v223
    v_add_f32 v132, 1.0, v132
    v_mfma_f32_16x16x32_bf16 v[108:111], v[192:195], a[60:63], v[108:111]
    v_add_f32 v133, 1.0, v133
    v_add_f32 v134, 1.0, v134
    v_mfma_f32_16x16x32_bf16 v[112:115], v[196:199], a[48:51], v[112:115]
    v_add_f32 v135, 1.0, v135
    v_mfma_f32_16x16x32_bf16 v[116:119], v[196:199], a[52:55], v[116:119]
    v_rcp_f32 v132, v132
    v_mfma_f32_16x16x32_bf16 v[120:123], v[196:199], a[56:59], v[120:123]
    v_rcp_f32 v133, v133
    v_mfma_f32_16x16x32_bf16 v[124:127], v[196:199], a[60:63], v[124:127]
    s_waitcnt lgkmcnt(2)
    v_mfma_f32_16x16x32_bf16 v[96:99], v[200:203], a[64:67], v[96:99]
    s_barrier
    v_mfma_f32_16x16x32_bf16 v[100:103], v[200:203], a[68:71], v[100:103]
    ds_read_b128 v[192:195], v249 offset:0
    v_mfma_f32_16x16x32_bf16 v[104:107], v[200:203], a[72:75], v[104:107]
    ds_read_b128 v[196:199], v249 offset:1024
    v_mfma_f32_16x16x32_bf16 v[108:111], v[200:203], a[76:79], v[108:111]
    s_add_u32 m0, s31, 16384
    s_add_u32 s40, s44, 270336
    buffer_load_dwordx4 v250, s[12:15], s40 offen lds
    v_mfma_f32_16x16x32_bf16 v[112:115], v[204:207], a[64:67], v[112:115]
    s_add_u32 m0, s31, 20480
    s_add_u32 s40, s44, 274432
    buffer_load_dwordx4 v250, s[12:15], s40 offen lds
    v_mfma_f32_16x16x32_bf16 v[116:119], v[204:207], a[68:71], v[116:119]
    s_add_u32 m0, s31, 24576
    s_add_u32 s40, s44, 278528
    buffer_load_dwordx4 v250, s[12:15], s40 offen lds
    v_mfma_f32_16x16x32_bf16 v[120:123], v[204:207], a[72:75], v[120:123]
    s_add_u32 m0, s31, 28672
    s_add_u32 s40, s44, 282624
    buffer_load_dwordx4 v250, s[12:15], s40 offen lds
    v_mfma_f32_16x16x32_bf16 v[124:127], v[204:207], a[76:79], v[124:127]
    s_waitcnt lgkmcnt(2)
    v_mfma_f32_16x16x32_bf16 v[96:99], v[208:211], a[80:83], v[96:99]
    ds_read_b128 v[200:203], v249 offset:2048
    v_mfma_f32_16x16x32_bf16 v[100:103], v[208:211], a[84:87], v[100:103]
    ds_read_b128 v[204:207], v249 offset:3072
    v_mfma_f32_16x16x32_bf16 v[104:107], v[208:211], a[88:91], v[104:107]
    s_add_u32 m0, s31, 32768
    s_add_u32 s40, s44, 286720
    buffer_load_dwordx4 v250, s[12:15], s40 offen lds
    v_mfma_f32_16x16x32_bf16 v[108:111], v[208:211], a[92:95], v[108:111]
    s_add_u32 m0, s31, 36864
    s_add_u32 s40, s44, 290816
    buffer_load_dwordx4 v250, s[12:15], s40 offen lds
    v_mfma_f32_16x16x32_bf16 v[112:115], v[212:215], a[80:83], v[112:115]
    v_rcp_f32 v134, v134
    v_mfma_f32_16x16x32_bf16 v[116:119], v[212:215], a[84:87], v[116:119]
    v_rcp_f32 v135, v135
    v_mfma_f32_16x16x32_bf16 v[120:123], v[212:215], a[88:91], v[120:123]
    v_mul_f32 v148, v148, v132
    v_mul_f32 v149, v149, v133
    v_mfma_f32_16x16x32_bf16 v[124:127], v[212:215], a[92:95], v[124:127]
    v_mul_f32 v150, v150, v134
    s_waitcnt lgkmcnt(2)
    v_mfma_f32_16x16x32_bf16 v[96:99], v[192:195], a[96:99], v[96:99]
    ds_read_b128 v[208:211], v249 offset:4096
    v_mul_f32 v151, v151, v135
    v_mfma_f32_16x16x32_bf16 v[100:103], v[192:195], a[100:103], v[100:103]
    ds_read_b128 v[212:215], v249 offset:5120
    v_cvt_pk_bf16_f32 v238, v148, v149
    v_mfma_f32_16x16x32_bf16 v[104:107], v[192:195], a[104:107], v[104:107]
    v_cvt_pk_bf16_f32 v239, v150, v151
    buffer_store_dwordx4 v[236:239], v252, s[16:19], s42 offen offset:1024 sc1
    v_mfma_f32_16x16x32_bf16 v[108:111], v[192:195], a[108:111], v[108:111]
    v_fmac_f32 v136, v226, v216
    v_fmac_f32 v137, v226, v217
    v_mfma_f32_16x16x32_bf16 v[112:115], v[196:199], a[96:99], v[112:115]
    v_fmac_f32 v138, v226, v218
    v_fmac_f32 v139, v226, v219
    v_mfma_f32_16x16x32_bf16 v[116:119], v[196:199], a[100:103], v[116:119]
    v_mul_f32 v136, v230, v136
    v_mul_f32 v137, v230, v137
    v_mfma_f32_16x16x32_bf16 v[120:123], v[196:199], a[104:107], v[120:123]
    v_mul_f32 v138, v230, v138
    v_mul_f32 v139, v230, v139
    v_mfma_f32_16x16x32_bf16 v[124:127], v[196:199], a[108:111], v[124:127]
    s_waitcnt lgkmcnt(2)
    v_mfma_f32_16x16x32_bf16 v[96:99], v[200:203], a[112:115], v[96:99]
    ds_read_b128 v[192:195], v249 offset:6144
    v_mfma_f32_16x16x32_bf16 v[100:103], v[200:203], a[116:119], v[100:103]
    ds_read_b128 v[196:199], v249 offset:7168
    v_mfma_f32_16x16x32_bf16 v[104:107], v[200:203], a[120:123], v[104:107]
    v_exp_f32 v136, v136
    v_mfma_f32_16x16x32_bf16 v[108:111], v[200:203], a[124:127], v[108:111]
    v_exp_f32 v137, v137
    v_mfma_f32_16x16x32_bf16 v[112:115], v[204:207], a[112:115], v[112:115]
    v_exp_f32 v138, v138
    v_mfma_f32_16x16x32_bf16 v[116:119], v[204:207], a[116:119], v[116:119]
    v_exp_f32 v139, v139
    v_mfma_f32_16x16x32_bf16 v[120:123], v[204:207], a[120:123], v[120:123]
    v_fmac_f32 v152, v226, v220
    v_fmac_f32 v153, v226, v221
    v_mfma_f32_16x16x32_bf16 v[124:127], v[204:207], a[124:127], v[124:127]
    v_fmac_f32 v154, v226, v222
    s_waitcnt lgkmcnt(2)
    v_mfma_f32_16x16x32_bf16 v[96:99], v[208:211], a[128:131], v[96:99]
    ds_read_b128 v[200:203], v249 offset:8192
    v_fmac_f32 v155, v226, v223
    v_mfma_f32_16x16x32_bf16 v[100:103], v[208:211], a[132:135], v[100:103]
    ds_read_b128 v[204:207], v249 offset:9216
    v_add_f32 v136, 1.0, v136
    v_mfma_f32_16x16x32_bf16 v[104:107], v[208:211], a[136:139], v[104:107]
    v_add_f32 v137, 1.0, v137
    v_add_f32 v138, 1.0, v138
    v_mfma_f32_16x16x32_bf16 v[108:111], v[208:211], a[140:143], v[108:111]
    v_add_f32 v139, 1.0, v139
    v_mfma_f32_16x16x32_bf16 v[112:115], v[212:215], a[128:131], v[112:115]
    v_rcp_f32 v136, v136
    v_mfma_f32_16x16x32_bf16 v[116:119], v[212:215], a[132:135], v[116:119]
    v_rcp_f32 v137, v137
    v_mfma_f32_16x16x32_bf16 v[120:123], v[212:215], a[136:139], v[120:123]
    v_rcp_f32 v138, v138
    v_mfma_f32_16x16x32_bf16 v[124:127], v[212:215], a[140:143], v[124:127]
    s_waitcnt lgkmcnt(2)
    v_mfma_f32_16x16x32_bf16 v[96:99], v[192:195], a[144:147], v[96:99]
    ds_read_b128 v[208:211], v249 offset:10240
    v_mfma_f32_16x16x32_bf16 v[100:103], v[192:195], a[148:151], v[100:103]
    ds_read_b128 v[212:215], v249 offset:11264
    v_mfma_f32_16x16x32_bf16 v[104:107], v[192:195], a[152:155], v[104:107]
    v_rcp_f32 v139, v139
    v_mfma_f32_16x16x32_bf16 v[108:111], v[192:195], a[156:159], v[108:111]
    v_mul_f32 v152, v152, v136
    v_mul_f32 v153, v153, v137
    v_mfma_f32_16x16x32_bf16 v[112:115], v[196:199], a[144:147], v[112:115]
    v_mul_f32 v154, v154, v138
    v_mul_f32 v155, v155, v139
    v_mfma_f32_16x16x32_bf16 v[116:119], v[196:199], a[148:151], v[116:119]
    v_cvt_pk_bf16_f32 v242, v152, v153
    v_cvt_pk_bf16_f32 v243, v154, v155
    v_mfma_f32_16x16x32_bf16 v[120:123], v[196:199], a[152:155], v[120:123]
    buffer_store_dwordx4 v[240:243], v253, s[16:19], s42 offen offset:0 sc1
    v_fmac_f32 v140, v227, v216
    v_mfma_f32_16x16x32_bf16 v[124:127], v[196:199], a[156:159], v[124:127]
    v_fmac_f32 v141, v227, v217
    s_waitcnt lgkmcnt(2)
    v_mfma_f32_16x16x32_bf16 v[96:99], v[200:203], a[160:163], v[96:99]
    ds_read_b128 v[192:195], v249 offset:12288
    v_fmac_f32 v142, v227, v218
    v_mfma_f32_16x16x32_bf16 v[100:103], v[200:203], a[164:167], v[100:103]
    ds_read_b128 v[196:199], v249 offset:13312
    v_fmac_f32 v143, v227, v219
    v_mfma_f32_16x16x32_bf16 v[104:107], v[200:203], a[168:171], v[104:107]
    v_mul_f32 v140, v231, v140
    v_mul_f32 v141, v231, v141
    v_mfma_f32_16x16x32_bf16 v[108:111], v[200:203], a[172:175], v[108:111]
    v_mul_f32 v142, v231, v142
    v_mul_f32 v143, v231, v143
    v_mfma_f32_16x16x32_bf16 v[112:115], v[204:207], a[160:163], v[112:115]
    v_exp_f32 v140, v140
    v_mfma_f32_16x16x32_bf16 v[116:119], v[204:207], a[164:167], v[116:119]
    v_exp_f32 v141, v141
    v_mfma_f32_16x16x32_bf16 v[120:123], v[204:207], a[168:171], v[120:123]
    v_exp_f32 v142, v142
    v_mfma_f32_16x16x32_bf16 v[124:127], v[204:207], a[172:175], v[124:127]
    s_waitcnt lgkmcnt(2)
    v_mfma_f32_16x16x32_bf16 v[96:99], v[208:211], a[176:179], v[96:99]
    ds_read_b128 v[200:203], v249 offset:14336
    v_mfma_f32_16x16x32_bf16 v[100:103], v[208:211], a[180:183], v[100:103]
    ds_read_b128 v[204:207], v249 offset:15360
    v_mfma_f32_16x16x32_bf16 v[104:107], v[208:211], a[184:187], v[104:107]
    v_exp_f32 v143, v143
    v_mfma_f32_16x16x32_bf16 v[108:111], v[208:211], a[188:191], v[108:111]
    v_fmac_f32 v156, v227, v220
    v_fmac_f32 v157, v227, v221
    v_mfma_f32_16x16x32_bf16 v[112:115], v[212:215], a[176:179], v[112:115]
    v_fmac_f32 v158, v227, v222
    v_fmac_f32 v159, v227, v223
    v_mfma_f32_16x16x32_bf16 v[116:119], v[212:215], a[180:183], v[116:119]
    v_add_f32 v140, 1.0, v140
    v_add_f32 v141, 1.0, v141
    v_mfma_f32_16x16x32_bf16 v[120:123], v[212:215], a[184:187], v[120:123]
    v_add_f32 v142, 1.0, v142
    v_add_f32 v143, 1.0, v143
    v_mfma_f32_16x16x32_bf16 v[124:127], v[212:215], a[188:191], v[124:127]
    s_waitcnt lgkmcnt(2)
    v_mfma_f32_16x16x32_bf16 v[96:99], v[192:195], a[192:195], v[96:99]
    ds_read_b128 v[208:211], v249 offset:16384
    buffer_load_dword v169, v168, s[48:51], 0 offen sc1
    v_mfma_f32_16x16x32_bf16 v[100:103], v[192:195], a[196:199], v[100:103]
    ds_read_b128 v[212:215], v249 offset:17408
    v_mfma_f32_16x16x32_bf16 v[104:107], v[192:195], a[200:203], v[104:107]
    v_rcp_f32 v140, v140
    v_mfma_f32_16x16x32_bf16 v[108:111], v[192:195], a[204:207], v[108:111]
    v_rcp_f32 v141, v141
    v_mfma_f32_16x16x32_bf16 v[112:115], v[196:199], a[192:195], v[112:115]
    v_rcp_f32 v142, v142
    v_mfma_f32_16x16x32_bf16 v[116:119], v[196:199], a[196:199], v[116:119]
    v_rcp_f32 v143, v143
    v_mfma_f32_16x16x32_bf16 v[120:123], v[196:199], a[200:203], v[120:123]
    v_mul_f32 v156, v156, v140
    v_mul_f32 v157, v157, v141
    v_mfma_f32_16x16x32_bf16 v[124:127], v[196:199], a[204:207], v[124:127]
    v_mul_f32 v158, v158, v142
    s_waitcnt lgkmcnt(2)
    v_mfma_f32_16x16x32_bf16 v[96:99], v[200:203], a[208:211], v[96:99]
    ds_read_b128 v[192:195], v249 offset:18432
    v_mul_f32 v159, v159, v143
    v_mfma_f32_16x16x32_bf16 v[100:103], v[200:203], a[212:215], v[100:103]
    ds_read_b128 v[196:199], v249 offset:19456
    v_cvt_pk_bf16_f32 v246, v156, v157
    v_mfma_f32_16x16x32_bf16 v[104:107], v[200:203], a[216:219], v[104:107]
    v_cvt_pk_bf16_f32 v247, v158, v159
    buffer_store_dwordx4 v[244:247], v253, s[16:19], s42 offen offset:1024 sc1
    v_mfma_f32_16x16x32_bf16 v[108:111], v[200:203], a[220:223], v[108:111]
    ds_read_b128 v[216:219], v251 offset:512
    ds_read_b128 v[220:223], v251 offset:576
    v_mfma_f32_16x16x32_bf16 v[112:115], v[204:207], a[208:211], v[112:115]
    s_waitcnt lgkmcnt(0)
    v_fmac_f32 v32, v224, v216
    v_mfma_f32_16x16x32_bf16 v[116:119], v[204:207], a[212:215], v[116:119]
    v_fmac_f32 v33, v224, v217
    v_fmac_f32 v34, v224, v218
    v_mfma_f32_16x16x32_bf16 v[120:123], v[204:207], a[216:219], v[120:123]
    v_fmac_f32 v35, v224, v219
    v_mul_f32 v32, v228, v32
    v_mfma_f32_16x16x32_bf16 v[124:127], v[204:207], a[220:223], v[124:127]
    v_mul_f32 v33, v228, v33
    v_mfma_f32_16x16x32_bf16 v[96:99], v[208:211], a[224:227], v[96:99]
    ds_read_b128 v[200:203], v249 offset:20480
    v_mul_f32 v34, v228, v34
    v_mfma_f32_16x16x32_bf16 v[100:103], v[208:211], a[228:231], v[100:103]
    ds_read_b128 v[204:207], v249 offset:21504
    v_mul_f32 v35, v228, v35
    v_mfma_f32_16x16x32_bf16 v[104:107], v[208:211], a[232:235], v[104:107]
    v_exp_f32 v32, v32
    v_mfma_f32_16x16x32_bf16 v[108:111], v[208:211], a[236:239], v[108:111]
    v_exp_f32 v33, v33
    v_mfma_f32_16x16x32_bf16 v[112:115], v[212:215], a[224:227], v[112:115]
    v_exp_f32 v34, v34
    v_mfma_f32_16x16x32_bf16 v[116:119], v[212:215], a[228:231], v[116:119]
    v_exp_f32 v35, v35
    v_mfma_f32_16x16x32_bf16 v[120:123], v[212:215], a[232:235], v[120:123]
    v_fmac_f32 v48, v224, v220
    v_fmac_f32 v49, v224, v221
    v_mfma_f32_16x16x32_bf16 v[124:127], v[212:215], a[236:239], v[124:127]
    v_fmac_f32 v50, v224, v222
    v_mfma_f32_16x16x32_bf16 v[96:99], v[192:195], a[240:243], v[96:99]
    ds_read_b128 v[208:211], v249 offset:22528
    v_fmac_f32 v51, v224, v223
    v_mfma_f32_16x16x32_bf16 v[100:103], v[192:195], a[244:247], v[100:103]
    ds_read_b128 v[212:215], v249 offset:23552
    v_add_f32 v32, 1.0, v32
    v_mfma_f32_16x16x32_bf16 v[104:107], v[192:195], a[248:251], v[104:107]
    v_add_f32 v33, 1.0, v33
    v_add_f32 v34, 1.0, v34
    v_mfma_f32_16x16x32_bf16 v[108:111], v[192:195], a[252:255], v[108:111]
    v_add_f32 v35, 1.0, v35
    v_mfma_f32_16x16x32_bf16 v[112:115], v[196:199], a[240:243], v[112:115]
    v_rcp_f32 v32, v32
    v_mfma_f32_16x16x32_bf16 v[116:119], v[196:199], a[244:247], v[116:119]
    v_rcp_f32 v33, v33
    v_mfma_f32_16x16x32_bf16 v[120:123], v[196:199], a[248:251], v[120:123]
    v_rcp_f32 v34, v34
    v_mfma_f32_16x16x32_bf16 v[124:127], v[196:199], a[252:255], v[124:127]
    s_waitcnt lgkmcnt(2)
    v_mfma_f32_16x16x32_bf16 v[96:99], v[200:203], v[0:3], v[96:99]
    s_waitcnt vmcnt(7)
    s_barrier
    v_mfma_f32_16x16x32_bf16 v[100:103], v[200:203], v[4:7], v[100:103]
    ds_read_b128 v[192:195], v248 offset:4096
    v_mfma_f32_16x16x32_bf16 v[104:107], v[200:203], v[8:11], v[104:107]
    ds_read_b128 v[196:199], v248 offset:5120
    v_mfma_f32_16x16x32_bf16 v[108:111], v[200:203], v[12:15], v[108:111]
    s_add_u32 m0, s31, 40960
    s_mov_b32 s40, 294912
    buffer_load_dwordx4 v250, s[12:15], s40 offen lds
    v_mfma_f32_16x16x32_bf16 v[112:115], v[204:207], v[0:3], v[112:115]
    s_add_u32 m0, s31, 45056
    s_mov_b32 s40, 299008
    buffer_load_dwordx4 v250, s[12:15], s40 offen lds
    v_mfma_f32_16x16x32_bf16 v[116:119], v[204:207], v[4:7], v[116:119]
    s_add_u32 m0, s31, 49152
    s_mov_b32 s40, 303104
    buffer_load_dwordx4 v250, s[12:15], s40 offen lds
    v_mfma_f32_16x16x32_bf16 v[120:123], v[204:207], v[8:11], v[120:123]
    s_add_u32 m0, s31, 53248
    s_mov_b32 s40, 307200
    buffer_load_dwordx4 v250, s[12:15], s40 offen lds
    v_mfma_f32_16x16x32_bf16 v[124:127], v[204:207], v[12:15], v[124:127]
    s_waitcnt lgkmcnt(2)
    v_mfma_f32_16x16x32_bf16 v[96:99], v[208:211], v[16:19], v[96:99]
    ds_read_b128 v[200:203], v248 offset:6144
    v_mfma_f32_16x16x32_bf16 v[100:103], v[208:211], v[20:23], v[100:103]
    ds_read_b128 v[204:207], v248 offset:7168
    v_mfma_f32_16x16x32_bf16 v[104:107], v[208:211], v[24:27], v[104:107]
    s_add_u32 m0, s31, 57344
    s_mov_b32 s40, 311296
    buffer_load_dwordx4 v250, s[12:15], s40 offen lds
    v_mfma_f32_16x16x32_bf16 v[108:111], v[208:211], v[28:31], v[108:111]
    s_add_u32 m0, s31, 61440
    s_mov_b32 s40, 315392
    buffer_load_dwordx4 v250, s[12:15], s40 offen lds
    v_mfma_f32_16x16x32_bf16 v[112:115], v[212:215], v[16:19], v[112:115]
    v_rcp_f32 v35, v35
    v_mfma_f32_16x16x32_bf16 v[116:119], v[212:215], v[20:23], v[116:119]
    v_mul_f32 v48, v48, v32
    v_mul_f32 v49, v49, v33
    v_mfma_f32_16x16x32_bf16 v[120:123], v[212:215], v[24:27], v[120:123]
    v_mul_f32 v50, v50, v34
    v_mul_f32 v51, v51, v35
    v_mfma_f32_16x16x32_bf16 v[124:127], v[212:215], v[28:31], v[124:127]
    v_cvt_pk_bf16_f32 v232, v48, v49
    s_waitcnt lgkmcnt(2)
    v_mfma_f32_16x16x32_bf16 v[128:131], v[192:195], a[0:3], 0
    ds_read_b128 v[208:211], v248 offset:8192
    v_cvt_pk_bf16_f32 v233, v50, v51
    v_mfma_f32_16x16x32_bf16 v[132:135], v[192:195], a[4:7], 0
    ds_read_b128 v[212:215], v248 offset:9216
    v_fmac_f32 v36, v225, v216
    v_mfma_f32_16x16x32_bf16 v[136:139], v[192:195], a[8:11], 0
    v_fmac_f32 v37, v225, v217
    v_fmac_f32 v38, v225, v218
    v_mfma_f32_16x16x32_bf16 v[140:143], v[192:195], a[12:15], 0
    v_fmac_f32 v39, v225, v219
    v_mul_f32 v36, v229, v36
    v_mfma_f32_16x16x32_bf16 v[144:147], v[196:199], a[0:3], 0
    v_mul_f32 v37, v229, v37
    v_mul_f32 v38, v229, v38
    v_mfma_f32_16x16x32_bf16 v[148:151], v[196:199], a[4:7], 0
    v_mul_f32 v39, v229, v39
    v_mfma_f32_16x16x32_bf16 v[152:155], v[196:199], a[8:11], 0
    v_exp_f32 v36, v36
    v_mfma_f32_16x16x32_bf16 v[156:159], v[196:199], a[12:15], 0
    s_waitcnt lgkmcnt(2)
    v_mfma_f32_16x16x32_bf16 v[128:131], v[200:203], a[16:19], v[128:131]
    ds_read_b128 v[192:195], v248 offset:10240
    v_mfma_f32_16x16x32_bf16 v[132:135], v[200:203], a[20:23], v[132:135]
    ds_read_b128 v[196:199], v248 offset:11264
    v_mfma_f32_16x16x32_bf16 v[136:139], v[200:203], a[24:27], v[136:139]
    v_exp_f32 v37, v37
    v_mfma_f32_16x16x32_bf16 v[140:143], v[200:203], a[28:31], v[140:143]
    v_exp_f32 v38, v38
    v_mfma_f32_16x16x32_bf16 v[144:147], v[204:207], a[16:19], v[144:147]
    v_exp_f32 v39, v39
    v_mfma_f32_16x16x32_bf16 v[148:151], v[204:207], a[20:23], v[148:151]
    v_fmac_f32 v52, v225, v220
    v_fmac_f32 v53, v225, v221
    v_mfma_f32_16x16x32_bf16 v[152:155], v[204:207], a[24:27], v[152:155]
    v_fmac_f32 v54, v225, v222
    v_fmac_f32 v55, v225, v223
    v_mfma_f32_16x16x32_bf16 v[156:159], v[204:207], a[28:31], v[156:159]
    v_add_f32 v36, 1.0, v36
    s_waitcnt lgkmcnt(2)
    v_mfma_f32_16x16x32_bf16 v[128:131], v[208:211], a[32:35], v[128:131]
    ds_read_b128 v[200:203], v248 offset:12288
    v_add_f32 v37, 1.0, v37
    v_mfma_f32_16x16x32_bf16 v[132:135], v[208:211], a[36:39], v[132:135]
    ds_read_b128 v[204:207], v248 offset:13312
    s_waitcnt vmcnt(7)
    v_cmp_gt_u32 vcc, 1, v169
    s_nop 0
    s_cmp_eq_u64 vcc, 0
    s_cbranch_scc1 L_fk_kernel_wd_ok
    s_mov_b32 s43, 0x10000
L_fk_kernel_wd_spin:
    buffer_load_dword v169, v168, s[48:51], 0 offen sc1
    s_waitcnt vmcnt(0)
    v_cmp_gt_u32 vcc, 1, v169
    s_nop 0
    s_cmp_eq_u64 vcc, 0
    s_cbranch_scc1 L_fk_kernel_wd_ok
    s_sleep 1
    s_sub_u32 s43, s43, 1
    s_cmp_lg_u32 s43, 0
    s_cbranch_scc1 L_fk_kernel_wd_spin
L_fk_kernel_wd_ok:
    v_add_f32 v38, 1.0, v38
    v_mfma_f32_16x16x32_bf16 v[136:139], v[208:211], a[40:43], v[136:139]
    v_add_f32 v39, 1.0, v39
    v_mfma_f32_16x16x32_bf16 v[140:143], v[208:211], a[44:47], v[140:143]
    v_rcp_f32 v36, v36
    v_mfma_f32_16x16x32_bf16 v[144:147], v[212:215], a[32:35], v[144:147]
    s_add_u32 m0, s31, 90112
    s_mov_b32 s47, 0
    buffer_load_dwordx4 v250, s[52:55], s47 offen sc1 lds
    v_mfma_f32_16x16x32_bf16 v[148:151], v[212:215], a[36:39], v[148:151]
    v_rcp_f32 v37, v37
    v_mfma_f32_16x16x32_bf16 v[152:155], v[212:215], a[40:43], v[152:155]
    v_rcp_f32 v38, v38
    v_mfma_f32_16x16x32_bf16 v[156:159], v[212:215], a[44:47], v[156:159]
    s_waitcnt lgkmcnt(2)
    v_mfma_f32_16x16x32_bf16 v[128:131], v[192:195], a[48:51], v[128:131]
    ds_read_b128 v[208:211], v248 offset:14336
    v_mfma_f32_16x16x32_bf16 v[132:135], v[192:195], a[52:55], v[132:135]
    ds_read_b128 v[212:215], v248 offset:15360
    v_mfma_f32_16x16x32_bf16 v[136:139], v[192:195], a[56:59], v[136:139]
    s_add_u32 m0, s31, 94208
    s_mov_b32 s47, 4096
    buffer_load_dwordx4 v250, s[52:55], s47 offen sc1 lds
    v_mfma_f32_16x16x32_bf16 v[140:143], v[192:195], a[60:63], v[140:143]
    v_rcp_f32 v39, v39
    v_mfma_f32_16x16x32_bf16 v[144:147], v[196:199], a[48:51], v[144:147]
    v_mul_f32 v52, v52, v36
    v_mul_f32 v53, v53, v37
    v_mfma_f32_16x16x32_bf16 v[148:151], v[196:199], a[52:55], v[148:151]
    s_add_u32 m0, s31, 98304
    s_mov_b32 s47, 8192
    buffer_load_dwordx4 v250, s[52:55], s47 offen sc1 lds
    v_mfma_f32_16x16x32_bf16 v[152:155], v[196:199], a[56:59], v[152:155]
    v_mul_f32 v54, v54, v38
    v_mul_f32 v55, v55, v39
    v_mfma_f32_16x16x32_bf16 v[156:159], v[196:199], a[60:63], v[156:159]
    v_cvt_pk_bf16_f32 v236, v52, v53
    s_waitcnt lgkmcnt(2)
    v_mfma_f32_16x16x32_bf16 v[128:131], v[200:203], a[64:67], v[128:131]
    ds_read_b128 v[192:195], v248 offset:16384
    v_cvt_pk_bf16_f32 v237, v54, v55
    v_mfma_f32_16x16x32_bf16 v[132:135], v[200:203], a[68:71], v[132:135]
    ds_read_b128 v[196:199], v248 offset:17408
    s_waitcnt vmcnt(9)
    v_mfma_f32_16x16x32_bf16 v[136:139], v[200:203], a[72:75], v[136:139]
    v_mov_b32 v172, 2
    buffer_store_dword v172, off, s[48:51], s59 sc1
    v_mfma_f32_16x16x32_bf16 v[140:143], v[200:203], a[76:79], v[140:143]
    s_add_u32 m0, s31, 102400
    s_mov_b32 s47, 12288
    buffer_load_dwordx4 v250, s[52:55], s47 offen sc1 lds
    v_mfma_f32_16x16x32_bf16 v[144:147], v[204:207], a[64:67], v[144:147]
    v_fmac_f32 v40, v226, v216
    v_fmac_f32 v41, v226, v217
    v_mfma_f32_16x16x32_bf16 v[148:151], v[204:207], a[68:71], v[148:151]
    v_fmac_f32 v42, v226, v218
    v_fmac_f32 v43, v226, v219
    v_mfma_f32_16x16x32_bf16 v[152:155], v[204:207], a[72:75], v[152:155]
    s_add_u32 m0, s31, 106496
    s_mov_b32 s47, 16384
    buffer_load_dwordx4 v250, s[52:55], s47 offen sc1 lds
    v_mfma_f32_16x16x32_bf16 v[156:159], v[204:207], a[76:79], v[156:159]
    v_mul_f32 v40, v230, v40
    s_waitcnt lgkmcnt(2)
    v_mfma_f32_16x16x32_bf16 v[128:131], v[208:211], a[80:83], v[128:131]
    ds_read_b128 v[200:203], v248 offset:18432
    v_mul_f32 v41, v230, v41
    v_mfma_f32_16x16x32_bf16 v[132:135], v[208:211], a[84:87], v[132:135]
    ds_read_b128 v[204:207], v248 offset:19456
    v_mul_f32 v42, v230, v42
    v_mfma_f32_16x16x32_bf16 v[136:139], v[208:211], a[88:91], v[136:139]
    v_mul_f32 v43, v230, v43
    v_mfma_f32_16x16x32_bf16 v[140:143], v[208:211], a[92:95], v[140:143]
    v_exp_f32 v40, v40
    v_mfma_f32_16x16x32_bf16 v[144:147], v[212:215], a[80:83], v[144:147]
    s_add_u32 m0, s31, 110592
    s_mov_b32 s47, 20480
    buffer_load_dwordx4 v250, s[52:55], s47 offen sc1 lds
    v_mfma_f32_16x16x32_bf16 v[148:151], v[212:215], a[84:87], v[148:151]
    v_exp_f32 v41, v41
    v_mfma_f32_16x16x32_bf16 v[152:155], v[212:215], a[88:91], v[152:155]
    v_exp_f32 v42, v42
    v_mfma_f32_16x16x32_bf16 v[156:159], v[212:215], a[92:95], v[156:159]
    s_waitcnt lgkmcnt(2)
    v_mfma_f32_16x16x32_bf16 v[128:131], v[192:195], a[96:99], v[128:131]
    ds_read_b128 v[208:211], v248 offset:20480
    v_mfma_f32_16x16x32_bf16 v[132:135], v[192:195], a[100:103], v[132:135]
    ds_read_b128 v[212:215], v248 offset:21504
    v_mfma_f32_16x16x32_bf16 v[136:139], v[192:195], a[104:107], v[136:139]
    s_add_u32 m0, s31, 114688
    s_mov_b32 s47, 24576
    buffer_load_dwordx4 v250, s[52:55], s47 offen sc1 lds
    v_mfma_f32_16x16x32_bf16 v[140:143], v[192:195], a[108:111], v[140:143]
    v_exp_f32 v43, v43
    v_mfma_f32_16x16x32_bf16 v[144:147], v[196:199], a[96:99], v[144:147]
    v_fmac_f32 v56, v226, v220
    v_fmac_f32 v57, v226, v221
    v_mfma_f32_16x16x32_bf16 v[148:151], v[196:199], a[100:103], v[148:151]
    s_add_u32 m0, s31, 118784
    s_mov_b32 s47, 28672
    buffer_load_dwordx4 v250, s[52:55], s47 offen sc1 lds
    v_mfma_f32_16x16x32_bf16 v[152:155], v[196:199], a[104:107], v[152:155]
    v_fmac_f32 v58, v226, v222
    v_fmac_f32 v59, v226, v223
    v_mfma_f32_16x16x32_bf16 v[156:159], v[196:199], a[108:111], v[156:159]
    v_add_f32 v40, 1.0, v40
    s_waitcnt lgkmcnt(2)
    v_mfma_f32_16x16x32_bf16 v[128:131], v[200:203], a[112:115], v[128:131]
    ds_read_b128 v[192:195], v248 offset:22528
    v_add_f32 v41, 1.0, v41
    v_mfma_f32_16x16x32_bf16 v[132:135], v[200:203], a[116:119], v[132:135]
    ds_read_b128 v[196:199], v248 offset:23552
    v_add_f32 v42, 1.0, v42
    v_mfma_f32_16x16x32_bf16 v[136:139], v[200:203], a[120:123], v[136:139]
    v_add_f32 v43, 1.0, v43
    v_mfma_f32_16x16x32_bf16 v[140:143], v[200:203], a[124:127], v[140:143]
    s_add_u32 m0, s31, 122880
    s_mov_b32 s47, 32768
    buffer_load_dwordx4 v250, s[52:55], s47 offen sc1 lds
    v_mfma_f32_16x16x32_bf16 v[144:147], v[204:207], a[112:115], v[144:147]
    v_rcp_f32 v40, v40
    v_mfma_f32_16x16x32_bf16 v[148:151], v[204:207], a[116:119], v[148:151]
    v_rcp_f32 v41, v41
    v_mfma_f32_16x16x32_bf16 v[152:155], v[204:207], a[120:123], v[152:155]
    s_add_u32 m0, s31, 126976
    s_mov_b32 s47, 36864
    buffer_load_dwordx4 v250, s[52:55], s47 offen sc1 lds
    v_mfma_f32_16x16x32_bf16 v[156:159], v[204:207], a[124:127], v[156:159]
    s_waitcnt lgkmcnt(2)
    v_mfma_f32_16x16x32_bf16 v[128:131], v[208:211], a[128:131], v[128:131]
    ds_read_b128 v[200:203], v248 offset:24576
    v_mfma_f32_16x16x32_bf16 v[132:135], v[208:211], a[132:135], v[132:135]
    ds_read_b128 v[204:207], v248 offset:25600
    v_mfma_f32_16x16x32_bf16 v[136:139], v[208:211], a[136:139], v[136:139]
    v_rcp_f32 v42, v42
    v_mfma_f32_16x16x32_bf16 v[140:143], v[208:211], a[140:143], v[140:143]
    v_rcp_f32 v43, v43
    v_mfma_f32_16x16x32_bf16 v[144:147], v[212:215], a[128:131], v[144:147]
    s_add_u32 m0, s31, 131072
    s_mov_b32 s47, 40960
    buffer_load_dwordx4 v250, s[52:55], s47 offen sc1 lds
    v_mfma_f32_16x16x32_bf16 v[148:151], v[212:215], a[132:135], v[148:151]
    v_mul_f32 v56, v56, v40
    v_mul_f32 v57, v57, v41
    v_mfma_f32_16x16x32_bf16 v[152:155], v[212:215], a[136:139], v[152:155]
    v_mul_f32 v58, v58, v42
    v_mul_f32 v59, v59, v43
    v_mfma_f32_16x16x32_bf16 v[156:159], v[212:215], a[140:143], v[156:159]
    v_cvt_pk_bf16_f32 v240, v56, v57
    s_waitcnt lgkmcnt(2)
    v_mfma_f32_16x16x32_bf16 v[128:131], v[192:195], a[144:147], v[128:131]
    ds_read_b128 v[208:211], v248 offset:26624
    v_cvt_pk_bf16_f32 v241, v58, v59
    v_mfma_f32_16x16x32_bf16 v[132:135], v[192:195], a[148:151], v[132:135]
    ds_read_b128 v[212:215], v248 offset:27648
    v_fmac_f32 v44, v227, v216
    v_mfma_f32_16x16x32_bf16 v[136:139], v[192:195], a[152:155], v[136:139]
    s_add_u32 m0, s31, 135168
    s_mov_b32 s47, 45056
    buffer_load_dwordx4 v250, s[52:55], s47 offen sc1 lds
    v_mfma_f32_16x16x32_bf16 v[140:143], v[192:195], a[156:159], v[140:143]
    v_fmac_f32 v45, v227, v217
    v_fmac_f32 v46, v227, v218
    v_mfma_f32_16x16x32_bf16 v[144:147], v[196:199], a[144:147], v[144:147]
    v_fmac_f32 v47, v227, v219
    v_mul_f32 v44, v231, v44
    v_mfma_f32_16x16x32_bf16 v[148:151], v[196:199], a[148:151], v[148:151]
    s_add_u32 m0, s31, 139264
    s_mov_b32 s47, 49152
    buffer_load_dwordx4 v250, s[52:55], s47 offen sc1 lds
    v_mfma_f32_16x16x32_bf16 v[152:155], v[196:199], a[152:155], v[152:155]
    v_mul_f32 v45, v231, v45
    v_mul_f32 v46, v231, v46
    v_mfma_f32_16x16x32_bf16 v[156:159], v[196:199], a[156:159], v[156:159]
    v_mul_f32 v47, v231, v47
    s_waitcnt lgkmcnt(2)
    v_mfma_f32_16x16x32_bf16 v[128:131], v[200:203], a[160:163], v[128:131]
    s_waitcnt vmcnt(17)
    s_barrier
    v_mfma_f32_16x16x32_bf16 v[132:135], v[200:203], a[164:167], v[132:135]
    ds_read_b128 v[192:195], v248 offset:28672
    v_mfma_f32_16x16x32_bf16 v[136:139], v[200:203], a[168:171], v[136:139]
    ds_read_b128 v[196:199], v248 offset:29696
    v_mfma_f32_16x16x32_bf16 v[140:143], v[200:203], a[172:175], v[140:143]
    s_add_u32 m0, s31, 65536
    s_mov_b32 s40, 319488
    buffer_load_dwordx4 v250, s[12:15], s40 offen lds
    v_mfma_f32_16x16x32_bf16 v[144:147], v[204:207], a[160:163], v[144:147]
    s_add_u32 m0, s31, 69632
    s_mov_b32 s40, 323584
    buffer_load_dwordx4 v250, s[12:15], s40 offen lds
    v_mfma_f32_16x16x32_bf16 v[148:151], v[204:207], a[164:167], v[148:151]
    s_add_u32 m0, s31, 73728
    s_mov_b32 s40, 327680
    buffer_load_dwordx4 v250, s[12:15], s40 offen lds
    v_mfma_f32_16x16x32_bf16 v[152:155], v[204:207], a[168:171], v[152:155]
    s_add_u32 m0, s31, 77824
    s_mov_b32 s40, 331776
    buffer_load_dwordx4 v250, s[12:15], s40 offen lds
    v_mfma_f32_16x16x32_bf16 v[156:159], v[204:207], a[172:175], v[156:159]
    s_waitcnt lgkmcnt(2)
    v_mfma_f32_16x16x32_bf16 v[128:131], v[208:211], a[176:179], v[128:131]
    ds_read_b128 v[200:203], v248 offset:30720
    v_mfma_f32_16x16x32_bf16 v[132:135], v[208:211], a[180:183], v[132:135]
    ds_read_b128 v[204:207], v248 offset:31744
    v_mfma_f32_16x16x32_bf16 v[136:139], v[208:211], a[184:187], v[136:139]
    s_add_u32 m0, s31, 81920
    s_mov_b32 s40, 335872
    buffer_load_dwordx4 v250, s[12:15], s40 offen lds
    v_mfma_f32_16x16x32_bf16 v[140:143], v[208:211], a[188:191], v[140:143]
    s_add_u32 m0, s31, 86016
    s_mov_b32 s40, 339968
    buffer_load_dwordx4 v250, s[12:15], s40 offen lds
    v_mfma_f32_16x16x32_bf16 v[144:147], v[212:215], a[176:179], v[144:147]
    s_add_u32 m0, s31, 143360
    s_mov_b32 s47, 53248
    buffer_load_dwordx4 v250, s[52:55], s47 offen sc1 lds
    v_mfma_f32_16x16x32_bf16 v[148:151], v[212:215], a[180:183], v[148:151]
    v_exp_f32 v44, v44
    v_mfma_f32_16x16x32_bf16 v[152:155], v[212:215], a[184:187], v[152:155]
    v_exp_f32 v45, v45
    v_mfma_f32_16x16x32_bf16 v[156:159], v[212:215], a[188:191], v[156:159]
    s_waitcnt lgkmcnt(2)
    v_mfma_f32_16x16x32_bf16 v[128:131], v[192:195], a[192:195], v[128:131]
    ds_read_b128 v[208:211], v248 offset:32768
    v_mfma_f32_16x16x32_bf16 v[132:135], v[192:195], a[196:199], v[132:135]
    ds_read_b128 v[212:215], v248 offset:33792
    v_mfma_f32_16x16x32_bf16 v[136:139], v[192:195], a[200:203], v[136:139]
    s_add_u32 m0, s31, 147456
    s_mov_b32 s47, 57344
    buffer_load_dwordx4 v250, s[52:55], s47 offen sc1 lds
    v_mfma_f32_16x16x32_bf16 v[140:143], v[192:195], a[204:207], v[140:143]
    v_exp_f32 v46, v46
    v_mfma_f32_16x16x32_bf16 v[144:147], v[196:199], a[192:195], v[144:147]
    v_exp_f32 v47, v47
    v_mfma_f32_16x16x32_bf16 v[148:151], v[196:199], a[196:199], v[148:151]
    s_add_u32 m0, s31, 151552
    s_mov_b32 s47, 61440
    buffer_load_dwordx4 v250, s[52:55], s47 offen sc1 lds
    v_mfma_f32_16x16x32_bf16 v[152:155], v[196:199], a[200:203], v[152:155]
    v_fmac_f32 v60, v227, v220
    v_fmac_f32 v61, v227, v221
    v_mfma_f32_16x16x32_bf16 v[156:159], v[196:199], a[204:207], v[156:159]
    v_fmac_f32 v62, v227, v222
    s_waitcnt lgkmcnt(2)
    v_mfma_f32_16x16x32_bf16 v[128:131], v[200:203], a[208:211], v[128:131]
    ds_read_b128 v[192:195], v248 offset:34816
    v_fmac_f32 v63, v227, v223
    v_mfma_f32_16x16x32_bf16 v[132:135], v[200:203], a[212:215], v[132:135]
    ds_read_b128 v[196:199], v248 offset:35840
    v_add_f32 v44, 1.0, v44
    v_mfma_f32_16x16x32_bf16 v[136:139], v[200:203], a[216:219], v[136:139]
    v_add_f32 v45, 1.0, v45
    v_add_f32 v46, 1.0, v46
    v_mfma_f32_16x16x32_bf16 v[140:143], v[200:203], a[220:223], v[140:143]
    s_add_u32 m0, s31, 155648
    s_mov_b32 s47, 65536
    buffer_load_dwordx4 v250, s[52:55], s47 offen sc1 lds
    v_mfma_f32_16x16x32_bf16 v[144:147], v[204:207], a[208:211], v[144:147]
    v_add_f32 v47, 1.0, v47
    v_mfma_f32_16x16x32_bf16 v[148:151], v[204:207], a[212:215], v[148:151]
    v_rcp_f32 v44, v44
    v_mfma_f32_16x16x32_bf16 v[152:155], v[204:207], a[216:219], v[152:155]
    s_add_u32 m0, s31, 159744
    s_mov_b32 s47, 69632
    buffer_load_dwordx4 v250, s[52:55], s47 offen sc1 lds
    v_mfma_f32_16x16x32_bf16 v[156:159], v[204:207], a[220:223], v[156:159]
    s_waitcnt lgkmcnt(2)
    v_mfma_f32_16x16x32_bf16 v[128:131], v[208:211], a[224:227], v[128:131]
    ds_read_b128 v[200:203], v248 offset:36864
    v_mfma_f32_16x16x32_bf16 v[132:135], v[208:211], a[228:231], v[132:135]
    ds_read_b128 v[204:207], v248 offset:37888
    v_mfma_f32_16x16x32_bf16 v[136:139], v[208:211], a[232:235], v[136:139]
    v_rcp_f32 v45, v45
    v_mfma_f32_16x16x32_bf16 v[140:143], v[208:211], a[236:239], v[140:143]
    v_rcp_f32 v46, v46
    v_mfma_f32_16x16x32_bf16 v[144:147], v[212:215], a[224:227], v[144:147]
    v_rcp_f32 v47, v47
    v_mfma_f32_16x16x32_bf16 v[148:151], v[212:215], a[228:231], v[148:151]
    v_mul_f32 v60, v60, v44
    v_mul_f32 v61, v61, v45
    v_mfma_f32_16x16x32_bf16 v[152:155], v[212:215], a[232:235], v[152:155]
    v_mul_f32 v62, v62, v46
    v_mul_f32 v63, v63, v47
    v_mfma_f32_16x16x32_bf16 v[156:159], v[212:215], a[236:239], v[156:159]
    v_cvt_pk_bf16_f32 v244, v60, v61
    s_waitcnt lgkmcnt(2)
    v_mfma_f32_16x16x32_bf16 v[128:131], v[192:195], a[240:243], v[128:131]
    ds_read_b128 v[208:211], v248 offset:38912
    v_cvt_pk_bf16_f32 v245, v62, v63
    v_mfma_f32_16x16x32_bf16 v[132:135], v[192:195], a[244:247], v[132:135]
    ds_read_b128 v[212:215], v248 offset:39936
    ds_read_b128 v[216:219], v251 offset:640
    v_mfma_f32_16x16x32_bf16 v[136:139], v[192:195], a[248:251], v[136:139]
    ds_read_b128 v[220:223], v251 offset:704
    s_waitcnt lgkmcnt(0)
    v_mfma_f32_16x16x32_bf16 v[140:143], v[192:195], a[252:255], v[140:143]
    v_fmac_f32 v64, v224, v216
    v_fmac_f32 v65, v224, v217
    v_mfma_f32_16x16x32_bf16 v[144:147], v[196:199], a[240:243], v[144:147]
    v_fmac_f32 v66, v224, v218
    v_fmac_f32 v67, v224, v219
    v_mfma_f32_16x16x32_bf16 v[148:151], v[196:199], a[244:247], v[148:151]
    v_mul_f32 v64, v228, v64
    v_mul_f32 v65, v228, v65
    v_mfma_f32_16x16x32_bf16 v[152:155], v[196:199], a[248:251], v[152:155]
    v_mul_f32 v66, v228, v66
    v_mul_f32 v67, v228, v67
    v_mfma_f32_16x16x32_bf16 v[156:159], v[196:199], a[252:255], v[156:159]
    v_mfma_f32_16x16x32_bf16 v[128:131], v[200:203], v[0:3], v[128:131]
    ds_read_b128 v[192:195], v248 offset:40960
    v_mfma_f32_16x16x32_bf16 v[132:135], v[200:203], v[4:7], v[132:135]
    ds_read_b128 v[196:199], v248 offset:41984
    v_mfma_f32_16x16x32_bf16 v[136:139], v[200:203], v[8:11], v[136:139]
    v_exp_f32 v64, v64
    v_mfma_f32_16x16x32_bf16 v[140:143], v[200:203], v[12:15], v[140:143]
    v_exp_f32 v65, v65
    v_mfma_f32_16x16x32_bf16 v[144:147], v[204:207], v[0:3], v[144:147]
    v_exp_f32 v66, v66
    v_mfma_f32_16x16x32_bf16 v[148:151], v[204:207], v[4:7], v[148:151]
    v_exp_f32 v67, v67
    v_mfma_f32_16x16x32_bf16 v[152:155], v[204:207], v[8:11], v[152:155]
    v_fmac_f32 v80, v224, v220
    v_fmac_f32 v81, v224, v221
    v_mfma_f32_16x16x32_bf16 v[156:159], v[204:207], v[12:15], v[156:159]
    v_fmac_f32 v82, v224, v222
    v_mfma_f32_16x16x32_bf16 v[128:131], v[208:211], v[16:19], v[128:131]
    ds_read_b128 v[200:203], v248 offset:43008
    v_fmac_f32 v83, v224, v223
    v_mfma_f32_16x16x32_bf16 v[132:135], v[208:211], v[20:23], v[132:135]
    ds_read_b128 v[204:207], v248 offset:44032
    v_add_f32 v64, 1.0, v64
    v_mfma_f32_16x16x32_bf16 v[136:139], v[208:211], v[24:27], v[136:139]
    v_add_f32 v65, 1.0, v65
    v_add_f32 v66, 1.0, v66
    v_mfma_f32_16x16x32_bf16 v[140:143], v[208:211], v[28:31], v[140:143]
    v_add_f32 v67, 1.0, v67
    v_mfma_f32_16x16x32_bf16 v[144:147], v[212:215], v[16:19], v[144:147]
    v_rcp_f32 v64, v64
    v_mfma_f32_16x16x32_bf16 v[148:151], v[212:215], v[20:23], v[148:151]
    v_rcp_f32 v65, v65
    v_mfma_f32_16x16x32_bf16 v[152:155], v[212:215], v[24:27], v[152:155]
    v_rcp_f32 v66, v66
    v_mfma_f32_16x16x32_bf16 v[156:159], v[212:215], v[28:31], v[156:159]
    s_waitcnt lgkmcnt(2)
    v_mfma_f32_16x16x32_bf16 v[32:35], v[192:195], a[0:3], 0
    ds_read_b128 v[208:211], v248 offset:45056
    v_mfma_f32_16x16x32_bf16 v[36:39], v[192:195], a[4:7], 0
    ds_read_b128 v[212:215], v248 offset:46080
    v_mfma_f32_16x16x32_bf16 v[48:51], v[196:199], a[0:3], 0
    v_rcp_f32 v67, v67
    v_mfma_f32_16x16x32_bf16 v[52:55], v[196:199], a[4:7], 0
    v_mul_f32 v80, v80, v64
    s_waitcnt lgkmcnt(2)
    v_mfma_f32_16x16x32_bf16 v[32:35], v[200:203], a[16:19], v[32:35]
    ds_read_b128 v[192:195], v248 offset:47104
    v_mul_f32 v81, v81, v65
    v_mfma_f32_16x16x32_bf16 v[36:39], v[200:203], a[20:23], v[36:39]
    ds_read_b128 v[196:199], v248 offset:48128
    v_mul_f32 v82, v82, v66
    v_mfma_f32_16x16x32_bf16 v[48:51], v[204:207], a[16:19], v[48:51]
    v_mul_f32 v83, v83, v67
    v_cvt_pk_bf16_f32 v234, v80, v81
    v_mfma_f32_16x16x32_bf16 v[52:55], v[204:207], a[20:23], v[52:55]
    v_cvt_pk_bf16_f32 v235, v82, v83
    s_waitcnt lgkmcnt(2)
    v_mfma_f32_16x16x32_bf16 v[32:35], v[208:211], a[32:35], v[32:35]
    ds_read_b128 v[200:203], v248 offset:49152
    v_cmp_gt_u32 vcc, 2, v171
    s_nop 0
    s_cmp_eq_u64 vcc, 0
    s_cbranch_scc1 L_fk_kernel_r01_ok
    s_mov_b32 s43, 0x10000
L_fk_kernel_r01_spin:
    buffer_load_dword v171, v170, s[48:51], 0 offen sc1
    s_waitcnt vmcnt(0)
    v_cmp_gt_u32 vcc, 2, v171
    s_nop 0
    s_cmp_eq_u64 vcc, 0
    s_cbranch_scc1 L_fk_kernel_r01_ok
    s_sleep 1
    s_sub_u32 s43, s43, 1
    s_cmp_lg_u32 s43, 0
    s_cbranch_scc1 L_fk_kernel_r01_spin
L_fk_kernel_r01_ok:
    s_add_u32 s42, s45, 8192
    v_mfma_f32_16x16x32_bf16 v[36:39], v[208:211], a[36:39], v[36:39]
    ds_read_b128 v[204:207], v248 offset:50176
    buffer_store_dwordx4 v[232:235], v252, s[16:19], s42 offen offset:0 sc1
    v_mfma_f32_16x16x32_bf16 v[48:51], v[212:215], a[32:35], v[48:51]
    v_fmac_f32 v68, v225, v216
    v_fmac_f32 v69, v225, v217
    v_mfma_f32_16x16x32_bf16 v[52:55], v[212:215], a[36:39], v[52:55]
    v_fmac_f32 v70, v225, v218
    s_waitcnt lgkmcnt(2)
    v_mfma_f32_16x16x32_bf16 v[32:35], v[192:195], a[48:51], v[32:35]
    ds_read_b128 v[208:211], v248 offset:51200
    v_fmac_f32 v71, v225, v219
    v_mfma_f32_16x16x32_bf16 v[36:39], v[192:195], a[52:55], v[36:39]
    ds_read_b128 v[212:215], v248 offset:52224
    v_mul_f32 v68, v229, v68
    v_mfma_f32_16x16x32_bf16 v[48:51], v[196:199], a[48:51], v[48:51]
    s_mov_b32 s47, 0
    buffer_load_dwordx4 a[8:11], v164, s[8:11], s47 offen offset:0 sc1
    buffer_load_dwordx4 a[12:15], v164, s[8:11], s47 offen offset:1024 sc1
    v_mfma_f32_16x16x32_bf16 v[52:55], v[196:199], a[52:55], v[52:55]
    v_mul_f32 v69, v229, v69
    s_waitcnt lgkmcnt(2)
    v_mfma_f32_16x16x32_bf16 v[32:35], v[200:203], a[64:67], v[32:35]
    s_waitcnt vmcnt(11)
    s_barrier
    v_mfma_f32_16x16x32_bf16 v[36:39], v[200:203], a[68:71], v[36:39]
    ds_read_b128 v[192:195], v248 offset:53248
    v_mul_f32 v70, v229, v70
    v_mfma_f32_16x16x32_bf16 v[48:51], v[204:207], a[64:67], v[48:51]
    ds_read_b128 v[196:199], v248 offset:54272
    v_mul_f32 v71, v229, v71
    v_mfma_f32_16x16x32_bf16 v[52:55], v[204:207], a[68:71], v[52:55]
    s_waitcnt lgkmcnt(2)
    v_mfma_f32_16x16x32_bf16 v[32:35], v[208:211], a[80:83], v[32:35]
    ds_read_b128 v[200:203], v248 offset:55296
    v_mfma_f32_16x16x32_bf16 v[36:39], v[208:211], a[84:87], v[36:39]
    ds_read_b128 v[204:207], v248 offset:56320
    v_mfma_f32_16x16x32_bf16 v[48:51], v[212:215], a[80:83], v[48:51]
    s_add_u32 m0, s31, 4096
    s_mov_b32 s40, 344064
    buffer_load_dwordx4 v250, s[12:15], s40 offen lds
    v_mfma_f32_16x16x32_bf16 v[52:55], v[212:215], a[84:87], v[52:55]
    s_waitcnt lgkmcnt(2)
    v_mfma_f32_16x16x32_bf16 v[32:35], v[192:195], a[96:99], v[32:35]
    ds_read_b128 v[208:211], v248 offset:57344
    v_mfma_f32_16x16x32_bf16 v[36:39], v[192:195], a[100:103], v[36:39]
    ds_read_b128 v[212:215], v248 offset:58368
    v_mfma_f32_16x16x32_bf16 v[48:51], v[196:199], a[96:99], v[48:51]
    s_add_u32 m0, s31, 8192
    s_mov_b32 s40, 348160
    buffer_load_dwordx4 v250, s[12:15], s40 offen lds
    v_mfma_f32_16x16x32_bf16 v[52:55], v[196:199], a[100:103], v[52:55]
    s_waitcnt lgkmcnt(2)
    v_mfma_f32_16x16x32_bf16 v[32:35], v[200:203], a[112:115], v[32:35]
    ds_read_b128 v[192:195], v248 offset:59392
    v_mfma_f32_16x16x32_bf16 v[36:39], v[200:203], a[116:119], v[36:39]
    ds_read_b128 v[196:199], v248 offset:60416
    v_mfma_f32_16x16x32_bf16 v[48:51], v[204:207], a[112:115], v[48:51]
    s_add_u32 m0, s31, 12288
    s_mov_b32 s40, 352256
    buffer_load_dwordx4 v250, s[12:15], s40 offen lds
    v_mfma_f32_16x16x32_bf16 v[52:55], v[204:207], a[116:119], v[52:55]
    s_waitcnt lgkmcnt(2)
    v_mfma_f32_16x16x32_bf16 v[32:35], v[208:211], a[128:131], v[32:35]
    ds_read_b128 v[200:203], v248 offset:61440
    v_mfma_f32_16x16x32_bf16 v[36:39], v[208:211], a[132:135], v[36:39]
    ds_read_b128 v[204:207], v248 offset:62464
    v_mfma_f32_16x16x32_bf16 v[48:51], v[212:215], a[128:131], v[48:51]
    s_add_u32 m0, s31, 16384
    s_mov_b32 s40, 356352
    buffer_load_dwordx4 v250, s[12:15], s40 offen lds
    v_mfma_f32_16x16x32_bf16 v[52:55], v[212:215], a[132:135], v[52:55]
    s_waitcnt lgkmcnt(2)
    v_mfma_f32_16x16x32_bf16 v[32:35], v[192:195], a[144:147], v[32:35]
    ds_read_b128 v[208:211], v248 offset:63488
    v_mfma_f32_16x16x32_bf16 v[36:39], v[192:195], a[148:151], v[36:39]
    ds_read_b128 v[212:215], v248 offset:64512
    v_mfma_f32_16x16x32_bf16 v[48:51], v[196:199], a[144:147], v[48:51]
    s_add_u32 m0, s31, 20480
    s_mov_b32 s40, 360448
    buffer_load_dwordx4 v250, s[12:15], s40 offen lds
    v_mfma_f32_16x16x32_bf16 v[52:55], v[196:199], a[148:151], v[52:55]
    s_waitcnt lgkmcnt(2)
    v_mfma_f32_16x16x32_bf16 v[32:35], v[200:203], a[160:163], v[32:35]
    ds_read_b128 v[192:195], v249 offset:0
    v_mfma_f32_16x16x32_bf16 v[36:39], v[200:203], a[164:167], v[36:39]
    ds_read_b128 v[196:199], v249 offset:1024
    v_mfma_f32_16x16x32_bf16 v[48:51], v[204:207], a[160:163], v[48:51]
    s_add_u32 m0, s31, 24576
    s_mov_b32 s40, 364544
    buffer_load_dwordx4 v250, s[12:15], s40 offen lds
    v_mfma_f32_16x16x32_bf16 v[52:55], v[204:207], a[164:167], v[52:55]
    s_waitcnt lgkmcnt(2)
    v_mfma_f32_16x16x32_bf16 v[32:35], v[208:211], a[176:179], v[32:35]
    ds_read_b128 v[200:203], v249 offset:2048
    v_mfma_f32_16x16x32_bf16 v[36:39], v[208:211], a[180:183], v[36:39]
    ds_read_b128 v[204:207], v249 offset:3072
    v_mfma_f32_16x16x32_bf16 v[48:51], v[212:215], a[176:179], v[48:51]
    v_exp_f32 v68, v68
    v_mfma_f32_16x16x32_bf16 v[52:55], v[212:215], a[180:183], v[52:55]
    s_waitcnt lgkmcnt(2)
    v_mfma_f32_16x16x32_bf16 v[32:35], v[192:195], a[192:195], v[32:35]
    ds_read_b128 v[208:211], v249 offset:4096
    v_mfma_f32_16x16x32_bf16 v[36:39], v[192:195], a[196:199], v[36:39]
    ds_read_b128 v[212:215], v249 offset:5120
    v_mfma_f32_16x16x32_bf16 v[48:51], v[196:199], a[192:195], v[48:51]
    s_mov_b32 s47, 20480
    buffer_load_dwordx4 a[24:27], v164, s[8:11], s47 offen offset:0 sc1
    buffer_load_dwordx4 a[28:31], v164, s[8:11], s47 offen offset:1024 sc1
    v_mfma_f32_16x16x32_bf16 v[52:55], v[196:199], a[196:199], v[52:55]
    s_waitcnt lgkmcnt(2)
    v_mfma_f32_16x16x32_bf16 v[32:35], v[200:203], a[208:211], v[32:35]
    ds_read_b128 v[192:195], v249 offset:6144
    v_mfma_f32_16x16x32_bf16 v[36:39], v[200:203], a[212:215], v[36:39]
    ds_read_b128 v[196:199], v249 offset:7168
    v_mfma_f32_16x16x32_bf16 v[48:51], v[204:207], a[208:211], v[48:51]
    v_exp_f32 v69, v69
    v_mfma_f32_16x16x32_bf16 v[52:55], v[204:207], a[212:215], v[52:55]
    s_waitcnt lgkmcnt(2)
    v_mfma_f32_16x16x32_bf16 v[32:35], v[208:211], a[224:227], v[32:35]
    ds_read_b128 v[200:203], v249 offset:8192
    v_mfma_f32_16x16x32_bf16 v[36:39], v[208:211], a[228:231], v[36:39]
    ds_read_b128 v[204:207], v249 offset:9216
    v_mfma_f32_16x16x32_bf16 v[48:51], v[212:215], a[224:227], v[48:51]
    v_exp_f32 v70, v70
    v_mfma_f32_16x16x32_bf16 v[52:55], v[212:215], a[228:231], v[52:55]
    s_waitcnt lgkmcnt(2)
    v_mfma_f32_16x16x32_bf16 v[32:35], v[192:195], a[240:243], v[32:35]
    ds_read_b128 v[208:211], v249 offset:10240
    v_mfma_f32_16x16x32_bf16 v[36:39], v[192:195], a[244:247], v[36:39]
    ds_read_b128 v[212:215], v249 offset:11264
    v_mfma_f32_16x16x32_bf16 v[48:51], v[196:199], a[240:243], v[48:51]
    s_mov_b32 s47, 36864
    buffer_load_dwordx4 a[40:43], v164, s[8:11], s47 offen offset:0 sc1
    buffer_load_dwordx4 a[44:47], v164, s[8:11], s47 offen offset:1024 sc1
    v_mfma_f32_16x16x32_bf16 v[52:55], v[196:199], a[244:247], v[52:55]
    s_waitcnt lgkmcnt(2)
    v_mfma_f32_16x16x32_bf16 v[32:35], v[200:203], v[0:3], v[32:35]
    s_waitcnt vmcnt(7)
    s_barrier
    v_mfma_f32_16x16x32_bf16 v[36:39], v[200:203], v[4:7], v[36:39]
    ds_read_b128 v[192:195], v249 offset:12288
    v_mfma_f32_16x16x32_bf16 v[48:51], v[204:207], v[0:3], v[48:51]
    ds_read_b128 v[196:199], v249 offset:13312
    v_mfma_f32_16x16x32_bf16 v[52:55], v[204:207], v[4:7], v[52:55]
    s_waitcnt lgkmcnt(2)
    v_mfma_f32_16x16x32_bf16 v[32:35], v[208:211], v[16:19], v[32:35]
    ds_read_b128 v[200:203], v249 offset:14336
    v_mfma_f32_16x16x32_bf16 v[36:39], v[208:211], v[20:23], v[36:39]
    ds_read_b128 v[204:207], v249 offset:15360
    v_mfma_f32_16x16x32_bf16 v[48:51], v[212:215], v[16:19], v[48:51]
    v_exp_f32 v71, v71
    v_mfma_f32_16x16x32_bf16 v[52:55], v[212:215], v[20:23], v[52:55]
    v_fmac_f32 v84, v225, v220
    v_fmac_f32 v85, v225, v221
    v_fmac_f32 v86, v225, v222
    v_fmac_f32 v87, v225, v223
    v_add_f32 v68, 1.0, v68
    v_add_f32 v69, 1.0, v69
    v_add_f32 v70, 1.0, v70
    v_add_f32 v71, 1.0, v71
    v_rcp_f32 v68, v68
    v_rcp_f32 v69, v69
    v_rcp_f32 v70, v70
    v_rcp_f32 v71, v71
    v_mul_f32 v84, v84, v68
    v_mul_f32 v85, v85, v69
    v_mul_f32 v86, v86, v70
    v_mul_f32 v87, v87, v71
    v_cvt_pk_bf16_f32 v238, v84, v85
    v_cvt_pk_bf16_f32 v239, v86, v87
    buffer_store_dwordx4 v[236:239], v252, s[16:19], s42 offen offset:1024 sc1
    v_fmac_f32 v72, v226, v216
    v_fmac_f32 v73, v226, v217
    v_fmac_f32 v74, v226, v218
    v_fmac_f32 v75, v226, v219
    v_mul_f32 v72, v230, v72
    v_mul_f32 v73, v230, v73
    v_mul_f32 v74, v230, v74
    v_mul_f32 v75, v230, v75
    v_exp_f32 v72, v72
    v_exp_f32 v73, v73
    v_exp_f32 v74, v74
    v_exp_f32 v75, v75
    v_fmac_f32 v88, v226, v220
    v_fmac_f32 v89, v226, v221
    v_fmac_f32 v90, v226, v222
    v_fmac_f32 v91, v226, v223
    v_add_f32 v72, 1.0, v72
    v_add_f32 v73, 1.0, v73
    v_add_f32 v74, 1.0, v74
    v_add_f32 v75, 1.0, v75
    v_rcp_f32 v72, v72
    v_rcp_f32 v73, v73
    v_rcp_f32 v74, v74
    v_rcp_f32 v75, v75
    v_mul_f32 v88, v88, v72
    v_mul_f32 v89, v89, v73
    v_mul_f32 v90, v90, v74
    v_mul_f32 v91, v91, v75
    v_cvt_pk_bf16_f32 v242, v88, v89
    v_cvt_pk_bf16_f32 v243, v90, v91
    buffer_store_dwordx4 v[240:243], v253, s[16:19], s42 offen offset:0 sc1
    v_fmac_f32 v76, v227, v216
    v_fmac_f32 v77, v227, v217
    v_fmac_f32 v78, v227, v218
    v_fmac_f32 v79, v227, v219
    v_mul_f32 v76, v231, v76
    v_mul_f32 v77, v231, v77
    v_mul_f32 v78, v231, v78
    v_mul_f32 v79, v231, v79
    v_exp_f32 v76, v76
    v_exp_f32 v77, v77
    v_exp_f32 v78, v78
    v_exp_f32 v79, v79
    v_fmac_f32 v92, v227, v220
    v_fmac_f32 v93, v227, v221
    v_fmac_f32 v94, v227, v222
    v_fmac_f32 v95, v227, v223
    v_add_f32 v76, 1.0, v76
    v_add_f32 v77, 1.0, v77
    v_add_f32 v78, 1.0, v78
    v_add_f32 v79, 1.0, v79
    v_rcp_f32 v76, v76
    v_rcp_f32 v77, v77
    v_rcp_f32 v78, v78
    v_rcp_f32 v79, v79
    v_mul_f32 v92, v92, v76
    v_mul_f32 v93, v93, v77
    v_mul_f32 v94, v94, v78
    v_mul_f32 v95, v95, v79
    v_cvt_pk_bf16_f32 v246, v92, v93
    v_cvt_pk_bf16_f32 v247, v94, v95
    buffer_store_dwordx4 v[244:247], v253, s[16:19], s42 offen offset:1024 sc1
    s_waitcnt lgkmcnt(2)
    v_mfma_f32_16x16x32_bf16 v[64:67], v[192:195], a[0:3], 0
    ds_read_b128 v[208:211], v249 offset:16384
    ds_read_b128 v[216:219], v251 offset:768
    v_mfma_f32_16x16x32_bf16 v[68:71], v[192:195], a[4:7], 0
    ds_read_b128 v[212:215], v249 offset:17408
    ds_read_b128 v[220:223], v251 offset:832
    v_mfma_f32_16x16x32_bf16 v[80:83], v[196:199], a[0:3], 0
    s_mov_b32 s47, 57344
    buffer_load_dwordx4 a[56:59], v164, s[8:11], s47 offen offset:0 sc1
    buffer_load_dwordx4 a[60:63], v164, s[8:11], s47 offen offset:1024 sc1
    v_mfma_f32_16x16x32_bf16 v[84:87], v[196:199], a[4:7], 0
    s_waitcnt lgkmcnt(0)
    v_mfma_f32_16x16x32_bf16 v[64:67], v[200:203], a[16:19], v[64:67]
    ds_read_b128 v[192:195], v249 offset:18432
    v_fmac_f32 v96, v224, v216
    v_mfma_f32_16x16x32_bf16 v[68:71], v[200:203], a[20:23], v[68:71]
    ds_read_b128 v[196:199], v249 offset:19456
    v_fmac_f32 v97, v224, v217
    v_mfma_f32_16x16x32_bf16 v[80:83], v[204:207], a[16:19], v[80:83]
    v_fmac_f32 v98, v224, v218
    v_fmac_f32 v99, v224, v219
    v_mfma_f32_16x16x32_bf16 v[84:87], v[204:207], a[20:23], v[84:87]
    v_mul_f32 v96, v228, v96
    v_mfma_f32_16x16x32_bf16 v[64:67], v[208:211], a[32:35], v[64:67]
    ds_read_b128 v[200:203], v249 offset:20480
    v_mul_f32 v97, v228, v97
    v_mfma_f32_16x16x32_bf16 v[68:71], v[208:211], a[36:39], v[68:71]
    ds_read_b128 v[204:207], v249 offset:21504
    v_mul_f32 v98, v228, v98
    v_mfma_f32_16x16x32_bf16 v[80:83], v[212:215], a[32:35], v[80:83]
    v_mul_f32 v99, v228, v99
    v_mfma_f32_16x16x32_bf16 v[84:87], v[212:215], a[36:39], v[84:87]
    s_waitcnt lgkmcnt(2)
    v_mfma_f32_16x16x32_bf16 v[64:67], v[192:195], a[48:51], v[64:67]
    ds_read_b128 v[208:211], v249 offset:22528
    v_mfma_f32_16x16x32_bf16 v[68:71], v[192:195], a[52:55], v[68:71]
    ds_read_b128 v[212:215], v249 offset:23552
    v_mfma_f32_16x16x32_bf16 v[80:83], v[196:199], a[48:51], v[80:83]
    s_mov_b32 s47, 73728
    buffer_load_dwordx4 a[72:75], v164, s[8:11], s47 offen offset:0 sc1
    buffer_load_dwordx4 a[76:79], v164, s[8:11], s47 offen offset:1024 sc1
    v_mfma_f32_16x16x32_bf16 v[84:87], v[196:199], a[52:55], v[84:87]
    s_waitcnt lgkmcnt(2)
    v_mfma_f32_16x16x32_bf16 v[64:67], v[200:203], a[64:67], v[64:67]
    ds_read_b128 v[192:195], v248 offset:4096
    v_mfma_f32_16x16x32_bf16 v[68:71], v[200:203], a[68:71], v[68:71]
    ds_read_b128 v[196:199], v248 offset:5120
    v_mfma_f32_16x16x32_bf16 v[80:83], v[204:207], a[64:67], v[80:83]
    v_exp_f32 v96, v96
    v_mfma_f32_16x16x32_bf16 v[84:87], v[204:207], a[68:71], v[84:87]
    s_waitcnt lgkmcnt(2)
    v_mfma_f32_16x16x32_bf16 v[64:67], v[208:211], a[80:83], v[64:67]
    ds_read_b128 v[200:203], v248 offset:6144
    v_mfma_f32_16x16x32_bf16 v[68:71], v[208:211], a[84:87], v[68:71]
    ds_read_b128 v[204:207], v248 offset:7168
    v_mfma_f32_16x16x32_bf16 v[80:83], v[212:215], a[80:83], v[80:83]
    v_exp_f32 v97, v97
    v_mfma_f32_16x16x32_bf16 v[84:87], v[212:215], a[84:87], v[84:87]
    s_waitcnt lgkmcnt(2)
    v_mfma_f32_16x16x32_bf16 v[64:67], v[192:195], a[96:99], v[64:67]
    ds_read_b128 v[208:211], v248 offset:8192
    v_mfma_f32_16x16x32_bf16 v[68:71], v[192:195], a[100:103], v[68:71]
    ds_read_b128 v[212:215], v248 offset:9216
    v_mfma_f32_16x16x32_bf16 v[80:83], v[196:199], a[96:99], v[80:83]
    s_mov_b32 s47, 94208
    buffer_load_dwordx4 a[88:91], v164, s[8:11], s47 offen offset:0 sc1
    buffer_load_dwordx4 a[92:95], v164, s[8:11], s47 offen offset:1024 sc1
    v_mfma_f32_16x16x32_bf16 v[84:87], v[196:199], a[100:103], v[84:87]
    s_waitcnt lgkmcnt(2)
    v_mfma_f32_16x16x32_bf16 v[64:67], v[200:203], a[112:115], v[64:67]
    ds_read_b128 v[192:195], v248 offset:10240
    v_mfma_f32_16x16x32_bf16 v[68:71], v[200:203], a[116:119], v[68:71]
    ds_read_b128 v[196:199], v248 offset:11264
    v_mfma_f32_16x16x32_bf16 v[80:83], v[204:207], a[112:115], v[80:83]
    v_exp_f32 v98, v98
    v_mfma_f32_16x16x32_bf16 v[84:87], v[204:207], a[116:119], v[84:87]
    s_waitcnt lgkmcnt(2)
    v_mfma_f32_16x16x32_bf16 v[64:67], v[208:211], a[128:131], v[64:67]
    ds_read_b128 v[200:203], v248 offset:12288
    v_mfma_f32_16x16x32_bf16 v[68:71], v[208:211], a[132:135], v[68:71]
    ds_read_b128 v[204:207], v248 offset:13312
    v_mfma_f32_16x16x32_bf16 v[80:83], v[212:215], a[128:131], v[80:83]
    v_exp_f32 v99, v99
    v_mfma_f32_16x16x32_bf16 v[84:87], v[212:215], a[132:135], v[84:87]
    v_fmac_f32 v112, v224, v220
    s_waitcnt lgkmcnt(2)
    v_mfma_f32_16x16x32_bf16 v[64:67], v[192:195], a[144:147], v[64:67]
    ds_read_b128 v[208:211], v248 offset:14336
    v_fmac_f32 v113, v224, v221
    v_mfma_f32_16x16x32_bf16 v[68:71], v[192:195], a[148:151], v[68:71]
    ds_read_b128 v[212:215], v248 offset:15360
    v_fmac_f32 v114, v224, v222
    v_mfma_f32_16x16x32_bf16 v[80:83], v[196:199], a[144:147], v[80:83]
    s_mov_b32 s47, 110592
    buffer_load_dwordx4 a[104:107], v164, s[8:11], s47 offen offset:0 sc1
    buffer_load_dwordx4 a[108:111], v164, s[8:11], s47 offen offset:1024 sc1
    v_mfma_f32_16x16x32_bf16 v[84:87], v[196:199], a[148:151], v[84:87]
    v_fmac_f32 v115, v224, v223
    s_waitcnt lgkmcnt(2)
    v_mfma_f32_16x16x32_bf16 v[64:67], v[200:203], a[160:163], v[64:67]
    s_waitcnt vmcnt(15)
    s_barrier
    v_mfma_f32_16x16x32_bf16 v[68:71], v[200:203], a[164:167], v[68:71]
    ds_read_b128 v[192:195], v248 offset:16384
    v_add_f32 v96, 1.0, v96
    v_mfma_f32_16x16x32_bf16 v[80:83], v[204:207], a[160:163], v[80:83]
    ds_read_b128 v[196:199], v248 offset:17408
    v_add_f32 v97, 1.0, v97
    v_mfma_f32_16x16x32_bf16 v[84:87], v[204:207], a[164:167], v[84:87]
    v_add_f32 v98, 1.0, v98
    s_waitcnt lgkmcnt(2)
    v_mfma_f32_16x16x32_bf16 v[64:67], v[208:211], a[176:179], v[64:67]
    ds_read_b128 v[200:203], v248 offset:18432
    v_add_f32 v99, 1.0, v99
    v_mfma_f32_16x16x32_bf16 v[68:71], v[208:211], a[180:183], v[68:71]
    ds_read_b128 v[204:207], v248 offset:19456
    v_mfma_f32_16x16x32_bf16 v[80:83], v[212:215], a[176:179], v[80:83]
    v_rcp_f32 v96, v96
    v_mfma_f32_16x16x32_bf16 v[84:87], v[212:215], a[180:183], v[84:87]
    s_waitcnt lgkmcnt(2)
    v_mfma_f32_16x16x32_bf16 v[64:67], v[192:195], a[192:195], v[64:67]
    ds_read_b128 v[208:211], v248 offset:20480
    v_mfma_f32_16x16x32_bf16 v[68:71], v[192:195], a[196:199], v[68:71]
    ds_read_b128 v[212:215], v248 offset:21504
    v_mfma_f32_16x16x32_bf16 v[80:83], v[196:199], a[192:195], v[80:83]
    s_mov_b32 s47, 131072
    buffer_load_dwordx4 a[120:123], v164, s[8:11], s47 offen offset:0 sc1
    buffer_load_dwordx4 a[124:127], v164, s[8:11], s47 offen offset:1024 sc1
    v_mfma_f32_16x16x32_bf16 v[84:87], v[196:199], a[196:199], v[84:87]
    s_waitcnt lgkmcnt(2)
    v_mfma_f32_16x16x32_bf16 v[64:67], v[200:203], a[208:211], v[64:67]
    ds_read_b128 v[192:195], v248 offset:22528
    v_mfma_f32_16x16x32_bf16 v[68:71], v[200:203], a[212:215], v[68:71]
    ds_read_b128 v[196:199], v248 offset:23552
    v_mfma_f32_16x16x32_bf16 v[80:83], v[204:207], a[208:211], v[80:83]
    v_rcp_f32 v97, v97
    v_mfma_f32_16x16x32_bf16 v[84:87], v[204:207], a[212:215], v[84:87]
    s_waitcnt lgkmcnt(2)
    v_mfma_f32_16x16x32_bf16 v[64:67], v[208:211], a[224:227], v[64:67]
    ds_read_b128 v[200:203], v248 offset:24576
    v_mfma_f32_16x16x32_bf16 v[68:71], v[208:211], a[228:231], v[68:71]
    ds_read_b128 v[204:207], v248 offset:25600
    v_mfma_f32_16x16x32_bf16 v[80:83], v[212:215], a[224:227], v[80:83]
    v_rcp_f32 v98, v98
    v_mfma_f32_16x16x32_bf16 v[84:87], v[212:215], a[228:231], v[84:87]
    s_waitcnt lgkmcnt(2)
    v_mfma_f32_16x16x32_bf16 v[64:67], v[192:195], a[240:243], v[64:67]
    ds_read_b128 v[208:211], v248 offset:26624
    v_mfma_f32_16x16x32_bf16 v[68:71], v[192:195], a[244:247], v[68:71]
    ds_read_b128 v[212:215], v248 offset:27648
    v_mfma_f32_16x16x32_bf16 v[80:83], v[196:199], a[240:243], v[80:83]
    s_mov_b32 s47, 4096
    buffer_load_dwordx4 a[136:139], v164, s[8:11], s47 offen offset:0 sc1
    buffer_load_dwordx4 a[140:143], v164, s[8:11], s47 offen offset:1024 sc1
    v_mfma_f32_16x16x32_bf16 v[84:87], v[196:199], a[244:247], v[84:87]
    s_waitcnt lgkmcnt(2)
    v_mfma_f32_16x16x32_bf16 v[64:67], v[200:203], v[0:3], v[64:67]
    v_rcp_f32 v99, v99
    v_mfma_f32_16x16x32_bf16 v[68:71], v[200:203], v[4:7], v[68:71]
    s_mov_b32 s47, 24576
    buffer_load_dwordx4 a[152:155], v164, s[8:11], s47 offen offset:0 sc1
    buffer_load_dwordx4 a[156:159], v164, s[8:11], s47 offen offset:1024 sc1
    v_mfma_f32_16x16x32_bf16 v[80:83], v[204:207], v[0:3], v[80:83]
    v_mul_f32 v112, v112, v96
    v_mul_f32 v113, v113, v97
    v_mfma_f32_16x16x32_bf16 v[84:87], v[204:207], v[4:7], v[84:87]
    v_mul_f32 v114, v114, v98
    s_waitcnt lgkmcnt(0)
    v_mfma_f32_16x16x32_bf16 v[64:67], v[208:211], v[16:19], v[64:67]
    v_mul_f32 v115, v115, v99
    v_cvt_pk_bf16_f32 v232, v112, v113
    v_mfma_f32_16x16x32_bf16 v[68:71], v[208:211], v[20:23], v[68:71]
    s_waitcnt vmcnt(14)
    v_mov_b32 v172, 3
    v_mfma_f32_16x16x32_bf16 v[80:83], v[212:215], v[16:19], v[80:83]
    buffer_store_dword v172, off, s[48:51], s59 sc1
    v_cvt_pk_bf16_f32 v233, v114, v115
    v_mfma_f32_16x16x32_bf16 v[84:87], v[212:215], v[20:23], v[84:87]
    v_fmac_f32 v100, v225, v216
    s_mov_b32 s12, s52
    s_mov_b32 s13, s53
    s_mov_b32 s14, s54
    s_mov_b32 s15, 0x20000
    v_mov_b32 v208, v170
    s_add_u32 s64, s4, 9961472
    s_addc_u32 s65, s5, 0
    s_mov_b32 s66, 4096
    s_mov_b32 s67, 0x20000
    v_mbcnt_lo_u32_b32 v165, -1, 0
    v_mbcnt_hi_u32_b32 v165, -1, v165
    v_lshlrev_b32 v160, 4, v165
    v_add_u32 v161, 0x10000, v160
    v_add_u32 v162, 0x20000, v160
    v_lshrrev_b32 v166, 4, v165
    v_and_b32 v167, 15, v165
    s_lshl_b32 s31, s30, 10
    v_add_u32 v163, s31, v160
    s_barrier
    ds_read_b128 a[0:3], v161 offset:24576
    ds_read_b128 a[4:7], v161 offset:25600
    ds_read_b128 a[16:19], v161 offset:26624
    ds_read_b128 a[20:23], v161 offset:27648
    ds_read_b128 a[32:35], v161 offset:28672
    ds_read_b128 a[36:39], v161 offset:29696
    ds_read_b128 a[48:51], v161 offset:30720
    ds_read_b128 a[52:55], v161 offset:31744
    ds_read_b128 a[64:67], v161 offset:32768
    s_waitcnt lgkmcnt(6)
    v_mfma_f32_16x16x32_bf16 v[0:3], a[0:3], a[8:11], 0
    s_add_u32 m0, s31, 4096
    s_mov_b32 s40, 73728
    buffer_load_dwordx4 v163, s[12:15], s40 offen sc1 lds
    v_fmac_f32 v101, v225, v217
    v_fmac_f32 v102, v225, v218
    v_mfma_f32_16x16x32_bf16 v[4:7], a[0:3], a[12:15], 0
    s_add_u32 m0, s31, 8192
    s_mov_b32 s40, 77824
    buffer_load_dwordx4 v163, s[12:15], s40 offen sc1 lds
    v_fmac_f32 v103, v225, v219
    v_mul_f32 v100, v229, v100
    v_mfma_f32_16x16x32_bf16 v[8:11], a[4:7], a[8:11], 0
    ds_read_b128 a[68:71], v161 offset:33792
    s_add_u32 m0, s31, 12288
    s_mov_b32 s40, 81920
    buffer_load_dwordx4 v163, s[12:15], s40 offen sc1 lds
    v_mul_f32 v101, v229, v101
    v_mul_f32 v102, v229, v102
    v_mfma_f32_16x16x32_bf16 v[12:15], a[4:7], a[12:15], 0
    ds_read_b128 a[80:83], v161 offset:34816
    s_add_u32 m0, s31, 16384
    s_mov_b32 s40, 86016
    buffer_load_dwordx4 v163, s[12:15], s40 offen sc1 lds
    v_mul_f32 v103, v229, v103
    v_mfma_f32_16x16x32_bf16 v[16:19], a[16:19], a[8:11], 0
    ds_read_b128 a[84:87], v161 offset:35840
    s_add_u32 m0, s31, 20480
    s_mov_b32 s40, 90112
    buffer_load_dwordx4 v163, s[12:15], s40 offen sc1 lds
    v_exp_f32 v100, v100
    v_mfma_f32_16x16x32_bf16 v[20:23], a[16:19], a[12:15], 0
    ds_read_b128 a[96:99], v161 offset:36864
    s_add_u32 m0, s31, 24576
    s_mov_b32 s40, 94208
    buffer_load_dwordx4 v163, s[12:15], s40 offen sc1 lds
    v_exp_f32 v101, v101
    s_waitcnt lgkmcnt(7)
    v_mfma_f32_16x16x32_bf16 v[24:27], a[20:23], a[8:11], 0
    ds_read_b128 a[100:103], v161 offset:37888
    s_add_u32 m0, s31, 28672
    s_mov_b32 s40, 98304
    buffer_load_dwordx4 v163, s[12:15], s40 offen sc1 lds
    v_exp_f32 v102, v102
    v_mfma_f32_16x16x32_bf16 v[28:31], a[20:23], a[12:15], 0
    ds_read_b128 a[112:115], v161 offset:38912
    s_add_u32 m0, s31, 32768
    s_mov_b32 s40, 102400
    buffer_load_dwordx4 v163, s[12:15], s40 offen sc1 lds
    v_exp_f32 v103, v103
    v_mfma_f32_16x16x32_bf16 v[40:43], a[32:35], a[8:11], 0
    ds_read_b128 a[116:119], v161 offset:39936
    s_add_u32 m0, s31, 36864
    s_mov_b32 s40, 106496
    buffer_load_dwordx4 v163, s[12:15], s40 offen sc1 lds
    v_fmac_f32 v116, v225, v220
    v_fmac_f32 v117, v225, v221
    v_mfma_f32_16x16x32_bf16 v[44:47], a[32:35], a[12:15], 0
    ds_read_b128 a[128:131], v161 offset:40960
    v_fmac_f32 v118, v225, v222
    v_fmac_f32 v119, v225, v223
    v_add_f32 v100, 1.0, v100
    v_mfma_f32_16x16x32_bf16 v[56:59], a[36:39], a[8:11], 0
    ds_read_b128 a[132:135], v161 offset:41984
    v_add_f32 v101, 1.0, v101
    v_add_f32 v102, 1.0, v102
    v_add_f32 v103, 1.0, v103
    v_mfma_f32_16x16x32_bf16 v[60:63], a[36:39], a[12:15], 0
    v_rcp_f32 v100, v100
    v_rcp_f32 v101, v101
    s_waitcnt lgkmcnt(9)
    v_mfma_f32_16x16x32_bf16 v[72:75], a[48:51], a[8:11], 0
    v_rcp_f32 v102, v102
    v_rcp_f32 v103, v103
    v_mfma_f32_16x16x32_bf16 v[76:79], a[48:51], a[12:15], 0
    v_mul_f32 v116, v116, v100
    v_mul_f32 v117, v117, v101
    v_mul_f32 v118, v118, v102
    v_mul_f32 v119, v119, v103
    v_mfma_f32_16x16x32_bf16 v[88:91], a[52:55], a[8:11], 0
    v_cvt_pk_bf16_f32 v236, v116, v117
    v_cvt_pk_bf16_f32 v237, v118, v119
    v_fmac_f32 v104, v226, v216
    v_fmac_f32 v105, v226, v217
    v_mfma_f32_16x16x32_bf16 v[92:95], a[52:55], a[12:15], 0
    v_fmac_f32 v106, v226, v218
    v_fmac_f32 v107, v226, v219
    v_mul_f32 v104, v230, v104
    v_mul_f32 v105, v230, v105
    v_mfma_f32_16x16x32_bf16 a[144:147], a[64:67], a[8:11], 0
    v_mul_f32 v106, v230, v106
    v_mul_f32 v107, v230, v107
    v_exp_f32 v104, v104
    v_mfma_f32_16x16x32_bf16 a[148:151], a[64:67], a[12:15], 0
    v_exp_f32 v105, v105
    v_exp_f32 v106, v106
    s_waitcnt lgkmcnt(6)
    v_mfma_f32_16x16x32_bf16 v[0:3], a[68:71], a[24:27], v[0:3]
    v_exp_f32 v107, v107
    v_fmac_f32 v120, v226, v220
    v_fmac_f32 v121, v226, v221
    v_mfma_f32_16x16x32_bf16 v[4:7], a[68:71], a[28:31], v[4:7]
    v_fmac_f32 v122, v226, v222
    v_fmac_f32 v123, v226, v223
    v_add_f32 v104, 1.0, v104
    v_add_f32 v105, 1.0, v105
    v_mfma_f32_16x16x32_bf16 v[8:11], a[80:83], a[24:27], v[8:11]
    ds_read_b128 a[0:3], v161 offset:43008
    v_add_f32 v106, 1.0, v106
    v_add_f32 v107, 1.0, v107
    v_mfma_f32_16x16x32_bf16 v[12:15], a[80:83], a[28:31], v[12:15]
    ds_read_b128 a[4:7], v161 offset:44032
    v_rcp_f32 v104, v104
    v_mfma_f32_16x16x32_bf16 v[16:19], a[84:87], a[24:27], v[16:19]
    ds_read_b128 a[16:19], v161 offset:45056
    v_rcp_f32 v105, v105
    v_mfma_f32_16x16x32_bf16 v[20:23], a[84:87], a[28:31], v[20:23]
    ds_read_b128 a[20:23], v161 offset:46080
    v_rcp_f32 v106, v106
    s_waitcnt lgkmcnt(7)
    v_mfma_f32_16x16x32_bf16 v[24:27], a[96:99], a[24:27], v[24:27]
    ds_read_b128 a[32:35], v161 offset:47104
    v_rcp_f32 v107, v107
    v_mul_f32 v120, v120, v104
    v_mfma_f32_16x16x32_bf16 v[28:31], a[96:99], a[28:31], v[28:31]
    ds_read_b128 a[36:39], v161 offset:48128
    v_mul_f32 v121, v121, v105
    v_mul_f32 v122, v122, v106
    v_mul_f32 v123, v123, v107
    v_mfma_f32_16x16x32_bf16 v[40:43], a[100:103], a[24:27], v[40:43]
    ds_read_b128 a[48:51], v161 offset:49152
    v_cvt_pk_bf16_f32 v240, v120, v121
    v_cvt_pk_bf16_f32 v241, v122, v123
    v_fmac_f32 v108, v227, v216
    v_mfma_f32_16x16x32_bf16 v[44:47], a[100:103], a[28:31], v[44:47]
    ds_read_b128 a[52:55], v161 offset:50176
    v_fmac_f32 v109, v227, v217
    v_fmac_f32 v110, v227, v218
    v_fmac_f32 v111, v227, v219
    v_mfma_f32_16x16x32_bf16 v[56:59], a[112:115], a[24:27], v[56:59]
    ds_read_b128 a[64:67], v161 offset:51200
    v_mul_f32 v108, v231, v108
    v_mul_f32 v109, v231, v109
    v_mul_f32 v110, v231, v110
    v_mfma_f32_16x16x32_bf16 v[60:63], a[112:115], a[28:31], v[60:63]
    v_mul_f32 v111, v231, v111
    v_exp_f32 v108, v108
    s_waitcnt lgkmcnt(9)
    v_mfma_f32_16x16x32_bf16 v[72:75], a[116:119], a[24:27], v[72:75]
    v_exp_f32 v109, v109
    v_exp_f32 v110, v110
    v_mfma_f32_16x16x32_bf16 v[76:79], a[116:119], a[28:31], v[76:79]
    v_exp_f32 v111, v111
    v_fmac_f32 v124, v227, v220
    v_fmac_f32 v125, v227, v221
    v_mfma_f32_16x16x32_bf16 v[88:91], a[128:131], a[24:27], v[88:91]
    v_fmac_f32 v126, v227, v222
    v_fmac_f32 v127, v227, v223
    v_add_f32 v108, 1.0, v108
    v_add_f32 v109, 1.0, v109
    v_mfma_f32_16x16x32_bf16 v[92:95], a[128:131], a[28:31], v[92:95]
    v_add_f32 v110, 1.0, v110
    v_add_f32 v111, 1.0, v111
    v_rcp_f32 v108, v108
    v_mfma_f32_16x16x32_bf16 a[144:147], a[132:135], a[24:27], a[144:147]
    v_rcp_f32 v109, v109
    v_rcp_f32 v110, v110
    v_mfma_f32_16x16x32_bf16 a[148:151], a[132:135], a[28:31], a[148:151]
    v_rcp_f32 v111, v111
    v_mul_f32 v124, v124, v108
    v_mul_f32 v125, v125, v109
    s_waitcnt lgkmcnt(6)
    v_mfma_f32_16x16x32_bf16 v[0:3], a[0:3], a[40:43], v[0:3]
    s_mov_b32 s41, 40960
    buffer_load_dwordx4 a[168:171], v164, s[8:11], s41 offen offset:0 sc1
    buffer_load_dwordx4 a[172:175], v164, s[8:11], s41 offen offset:1024 sc1
    v_mul_f32 v126, v126, v110
    v_mul_f32 v127, v127, v111
    v_mfma_f32_16x16x32_bf16 v[4:7], a[0:3], a[44:47], v[4:7]
    v_cvt_pk_bf16_f32 v244, v124, v125
    v_cvt_pk_bf16_f32 v245, v126, v127
    ds_read_b128 v[216:219], v251 offset:896
    ds_read_b128 v[220:223], v251 offset:960
    v_mfma_f32_16x16x32_bf16 v[8:11], a[4:7], a[40:43], v[8:11]
    ds_read_b128 a[68:71], v161 offset:52224
    s_waitcnt lgkmcnt(1)
    v_fmac_f32 v128, v224, v216
    v_fmac_f32 v129, v224, v217
    v_mfma_f32_16x16x32_bf16 v[12:15], a[4:7], a[44:47], v[12:15]
    ds_read_b128 a[80:83], v161 offset:53248
    v_fmac_f32 v130, v224, v218
    v_fmac_f32 v131, v224, v219
    v_mul_f32 v128, v228, v128
    v_mfma_f32_16x16x32_bf16 v[16:19], a[16:19], a[40:43], v[16:19]
    ds_read_b128 a[84:87], v161 offset:54272
    v_mul_f32 v129, v228, v129
    v_mul_f32 v130, v228, v130
    v_mul_f32 v131, v228, v131
    v_mfma_f32_16x16x32_bf16 v[20:23], a[16:19], a[44:47], v[20:23]
    ds_read_b128 a[96:99], v161 offset:55296
    v_exp_f32 v128, v128
    v_mfma_f32_16x16x32_bf16 v[24:27], a[20:23], a[40:43], v[24:27]
    ds_read_b128 a[100:103], v161 offset:56320
    v_exp_f32 v129, v129
    v_mfma_f32_16x16x32_bf16 v[28:31], a[20:23], a[44:47], v[28:31]
    ds_read_b128 a[112:115], v161 offset:57344
    v_exp_f32 v130, v130
    v_mfma_f32_16x16x32_bf16 v[40:43], a[32:35], a[40:43], v[40:43]
    ds_read_b128 a[116:119], v161 offset:58368
    v_exp_f32 v131, v131
    v_fmac_f32 v144, v224, v220
    v_mfma_f32_16x16x32_bf16 v[44:47], a[32:35], a[44:47], v[44:47]
    ds_read_b128 a[128:131], v161 offset:59392
    v_fmac_f32 v145, v224, v221
    v_fmac_f32 v146, v224, v222
    v_fmac_f32 v147, v224, v223
    v_mfma_f32_16x16x32_bf16 v[56:59], a[36:39], a[40:43], v[56:59]
    ds_read_b128 a[132:135], v161 offset:60416
    v_add_f32 v128, 1.0, v128
    v_add_f32 v129, 1.0, v129
    v_add_f32 v130, 1.0, v130
    v_mfma_f32_16x16x32_bf16 v[60:63], a[36:39], a[44:47], v[60:63]
    v_add_f32 v131, 1.0, v131
    v_rcp_f32 v128, v128
    v_mfma_f32_16x16x32_bf16 v[72:75], a[48:51], a[40:43], v[72:75]
    v_rcp_f32 v129, v129
    v_rcp_f32 v130, v130
    v_mfma_f32_16x16x32_bf16 v[76:79], a[48:51], a[44:47], v[76:79]
    v_rcp_f32 v131, v131
    v_mul_f32 v144, v144, v128
    v_mul_f32 v145, v145, v129
    v_mfma_f32_16x16x32_bf16 v[88:91], a[52:55], a[40:43], v[88:91]
    v_mul_f32 v146, v146, v130
    v_mul_f32 v147, v147, v131
    v_cvt_pk_bf16_f32 v234, v144, v145
    v_cvt_pk_bf16_f32 v235, v146, v147
    v_mfma_f32_16x16x32_bf16 v[92:95], a[52:55], a[44:47], v[92:95]
    s_add_u32 s42, s45, 12288
    buffer_store_dwordx4 v[232:235], v252, s[16:19], s42 offen offset:0 sc1
    v_fmac_f32 v132, v225, v216
    v_fmac_f32 v133, v225, v217
    v_mfma_f32_16x16x32_bf16 a[144:147], a[64:67], a[40:43], a[144:147]
    v_fmac_f32 v134, v225, v218
    v_fmac_f32 v135, v225, v219
    v_mul_f32 v132, v229, v132
    v_mul_f32 v133, v229, v133
    v_mfma_f32_16x16x32_bf16 a[148:151], a[64:67], a[44:47], a[148:151]
    v_mul_f32 v134, v229, v134
    v_mul_f32 v135, v229, v135
    v_exp_f32 v132, v132
    s_waitcnt vmcnt(25)
    s_waitcnt lgkmcnt(6)
    v_mfma_f32_16x16x32_bf16 v[0:3], a[68:71], a[56:59], v[0:3]
    s_mov_b32 s41, 61440
    buffer_load_dwordx4 a[184:187], v164, s[8:11], s41 offen offset:0 sc1
    buffer_load_dwordx4 a[188:191], v164, s[8:11], s41 offen offset:1024 sc1
    v_exp_f32 v133, v133
    v_mfma_f32_16x16x32_bf16 v[4:7], a[68:71], a[60:63], v[4:7]
    s_add_u32 m0, s31, 40960
    s_mov_b32 s40, 110592
    buffer_load_dwordx4 v163, s[12:15], s40 offen sc1 lds
    v_exp_f32 v134, v134
    v_mfma_f32_16x16x32_bf16 v[8:11], a[80:83], a[56:59], v[8:11]
    s_barrier
    v_exp_f32 v135, v135
    v_mfma_f32_16x16x32_bf16 v[12:15], a[80:83], a[60:63], v[12:15]
    ds_read_b128 a[0:3], v161 offset:61440
    s_add_u32 m0, s31, 45056
    s_mov_b32 s40, 114688
    buffer_load_dwordx4 v163, s[12:15], s40 offen sc1 lds
    v_fmac_f32 v148, v225, v220
    v_fmac_f32 v149, v225, v221
    v_mfma_f32_16x16x32_bf16 v[16:19], a[84:87], a[56:59], v[16:19]
    ds_read_b128 a[4:7], v161 offset:62464
    s_add_u32 m0, s31, 49152
    s_mov_b32 s40, 118784
    buffer_load_dwordx4 v163, s[12:15], s40 offen sc1 lds
    v_fmac_f32 v150, v225, v222
    v_fmac_f32 v151, v225, v223
    v_mfma_f32_16x16x32_bf16 v[20:23], a[84:87], a[60:63], v[20:23]
    ds_read_b128 a[16:19], v161 offset:63488
    s_add_u32 m0, s31, 53248
    s_mov_b32 s40, 122880
    buffer_load_dwordx4 v163, s[12:15], s40 offen sc1 lds
    v_add_f32 v132, 1.0, v132
    v_add_f32 v133, 1.0, v133
    s_waitcnt lgkmcnt(6)
    v_mfma_f32_16x16x32_bf16 v[24:27], a[96:99], a[56:59], v[24:27]
    ds_read_b128 a[20:23], v161 offset:64512
    s_add_u32 m0, s31, 57344
    s_mov_b32 s40, 126976
    buffer_load_dwordx4 v163, s[12:15], s40 offen sc1 lds
    v_add_f32 v134, 1.0, v134
    v_add_f32 v135, 1.0, v135
    v_mfma_f32_16x16x32_bf16 v[28:31], a[96:99], a[60:63], v[28:31]
    ds_read_b128 a[32:35], v162 offset:0
    s_add_u32 m0, s31, 61440
    s_mov_b32 s40, 131072
    buffer_load_dwordx4 v163, s[12:15], s40 offen sc1 lds
    v_rcp_f32 v132, v132
    v_mfma_f32_16x16x32_bf16 v[40:43], a[100:103], a[56:59], v[40:43]
    ds_read_b128 a[36:39], v162 offset:1024
    s_add_u32 m0, s31, 65536
    s_mov_b32 s40, 135168
    buffer_load_dwordx4 v163, s[12:15], s40 offen sc1 lds
    v_rcp_f32 v133, v133
    v_mfma_f32_16x16x32_bf16 v[44:47], a[100:103], a[60:63], v[44:47]
    ds_read_b128 a[48:51], v162 offset:2048
    s_add_u32 m0, s31, 69632
    s_mov_b32 s40, 139264
    buffer_load_dwordx4 v163, s[12:15], s40 offen sc1 lds
    v_rcp_f32 v134, v134
    v_mfma_f32_16x16x32_bf16 v[56:59], a[112:115], a[56:59], v[56:59]
    ds_read_b128 a[52:55], v162 offset:3072
    s_add_u32 m0, s31, 73728
    s_mov_b32 s40, 143360
    buffer_load_dwordx4 v163, s[12:15], s40 offen sc1 lds
    v_rcp_f32 v135, v135
    v_mfma_f32_16x16x32_bf16 v[60:63], a[112:115], a[60:63], v[60:63]
    ds_read_b128 a[64:67], v162 offset:4096
    v_mul_f32 v148, v148, v132
    v_mul_f32 v149, v149, v133
    v_mul_f32 v150, v150, v134
    s_waitcnt lgkmcnt(9)
    v_mfma_f32_16x16x32_bf16 v[72:75], a[116:119], a[56:59], v[72:75]
    v_mul_f32 v151, v151, v135
    v_cvt_pk_bf16_f32 v238, v148, v149
    v_cvt_pk_bf16_f32 v239, v150, v151
    buffer_store_dwordx4 v[236:239], v252, s[16:19], s42 offen offset:1024 sc1
    v_mfma_f32_16x16x32_bf16 v[76:79], a[116:119], a[60:63], v[76:79]
    v_fmac_f32 v136, v226, v216
    v_fmac_f32 v137, v226, v217
    v_fmac_f32 v138, v226, v218
    v_fmac_f32 v139, v226, v219
    v_mfma_f32_16x16x32_bf16 v[88:91], a[128:131], a[56:59], v[88:91]
    v_mul_f32 v136, v230, v136
    v_mul_f32 v137, v230, v137
    v_mul_f32 v138, v230, v138
    v_mul_f32 v139, v230, v139
    v_mfma_f32_16x16x32_bf16 v[92:95], a[128:131], a[60:63], v[92:95]
    v_exp_f32 v136, v136
    v_exp_f32 v137, v137
    v_mfma_f32_16x16x32_bf16 a[144:147], a[132:135], a[56:59], a[144:147]
    v_exp_f32 v138, v138
    v_exp_f32 v139, v139
    v_mfma_f32_16x16x32_bf16 a[148:151], a[132:135], a[60:63], a[148:151]
    v_fmac_f32 v152, v226, v220
    v_fmac_f32 v153, v226, v221
    v_fmac_f32 v154, v226, v222
    v_fmac_f32 v155, v226, v223
    s_waitcnt vmcnt(35)
    s_waitcnt lgkmcnt(6)
    v_mfma_f32_16x16x32_bf16 v[0:3], a[0:3], a[72:75], v[0:3]
    s_mov_b32 s41, 77824
    buffer_load_dwordx4 a[8:11], v164, s[8:11], s41 offen offset:0 sc1
    buffer_load_dwordx4 a[12:15], v164, s[8:11], s41 offen offset:1024 sc1
    v_add_f32 v136, 1.0, v136
    v_add_f32 v137, 1.0, v137
    v_mfma_f32_16x16x32_bf16 v[4:7], a[0:3], a[76:79], v[4:7]
    v_add_f32 v138, 1.0, v138
    v_add_f32 v139, 1.0, v139
    v_rcp_f32 v136, v136
    v_mfma_f32_16x16x32_bf16 v[8:11], a[4:7], a[72:75], v[8:11]
    ds_read_b128 a[68:71], v162 offset:5120
    v_rcp_f32 v137, v137
    v_mfma_f32_16x16x32_bf16 v[12:15], a[4:7], a[76:79], v[12:15]
    ds_read_b128 a[80:83], v162 offset:6144
    v_rcp_f32 v138, v138
    v_mfma_f32_16x16x32_bf16 v[16:19], a[16:19], a[72:75], v[16:19]
    ds_read_b128 a[84:87], v162 offset:7168
    v_rcp_f32 v139, v139
    v_mul_f32 v152, v152, v136
    v_mfma_f32_16x16x32_bf16 v[20:23], a[16:19], a[76:79], v[20:23]
    ds_read_b128 a[96:99], v162 offset:8192
    v_mul_f32 v153, v153, v137
    v_mul_f32 v154, v154, v138
    v_mul_f32 v155, v155, v139
    s_waitcnt lgkmcnt(7)
    v_mfma_f32_16x16x32_bf16 v[24:27], a[20:23], a[72:75], v[24:27]
    ds_read_b128 a[100:103], v162 offset:9216
    v_cvt_pk_bf16_f32 v242, v152, v153
    v_cvt_pk_bf16_f32 v243, v154, v155
    buffer_store_dwordx4 v[240:243], v253, s[16:19], s42 offen offset:0 sc1
    v_mfma_f32_16x16x32_bf16 v[28:31], a[20:23], a[76:79], v[28:31]
    ds_read_b128 a[112:115], v162 offset:10240
    v_fmac_f32 v140, v227, v216
    v_fmac_f32 v141, v227, v217
    v_fmac_f32 v142, v227, v218
    v_mfma_f32_16x16x32_bf16 v[40:43], a[32:35], a[72:75], v[40:43]
    ds_read_b128 a[116:119], v162 offset:11264
    v_fmac_f32 v143, v227, v219
    v_mul_f32 v140, v231, v140
    v_mul_f32 v141, v231, v141
    v_mfma_f32_16x16x32_bf16 v[44:47], a[32:35], a[76:79], v[44:47]
    ds_read_b128 a[128:131], v162 offset:12288
    v_mul_f32 v142, v231, v142
    v_mul_f32 v143, v231, v143
    v_mfma_f32_16x16x32_bf16 v[56:59], a[36:39], a[72:75], v[56:59]
    ds_read_b128 a[132:135], v162 offset:13312
    v_exp_f32 v140, v140
    v_mfma_f32_16x16x32_bf16 v[60:63], a[36:39], a[76:79], v[60:63]
    v_exp_f32 v141, v141
    v_exp_f32 v142, v142
    s_waitcnt lgkmcnt(9)
    v_mfma_f32_16x16x32_bf16 v[72:75], a[48:51], a[72:75], v[72:75]
    v_exp_f32 v143, v143
    v_fmac_f32 v156, v227, v220
    v_fmac_f32 v157, v227, v221
    v_mfma_f32_16x16x32_bf16 v[76:79], a[48:51], a[76:79], v[76:79]
    v_fmac_f32 v158, v227, v222
    v_fmac_f32 v159, v227, v223
    v_add_f32 v140, 1.0, v140
    v_add_f32 v141, 1.0, v141
    v_mfma_f32_16x16x32_bf16 v[88:91], a[52:55], a[72:75], v[88:91]
    v_add_f32 v142, 1.0, v142
    v_add_f32 v143, 1.0, v143
    v_rcp_f32 v140, v140
    v_mfma_f32_16x16x32_bf16 v[92:95], a[52:55], a[76:79], v[92:95]
    v_rcp_f32 v141, v141
    v_rcp_f32 v142, v142
    v_mfma_f32_16x16x32_bf16 a[144:147], a[64:67], a[72:75], a[144:147]
    v_rcp_f32 v143, v143
    v_mul_f32 v156, v156, v140
    v_mul_f32 v157, v157, v141
    v_mfma_f32_16x16x32_bf16 a[148:151], a[64:67], a[76:79], a[148:151]
    v_mul_f32 v158, v158, v142
    v_mul_f32 v159, v159, v143
    v_cvt_pk_bf16_f32 v246, v156, v157
    v_cvt_pk_bf16_f32 v247, v158, v159
    s_waitcnt vmcnt(36)
    s_waitcnt lgkmcnt(6)
    v_mfma_f32_16x16x32_bf16 v[0:3], a[68:71], a[88:91], v[0:3]
    s_mov_b32 s41, 98304
    buffer_load_dwordx4 a[24:27], v164, s[8:11], s41 offen offset:0 sc1
    buffer_load_dwordx4 a[28:31], v164, s[8:11], s41 offen offset:1024 sc1
    buffer_store_dwordx4 v[244:247], v253, s[16:19], s42 offen offset:1024 sc1
    ds_read_b128 v[216:219], v254 offset:1024
    v_mfma_f32_16x16x32_bf16 v[4:7], a[68:71], a[92:95], v[4:7]
    buffer_load_dword v209, v208, s[64:67], 0 offen sc1
    ds_read_b128 v[220:223], v254 offset:1088
    s_waitcnt lgkmcnt(0)
    v_fmac_f32 v32, v224, v216
    v_mfma_f32_16x16x32_bf16 v[8:11], a[80:83], a[88:91], v[8:11]
    ds_read_b128 a[0:3], v162 offset:14336
    v_fmac_f32 v33, v224, v217
    v_fmac_f32 v34, v224, v218
    v_fmac_f32 v35, v224, v219
    v_mfma_f32_16x16x32_bf16 v[12:15], a[80:83], a[92:95], v[12:15]
    ds_read_b128 a[4:7], v162 offset:15360
    v_mul_f32 v32, v228, v32
    v_mul_f32 v33, v228, v33
    v_mul_f32 v34, v228, v34
    v_mfma_f32_16x16x32_bf16 v[16:19], a[84:87], a[88:91], v[16:19]
    ds_read_b128 a[16:19], v162 offset:16384
    v_mul_f32 v35, v228, v35
    v_exp_f32 v32, v32
    v_mfma_f32_16x16x32_bf16 v[20:23], a[84:87], a[92:95], v[20:23]
    ds_read_b128 a[20:23], v162 offset:17408
    v_exp_f32 v33, v33
    v_mfma_f32_16x16x32_bf16 v[24:27], a[96:99], a[88:91], v[24:27]
    ds_read_b128 a[32:35], v162 offset:18432
    v_exp_f32 v34, v34
    v_mfma_f32_16x16x32_bf16 v[28:31], a[96:99], a[92:95], v[28:31]
    ds_read_b128 a[36:39], v162 offset:19456
    v_exp_f32 v35, v35
    v_fmac_f32 v48, v224, v220
    v_mfma_f32_16x16x32_bf16 v[40:43], a[100:103], a[88:91], v[40:43]
    ds_read_b128 a[48:51], v162 offset:20480
    v_fmac_f32 v49, v224, v221
    v_fmac_f32 v50, v224, v222
    v_fmac_f32 v51, v224, v223
    v_mfma_f32_16x16x32_bf16 v[44:47], a[100:103], a[92:95], v[44:47]
    ds_read_b128 a[52:55], v162 offset:21504
    v_add_f32 v32, 1.0, v32
    v_add_f32 v33, 1.0, v33
    v_add_f32 v34, 1.0, v34
    v_mfma_f32_16x16x32_bf16 v[56:59], a[112:115], a[88:91], v[56:59]
    ds_read_b128 a[64:67], v162 offset:22528
    v_add_f32 v35, 1.0, v35
    v_rcp_f32 v32, v32
    v_mfma_f32_16x16x32_bf16 v[60:63], a[112:115], a[92:95], v[60:63]
    v_rcp_f32 v33, v33
    v_rcp_f32 v34, v34
    v_mfma_f32_16x16x32_bf16 v[72:75], a[116:119], a[88:91], v[72:75]
    v_rcp_f32 v35, v35
    v_mul_f32 v48, v48, v32
    v_mul_f32 v49, v49, v33
    v_mfma_f32_16x16x32_bf16 v[76:79], a[116:119], a[92:95], v[76:79]
    v_mul_f32 v50, v50, v34
    v_mul_f32 v51, v51, v35
    v_cvt_pk_bf16_f32 v232, v48, v49
    v_cvt_pk_bf16_f32 v233, v50, v51
    v_mfma_f32_16x16x32_bf16 v[88:91], a[128:131], a[88:91], v[88:91]
    v_fmac_f32 v36, v225, v216
    v_fmac_f32 v37, v225, v217
    v_fmac_f32 v38, v225, v218
    v_fmac_f32 v39, v225, v219
    v_mfma_f32_16x16x32_bf16 v[92:95], a[128:131], a[92:95], v[92:95]
    v_mul_f32 v36, v229, v36
    v_mul_f32 v37, v229, v37
    v_mul_f32 v38, v229, v38
    v_mul_f32 v39, v229, v39
    v_mfma_f32_16x16x32_bf16 a[144:147], a[132:135], a[88:91], a[144:147]
    v_exp_f32 v36, v36
    v_exp_f32 v37, v37
    v_mfma_f32_16x16x32_bf16 a[148:151], a[132:135], a[92:95], a[148:151]
    v_exp_f32 v38, v38
    v_exp_f32 v39, v39
    s_waitcnt vmcnt(38)
    s_waitcnt lgkmcnt(6)
    v_mfma_f32_16x16x32_bf16 v[0:3], a[0:3], a[104:107], v[0:3]
    s_mov_b32 s41, 114688
    buffer_load_dwordx4 a[40:43], v164, s[8:11], s41 offen offset:0 sc1
    buffer_load_dwordx4 a[44:47], v164, s[8:11], s41 offen offset:1024 sc1
    v_fmac_f32 v52, v225, v220
    v_fmac_f32 v53, v225, v221
    v_mfma_f32_16x16x32_bf16 v[4:7], a[0:3], a[108:111], v[4:7]
    v_fmac_f32 v54, v225, v222
    v_fmac_f32 v55, v225, v223
    v_add_f32 v36, 1.0, v36
    v_add_f32 v37, 1.0, v37
    v_mfma_f32_16x16x32_bf16 v[8:11], a[4:7], a[104:107], v[8:11]
    ds_read_b128 a[68:71], v162 offset:23552
    v_add_f32 v38, 1.0, v38
    v_add_f32 v39, 1.0, v39
    v_mfma_f32_16x16x32_bf16 v[12:15], a[4:7], a[108:111], v[12:15]
    ds_read_b128 a[80:83], v162 offset:24576
    v_rcp_f32 v36, v36
    v_mfma_f32_16x16x32_bf16 v[16:19], a[16:19], a[104:107], v[16:19]
    ds_read_b128 a[84:87], v162 offset:25600
    v_rcp_f32 v37, v37
    v_mfma_f32_16x16x32_bf16 v[20:23], a[16:19], a[108:111], v[20:23]
    ds_read_b128 a[96:99], v162 offset:26624
    v_rcp_f32 v38, v38
    s_waitcnt lgkmcnt(7)
    v_mfma_f32_16x16x32_bf16 v[24:27], a[20:23], a[104:107], v[24:27]
    ds_read_b128 a[100:103], v162 offset:27648
    v_rcp_f32 v39, v39
    v_mul_f32 v52, v52, v36
    v_mfma_f32_16x16x32_bf16 v[28:31], a[20:23], a[108:111], v[28:31]
    ds_read_b128 a[112:115], v162 offset:28672
    v_mul_f32 v53, v53, v37
    v_mul_f32 v54, v54, v38
    v_mul_f32 v55, v55, v39
    v_mfma_f32_16x16x32_bf16 v[40:43], a[32:35], a[104:107], v[40:43]
    ds_read_b128 a[116:119], v162 offset:29696
    v_cvt_pk_bf16_f32 v236, v52, v53
    v_cvt_pk_bf16_f32 v237, v54, v55
    ds_read_b128 v[216:219], v254 offset:1152
    v_mfma_f32_16x16x32_bf16 v[44:47], a[32:35], a[108:111], v[44:47]
    ds_read_b128 a[128:131], v162 offset:30720
    ds_read_b128 v[220:223], v254 offset:1216
    s_waitcnt lgkmcnt(0)
    v_fmac_f32 v64, v224, v216
    v_mfma_f32_16x16x32_bf16 v[56:59], a[36:39], a[104:107], v[56:59]
    ds_read_b128 a[132:135], v162 offset:31744
    v_fmac_f32 v65, v224, v217
    v_fmac_f32 v66, v224, v218
    v_fmac_f32 v67, v224, v219
    v_mfma_f32_16x16x32_bf16 v[60:63], a[36:39], a[108:111], v[60:63]
    v_mul_f32 v64, v228, v64
    v_mul_f32 v65, v228, v65
    v_mul_f32 v66, v228, v66
    v_mul_f32 v67, v228, v67
    v_mfma_f32_16x16x32_bf16 v[72:75], a[48:51], a[104:107], v[72:75]
    v_exp_f32 v64, v64
    v_exp_f32 v65, v65
    v_mfma_f32_16x16x32_bf16 v[76:79], a[48:51], a[108:111], v[76:79]
    v_exp_f32 v66, v66
    v_exp_f32 v67, v67
    v_mfma_f32_16x16x32_bf16 v[88:91], a[52:55], a[104:107], v[88:91]
    v_fmac_f32 v80, v224, v220
    v_fmac_f32 v81, v224, v221
    v_fmac_f32 v82, v224, v222
    v_fmac_f32 v83, v224, v223
    v_mfma_f32_16x16x32_bf16 v[92:95], a[52:55], a[108:111], v[92:95]
    v_add_f32 v64, 1.0, v64
    v_add_f32 v65, 1.0, v65
    v_add_f32 v66, 1.0, v66
    v_add_f32 v67, 1.0, v67
    v_mfma_f32_16x16x32_bf16 a[144:147], a[64:67], a[104:107], a[144:147]
    v_rcp_f32 v64, v64
    v_rcp_f32 v65, v65
    v_mfma_f32_16x16x32_bf16 a[148:151], a[64:67], a[108:111], a[148:151]
    v_rcp_f32 v66, v66
    v_rcp_f32 v67, v67
    s_waitcnt vmcnt(38)
    v_mfma_f32_16x16x32_bf16 v[0:3], a[68:71], a[120:123], v[0:3]
    s_mov_b32 s41, 135168
    buffer_load_dwordx4 a[56:59], v164, s[8:11], s41 offen offset:0 sc1
    buffer_load_dwordx4 a[60:63], v164, s[8:11], s41 offen offset:1024 sc1
    v_mul_f32 v80, v80, v64
    v_mul_f32 v81, v81, v65
    v_mfma_f32_16x16x32_bf16 v[4:7], a[68:71], a[124:127], v[4:7]
    v_mul_f32 v82, v82, v66
    v_mul_f32 v83, v83, v67
    v_cvt_pk_bf16_f32 v234, v80, v81
    v_cvt_pk_bf16_f32 v235, v82, v83
    v_mfma_f32_16x16x32_bf16 v[8:11], a[80:83], a[120:123], v[8:11]
    s_waitcnt vmcnt(26)
    s_barrier
    s_mov_b32 s42, 16384
    buffer_store_dwordx4 v[232:235], v252, s[16:19], s42 offen offset:0 sc1
    v_mfma_f32_16x16x32_bf16 v[12:15], a[80:83], a[124:127], v[12:15]
    ds_read_b128 a[0:3], v160 offset:4096
    s_add_u32 m0, s31, 90112
    s_mov_b32 s40, 147456
    buffer_load_dwordx4 v163, s[12:15], s40 offen sc1 lds
    v_fmac_f32 v68, v225, v216
    v_fmac_f32 v69, v225, v217
    v_mfma_f32_16x16x32_bf16 v[16:19], a[84:87], a[120:123], v[16:19]
    ds_read_b128 a[4:7], v160 offset:5120
    s_add_u32 m0, s31, 94208
    s_mov_b32 s40, 151552
    buffer_load_dwordx4 v163, s[12:15], s40 offen sc1 lds
    v_fmac_f32 v70, v225, v218
    v_fmac_f32 v71, v225, v219
    v_mfma_f32_16x16x32_bf16 v[20:23], a[84:87], a[124:127], v[20:23]
    ds_read_b128 a[16:19], v160 offset:6144
    s_add_u32 m0, s31, 98304
    s_mov_b32 s40, 155648
    buffer_load_dwordx4 v163, s[12:15], s40 offen sc1 lds
    v_mul_f32 v68, v229, v68
    v_mul_f32 v69, v229, v69
    v_mfma_f32_16x16x32_bf16 v[24:27], a[96:99], a[120:123], v[24:27]
    ds_read_b128 a[20:23], v160 offset:7168
    s_add_u32 m0, s31, 102400
    s_mov_b32 s40, 159744
    buffer_load_dwordx4 v163, s[12:15], s40 offen sc1 lds
    v_mul_f32 v70, v229, v70
    v_mul_f32 v71, v229, v71
    v_mfma_f32_16x16x32_bf16 v[28:31], a[96:99], a[124:127], v[28:31]
    ds_read_b128 a[32:35], v160 offset:8192
    s_add_u32 m0, s31, 106496
    s_mov_b32 s40, 163840
    buffer_load_dwordx4 v163, s[12:15], s40 offen sc1 lds
    v_exp_f32 v68, v68
    v_mfma_f32_16x16x32_bf16 v[40:43], a[100:103], a[120:123], v[40:43]
    ds_read_b128 a[36:39], v160 offset:9216
    s_add_u32 m0, s31, 110592
    s_mov_b32 s40, 167936
    buffer_load_dwordx4 v163, s[12:15], s40 offen sc1 lds
    v_exp_f32 v69, v69
    v_mfma_f32_16x16x32_bf16 v[44:47], a[100:103], a[124:127], v[44:47]
    ds_read_b128 a[48:51], v160 offset:10240
    s_add_u32 m0, s31, 114688
    s_mov_b32 s40, 172032
    buffer_load_dwordx4 v163, s[12:15], s40 offen sc1 lds
    v_exp_f32 v70, v70
    v_mfma_f32_16x16x32_bf16 v[56:59], a[112:115], a[120:123], v[56:59]
    ds_read_b128 a[52:55], v160 offset:11264
    s_add_u32 m0, s31, 118784
    s_mov_b32 s40, 176128
    buffer_load_dwordx4 v163, s[12:15], s40 offen sc1 lds
    v_exp_f32 v71, v71
    v_mfma_f32_16x16x32_bf16 v[60:63], a[112:115], a[124:127], v[60:63]
    ds_read_b128 a[64:67], v160 offset:12288
    s_add_u32 m0, s31, 122880
    s_mov_b32 s40, 180224
    buffer_load_dwordx4 v163, s[12:15], s40 offen sc1 lds
    v_fmac_f32 v84, v225, v220
    v_fmac_f32 v85, v225, v221
    s_waitcnt lgkmcnt(9)
    v_mfma_f32_16x16x32_bf16 v[72:75], a[116:119], a[120:123], v[72:75]
    v_fmac_f32 v86, v225, v222
    v_fmac_f32 v87, v225, v223
    v_add_f32 v68, 1.0, v68
    v_add_f32 v69, 1.0, v69
    v_mfma_f32_16x16x32_bf16 v[76:79], a[116:119], a[124:127], v[76:79]
    v_add_f32 v70, 1.0, v70
    v_add_f32 v71, 1.0, v71
    v_rcp_f32 v68, v68
    v_mfma_f32_16x16x32_bf16 v[88:91], a[128:131], a[120:123], v[88:91]
    v_rcp_f32 v69, v69
    v_rcp_f32 v70, v70
    v_mfma_f32_16x16x32_bf16 v[92:95], a[128:131], a[124:127], v[92:95]
    v_rcp_f32 v71, v71
    v_mul_f32 v84, v84, v68
    v_mul_f32 v85, v85, v69
    v_mfma_f32_16x16x32_bf16 a[144:147], a[132:135], a[120:123], a[144:147]
    v_mul_f32 v86, v86, v70
    v_mul_f32 v87, v87, v71
    v_cvt_pk_bf16_f32 v238, v84, v85
    v_cvt_pk_bf16_f32 v239, v86, v87
    v_mfma_f32_16x16x32_bf16 a[148:151], a[132:135], a[124:127], a[148:151]
    buffer_store_dwordx4 v[236:239], v252, s[16:19], s42 offen offset:1024 sc1
    s_waitcnt lgkmcnt(6)
    v_mfma_f32_16x16x32_bf16 v[0:3], a[0:3], a[136:139], v[0:3]
    s_waitcnt vmcnt(15)
    v_cmp_gt_u32 vcc, 3, v209
    s_nop 0
    s_cmp_eq_u64 vcc, 0
    s_cbranch_scc1 L_fk_kernel_r16_ok
    s_mov_b32 s43, 0x10000
L_fk_kernel_r16_spin:
    buffer_load_dword v209, v208, s[64:67], 0 offen sc1
    s_waitcnt vmcnt(0)
    v_cmp_gt_u32 vcc, 3, v209
    s_nop 0
    s_cmp_eq_u64 vcc, 0
    s_cbranch_scc1 L_fk_kernel_r16_ok
    s_sleep 1
    s_sub_u32 s43, s43, 1
    s_cmp_lg_u32 s43, 0
    s_cbranch_scc1 L_fk_kernel_r16_spin
L_fk_kernel_r16_ok:
    s_mov_b32 s41, 8192
    buffer_load_dwordx4 a[72:75], v164, s[8:11], s41 offen offset:0 sc1
    buffer_load_dwordx4 a[76:79], v164, s[8:11], s41 offen offset:1024 sc1
    v_mfma_f32_16x16x32_bf16 v[4:7], a[0:3], a[140:143], v[4:7]
    v_mfma_f32_16x16x32_bf16 v[8:11], a[4:7], a[136:139], v[8:11]
    ds_read_b128 a[68:71], v160 offset:13312
    v_mfma_f32_16x16x32_bf16 v[12:15], a[4:7], a[140:143], v[12:15]
    ds_read_b128 a[80:83], v160 offset:14336
    v_mfma_f32_16x16x32_bf16 v[16:19], a[16:19], a[136:139], v[16:19]
    ds_read_b128 a[84:87], v160 offset:15360
    v_mfma_f32_16x16x32_bf16 v[20:23], a[16:19], a[140:143], v[20:23]
    ds_read_b128 a[96:99], v160 offset:16384
    s_waitcnt lgkmcnt(7)
    v_mfma_f32_16x16x32_bf16 v[24:27], a[20:23], a[136:139], v[24:27]
    ds_read_b128 a[100:103], v160 offset:17408
    v_mfma_f32_16x16x32_bf16 v[28:31], a[20:23], a[140:143], v[28:31]
    ds_read_b128 a[112:115], v160 offset:18432
    v_mfma_f32_16x16x32_bf16 v[40:43], a[32:35], a[136:139], v[40:43]
    ds_read_b128 a[116:119], v160 offset:19456
    v_mfma_f32_16x16x32_bf16 v[44:47], a[32:35], a[140:143], v[44:47]
    ds_read_b128 a[128:131], v160 offset:20480
    v_mfma_f32_16x16x32_bf16 v[56:59], a[36:39], a[136:139], v[56:59]
    ds_read_b128 a[132:135], v160 offset:21504
    v_mfma_f32_16x16x32_bf16 v[60:63], a[36:39], a[140:143], v[60:63]
    s_waitcnt lgkmcnt(9)
    v_mfma_f32_16x16x32_bf16 v[72:75], a[48:51], a[136:139], v[72:75]
    v_mfma_f32_16x16x32_bf16 v[76:79], a[48:51], a[140:143], v[76:79]
    v_mfma_f32_16x16x32_bf16 v[88:91], a[52:55], a[136:139], v[88:91]
    v_mfma_f32_16x16x32_bf16 v[92:95], a[52:55], a[140:143], v[92:95]
    v_mfma_f32_16x16x32_bf16 a[144:147], a[64:67], a[136:139], a[144:147]
    v_mfma_f32_16x16x32_bf16 a[148:151], a[64:67], a[140:143], a[148:151]
    s_waitcnt lgkmcnt(6)
    v_mfma_f32_16x16x32_bf16 v[0:3], a[68:71], a[152:155], v[0:3]
    s_mov_b32 s41, 28672
    buffer_load_dwordx4 a[88:91], v164, s[8:11], s41 offen offset:0 sc1
    buffer_load_dwordx4 a[92:95], v164, s[8:11], s41 offen offset:1024 sc1
    v_mfma_f32_16x16x32_bf16 v[4:7], a[68:71], a[156:159], v[4:7]
    s_waitcnt vmcnt(4)
    v_mov_b32 v210, 5
    buffer_store_dword v210, off, s[64:67], s59 sc1
    v_mfma_f32_16x16x32_bf16 v[8:11], a[80:83], a[152:155], v[8:11]
    ds_read_b128 a[0:3], v160 offset:22528
    v_mfma_f32_16x16x32_bf16 v[12:15], a[80:83], a[156:159], v[12:15]
    ds_read_b128 a[4:7], v160 offset:23552
    v_mfma_f32_16x16x32_bf16 v[16:19], a[84:87], a[152:155], v[16:19]
    ds_read_b128 a[16:19], v160 offset:24576
    v_mfma_f32_16x16x32_bf16 v[20:23], a[84:87], a[156:159], v[20:23]
    ds_read_b128 a[20:23], v160 offset:25600
    s_waitcnt lgkmcnt(7)
    v_mfma_f32_16x16x32_bf16 v[24:27], a[96:99], a[152:155], v[24:27]
    ds_read_b128 a[32:35], v160 offset:26624
    v_mfma_f32_16x16x32_bf16 v[28:31], a[96:99], a[156:159], v[28:31]
    ds_read_b128 a[36:39], v160 offset:27648
    v_mfma_f32_16x16x32_bf16 v[40:43], a[100:103], a[152:155], v[40:43]
    ds_read_b128 a[48:51], v160 offset:28672
    v_mfma_f32_16x16x32_bf16 v[44:47], a[100:103], a[156:159], v[44:47]
    ds_read_b128 a[52:55], v160 offset:29696
    v_mfma_f32_16x16x32_bf16 v[56:59], a[112:115], a[152:155], v[56:59]
    ds_read_b128 a[64:67], v160 offset:30720
    v_mfma_f32_16x16x32_bf16 v[60:63], a[112:115], a[156:159], v[60:63]
    s_waitcnt lgkmcnt(9)
    v_mfma_f32_16x16x32_bf16 v[72:75], a[116:119], a[152:155], v[72:75]
    v_mfma_f32_16x16x32_bf16 v[76:79], a[116:119], a[156:159], v[76:79]
    v_mfma_f32_16x16x32_bf16 v[88:91], a[128:131], a[152:155], v[88:91]
    v_mfma_f32_16x16x32_bf16 v[92:95], a[128:131], a[156:159], v[92:95]
    v_mfma_f32_16x16x32_bf16 a[144:147], a[132:135], a[152:155], a[144:147]
    v_mfma_f32_16x16x32_bf16 a[148:151], a[132:135], a[156:159], a[148:151]
    s_waitcnt lgkmcnt(6)
    v_mfma_f32_16x16x32_bf16 v[0:3], a[0:3], a[168:171], v[0:3]
    s_mov_b32 s41, 45056
    buffer_load_dwordx4 a[104:107], v164, s[8:11], s41 offen offset:0 sc1
    buffer_load_dwordx4 a[108:111], v164, s[8:11], s41 offen offset:1024 sc1
    v_mfma_f32_16x16x32_bf16 v[4:7], a[0:3], a[172:175], v[4:7]
    v_mfma_f32_16x16x32_bf16 v[8:11], a[4:7], a[168:171], v[8:11]
    ds_read_b128 a[68:71], v160 offset:31744
    v_mfma_f32_16x16x32_bf16 v[12:15], a[4:7], a[172:175], v[12:15]
    ds_read_b128 a[80:83], v160 offset:32768
    v_mfma_f32_16x16x32_bf16 v[16:19], a[16:19], a[168:171], v[16:19]
    ds_read_b128 a[84:87], v160 offset:33792
    v_mfma_f32_16x16x32_bf16 v[20:23], a[16:19], a[172:175], v[20:23]
    ds_read_b128 a[96:99], v160 offset:34816
    s_waitcnt lgkmcnt(7)
    v_mfma_f32_16x16x32_bf16 v[24:27], a[20:23], a[168:171], v[24:27]
    ds_read_b128 a[100:103], v160 offset:35840
    v_mfma_f32_16x16x32_bf16 v[28:31], a[20:23], a[172:175], v[28:31]
    ds_read_b128 a[112:115], v160 offset:36864
    v_mfma_f32_16x16x32_bf16 v[40:43], a[32:35], a[168:171], v[40:43]
    ds_read_b128 a[116:119], v160 offset:37888
    v_mfma_f32_16x16x32_bf16 v[44:47], a[32:35], a[172:175], v[44:47]
    ds_read_b128 a[128:131], v160 offset:38912
    v_mfma_f32_16x16x32_bf16 v[56:59], a[36:39], a[168:171], v[56:59]
    ds_read_b128 a[132:135], v160 offset:39936
    v_mfma_f32_16x16x32_bf16 v[60:63], a[36:39], a[172:175], v[60:63]
    s_waitcnt lgkmcnt(9)
    v_mfma_f32_16x16x32_bf16 v[72:75], a[48:51], a[168:171], v[72:75]
    v_mfma_f32_16x16x32_bf16 v[76:79], a[48:51], a[172:175], v[76:79]
    v_mfma_f32_16x16x32_bf16 v[88:91], a[52:55], a[168:171], v[88:91]
    v_mfma_f32_16x16x32_bf16 v[92:95], a[52:55], a[172:175], v[92:95]
    v_mfma_f32_16x16x32_bf16 a[144:147], a[64:67], a[168:171], a[144:147]
    v_mfma_f32_16x16x32_bf16 a[148:151], a[64:67], a[172:175], a[148:151]
    s_waitcnt lgkmcnt(6)
    v_mfma_f32_16x16x32_bf16 v[0:3], a[68:71], a[184:187], v[0:3]
    s_mov_b32 s41, 65536
    buffer_load_dwordx4 a[120:123], v164, s[8:11], s41 offen offset:0 sc1
    buffer_load_dwordx4 a[124:127], v164, s[8:11], s41 offen offset:1024 sc1
    v_mfma_f32_16x16x32_bf16 v[4:7], a[68:71], a[188:191], v[4:7]
    v_mfma_f32_16x16x32_bf16 v[8:11], a[80:83], a[184:187], v[8:11]
    s_barrier
    v_mfma_f32_16x16x32_bf16 v[12:15], a[80:83], a[188:191], v[12:15]
    ds_read_b128 a[0:3], v160 offset:40960
    s_add_u32 m0, s31, 126976
    s_mov_b32 s40, 184320
    buffer_load_dwordx4 v163, s[12:15], s40 offen sc1 lds
    v_mfma_f32_16x16x32_bf16 v[16:19], a[84:87], a[184:187], v[16:19]
    ds_read_b128 a[4:7], v160 offset:41984
    s_add_u32 m0, s31, 131072
    s_mov_b32 s40, 188416
    buffer_load_dwordx4 v163, s[12:15], s40 offen sc1 lds
    v_mfma_f32_16x16x32_bf16 v[20:23], a[84:87], a[188:191], v[20:23]
    ds_read_b128 a[16:19], v160 offset:43008
    s_add_u32 m0, s31, 135168
    s_mov_b32 s40, 192512
    buffer_load_dwordx4 v163, s[12:15], s40 offen sc1 lds
    s_waitcnt lgkmcnt(6)
    v_mfma_f32_16x16x32_bf16 v[24:27], a[96:99], a[184:187], v[24:27]
    ds_read_b128 a[20:23], v160 offset:44032
    s_add_u32 m0, s31, 139264
    s_mov_b32 s40, 196608
    buffer_load_dwordx4 v163, s[12:15], s40 offen sc1 lds
    v_mfma_f32_16x16x32_bf16 v[28:31], a[96:99], a[188:191], v[28:31]
    ds_read_b128 a[32:35], v160 offset:45056
    s_add_u32 m0, s31, 143360
    s_mov_b32 s40, 200704
    buffer_load_dwordx4 v163, s[12:15], s40 offen sc1 lds
    v_mfma_f32_16x16x32_bf16 v[40:43], a[100:103], a[184:187], v[40:43]
    ds_read_b128 a[36:39], v160 offset:46080
    s_add_u32 m0, s31, 147456
    s_mov_b32 s40, 204800
    buffer_load_dwordx4 v163, s[12:15], s40 offen sc1 lds
    v_mfma_f32_16x16x32_bf16 v[44:47], a[100:103], a[188:191], v[44:47]
    ds_read_b128 a[48:51], v160 offset:47104
    s_add_u32 m0, s31, 151552
    s_mov_b32 s40, 208896
    buffer_load_dwordx4 v163, s[12:15], s40 offen sc1 lds
    v_mfma_f32_16x16x32_bf16 v[56:59], a[112:115], a[184:187], v[56:59]
    ds_read_b128 a[52:55], v160 offset:48128
    s_add_u32 m0, s31, 155648
    s_mov_b32 s40, 212992
    buffer_load_dwordx4 v163, s[12:15], s40 offen sc1 lds
    v_mfma_f32_16x16x32_bf16 v[60:63], a[112:115], a[188:191], v[60:63]
    ds_read_b128 a[64:67], v160 offset:49152
    s_add_u32 m0, s31, 159744
    s_mov_b32 s40, 217088
    buffer_load_dwordx4 v163, s[12:15], s40 offen sc1 lds
    s_waitcnt lgkmcnt(9)
    v_mfma_f32_16x16x32_bf16 v[72:75], a[116:119], a[184:187], v[72:75]
    v_mfma_f32_16x16x32_bf16 v[76:79], a[116:119], a[188:191], v[76:79]
    v_mfma_f32_16x16x32_bf16 v[88:91], a[128:131], a[184:187], v[88:91]
    v_mfma_f32_16x16x32_bf16 v[92:95], a[128:131], a[188:191], v[92:95]
    v_mfma_f32_16x16x32_bf16 a[144:147], a[132:135], a[184:187], a[144:147]
    v_mfma_f32_16x16x32_bf16 a[148:151], a[132:135], a[188:191], a[148:151]
    s_waitcnt lgkmcnt(6)
    v_mfma_f32_16x16x32_bf16 v[0:3], a[0:3], a[8:11], v[0:3]
    s_mov_b32 s41, 81920
    buffer_load_dwordx4 a[136:139], v164, s[8:11], s41 offen offset:0 sc1
    buffer_load_dwordx4 a[140:143], v164, s[8:11], s41 offen offset:1024 sc1
    v_mfma_f32_16x16x32_bf16 v[4:7], a[0:3], a[12:15], v[4:7]
    v_mfma_f32_16x16x32_bf16 v[8:11], a[4:7], a[8:11], v[8:11]
    ds_read_b128 a[68:71], v160 offset:50176
    v_mfma_f32_16x16x32_bf16 v[12:15], a[4:7], a[12:15], v[12:15]
    ds_read_b128 a[80:83], v160 offset:51200
    v_mfma_f32_16x16x32_bf16 v[16:19], a[16:19], a[8:11], v[16:19]
    ds_read_b128 a[84:87], v160 offset:52224
    v_mfma_f32_16x16x32_bf16 v[20:23], a[16:19], a[12:15], v[20:23]
    ds_read_b128 a[96:99], v160 offset:53248
    s_waitcnt lgkmcnt(7)
    v_mfma_f32_16x16x32_bf16 v[24:27], a[20:23], a[8:11], v[24:27]
    ds_read_b128 a[100:103], v160 offset:54272
    v_mfma_f32_16x16x32_bf16 v[28:31], a[20:23], a[12:15], v[28:31]
    ds_read_b128 a[112:115], v160 offset:55296
    v_mfma_f32_16x16x32_bf16 v[40:43], a[32:35], a[8:11], v[40:43]
    ds_read_b128 a[116:119], v160 offset:56320
    v_mfma_f32_16x16x32_bf16 v[44:47], a[32:35], a[12:15], v[44:47]
    ds_read_b128 a[128:131], v160 offset:57344
    v_mfma_f32_16x16x32_bf16 v[56:59], a[36:39], a[8:11], v[56:59]
    ds_read_b128 a[132:135], v160 offset:58368
    v_mfma_f32_16x16x32_bf16 v[60:63], a[36:39], a[12:15], v[60:63]
    s_waitcnt lgkmcnt(9)
    v_mfma_f32_16x16x32_bf16 v[72:75], a[48:51], a[8:11], v[72:75]
    v_mfma_f32_16x16x32_bf16 v[76:79], a[48:51], a[12:15], v[76:79]
    v_mfma_f32_16x16x32_bf16 v[88:91], a[52:55], a[8:11], v[88:91]
    v_mfma_f32_16x16x32_bf16 v[92:95], a[52:55], a[12:15], v[92:95]
    v_mfma_f32_16x16x32_bf16 a[144:147], a[64:67], a[8:11], a[144:147]
    v_mfma_f32_16x16x32_bf16 a[148:151], a[64:67], a[12:15], a[148:151]
    s_waitcnt lgkmcnt(6)
    v_mfma_f32_16x16x32_bf16 v[0:3], a[68:71], a[24:27], v[0:3]
    s_mov_b32 s41, 102400
    buffer_load_dwordx4 a[152:155], v164, s[8:11], s41 offen offset:0 sc1
    buffer_load_dwordx4 a[156:159], v164, s[8:11], s41 offen offset:1024 sc1
    v_mfma_f32_16x16x32_bf16 v[4:7], a[68:71], a[28:31], v[4:7]
    buffer_load_dword v209, v208, s[64:67], 0 offen sc1
    v_mfma_f32_16x16x32_bf16 v[8:11], a[80:83], a[24:27], v[8:11]
    ds_read_b128 a[0:3], v160 offset:59392
    v_mfma_f32_16x16x32_bf16 v[12:15], a[80:83], a[28:31], v[12:15]
    ds_read_b128 a[4:7], v160 offset:60416
    v_mfma_f32_16x16x32_bf16 v[16:19], a[84:87], a[24:27], v[16:19]
    ds_read_b128 a[16:19], v160 offset:61440
    v_mfma_f32_16x16x32_bf16 v[20:23], a[84:87], a[28:31], v[20:23]
    ds_read_b128 a[20:23], v160 offset:62464
    s_waitcnt lgkmcnt(7)
    v_mfma_f32_16x16x32_bf16 v[24:27], a[96:99], a[24:27], v[24:27]
    ds_read_b128 a[32:35], v160 offset:63488
    v_mfma_f32_16x16x32_bf16 v[28:31], a[96:99], a[28:31], v[28:31]
    ds_read_b128 a[36:39], v160 offset:64512
    v_mfma_f32_16x16x32_bf16 v[40:43], a[100:103], a[24:27], v[40:43]
    ds_read_b128 a[48:51], v161 offset:0
    v_mfma_f32_16x16x32_bf16 v[44:47], a[100:103], a[28:31], v[44:47]
    ds_read_b128 a[52:55], v161 offset:1024
    v_mfma_f32_16x16x32_bf16 v[56:59], a[112:115], a[24:27], v[56:59]
    ds_read_b128 a[64:67], v161 offset:2048
    v_mfma_f32_16x16x32_bf16 v[60:63], a[112:115], a[28:31], v[60:63]
    s_waitcnt lgkmcnt(9)
    v_mfma_f32_16x16x32_bf16 v[72:75], a[116:119], a[24:27], v[72:75]
    v_mfma_f32_16x16x32_bf16 v[76:79], a[116:119], a[28:31], v[76:79]
    v_mfma_f32_16x16x32_bf16 v[88:91], a[128:131], a[24:27], v[88:91]
    v_mfma_f32_16x16x32_bf16 v[92:95], a[128:131], a[28:31], v[92:95]
    v_mfma_f32_16x16x32_bf16 a[144:147], a[132:135], a[24:27], a[144:147]
    v_mfma_f32_16x16x32_bf16 a[148:151], a[132:135], a[28:31], a[148:151]
    s_waitcnt lgkmcnt(6)
    v_mfma_f32_16x16x32_bf16 v[0:3], a[0:3], a[40:43], v[0:3]
    s_mov_b32 s41, 118784
    buffer_load_dwordx4 a[168:171], v164, s[8:11], s41 offen offset:0 sc1
    buffer_load_dwordx4 a[172:175], v164, s[8:11], s41 offen offset:1024 sc1
    v_mfma_f32_16x16x32_bf16 v[4:7], a[0:3], a[44:47], v[4:7]
    v_mfma_f32_16x16x32_bf16 v[8:11], a[4:7], a[40:43], v[8:11]
    ds_read_b128 a[68:71], v161 offset:3072
    v_mfma_f32_16x16x32_bf16 v[12:15], a[4:7], a[44:47], v[12:15]
    ds_read_b128 a[80:83], v161 offset:4096
    v_mfma_f32_16x16x32_bf16 v[16:19], a[16:19], a[40:43], v[16:19]
    ds_read_b128 a[84:87], v161 offset:5120
    v_mfma_f32_16x16x32_bf16 v[20:23], a[16:19], a[44:47], v[20:23]
    ds_read_b128 a[96:99], v161 offset:6144
    s_waitcnt lgkmcnt(7)
    v_mfma_f32_16x16x32_bf16 v[24:27], a[20:23], a[40:43], v[24:27]
    ds_read_b128 a[100:103], v161 offset:7168
    v_mfma_f32_16x16x32_bf16 v[28:31], a[20:23], a[44:47], v[28:31]
    ds_read_b128 a[112:115], v161 offset:8192
    v_mfma_f32_16x16x32_bf16 v[40:43], a[32:35], a[40:43], v[40:43]
    ds_read_b128 a[116:119], v161 offset:9216
    v_mfma_f32_16x16x32_bf16 v[44:47], a[32:35], a[44:47], v[44:47]
    ds_read_b128 a[128:131], v161 offset:10240
    v_mfma_f32_16x16x32_bf16 v[56:59], a[36:39], a[40:43], v[56:59]
    ds_read_b128 a[132:135], v161 offset:11264
    v_mfma_f32_16x16x32_bf16 v[60:63], a[36:39], a[44:47], v[60:63]
    s_waitcnt lgkmcnt(9)
    v_mfma_f32_16x16x32_bf16 v[72:75], a[48:51], a[40:43], v[72:75]
    v_mfma_f32_16x16x32_bf16 v[76:79], a[48:51], a[44:47], v[76:79]
    v_mfma_f32_16x16x32_bf16 v[88:91], a[52:55], a[40:43], v[88:91]
    v_mfma_f32_16x16x32_bf16 v[92:95], a[52:55], a[44:47], v[92:95]
    v_mfma_f32_16x16x32_bf16 a[144:147], a[64:67], a[40:43], a[144:147]
    v_mfma_f32_16x16x32_bf16 a[148:151], a[64:67], a[44:47], a[148:151]
    s_waitcnt lgkmcnt(6)
    v_mfma_f32_16x16x32_bf16 v[0:3], a[68:71], a[56:59], v[0:3]
    s_mov_b32 s41, 139264
    buffer_load_dwordx4 a[184:187], v164, s[8:11], s41 offen offset:0 sc1
    buffer_load_dwordx4 a[188:191], v164, s[8:11], s41 offen offset:1024 sc1
    v_mfma_f32_16x16x32_bf16 v[4:7], a[68:71], a[60:63], v[4:7]
    v_mfma_f32_16x16x32_bf16 v[8:11], a[80:83], a[56:59], v[8:11]
    s_barrier
    v_mfma_f32_16x16x32_bf16 v[12:15], a[80:83], a[60:63], v[12:15]
    ds_read_b128 a[0:3], v161 offset:24576
    s_add_u32 m0, s31, 4096
    s_mov_b32 s40, 221184
    buffer_load_dwordx4 v163, s[12:15], s40 offen sc1 lds
    v_mfma_f32_16x16x32_bf16 v[16:19], a[84:87], a[56:59], v[16:19]
    ds_read_b128 a[4:7], v161 offset:25600
    s_add_u32 m0, s31, 8192
    s_mov_b32 s40, 225280
    buffer_load_dwordx4 v163, s[12:15], s40 offen sc1 lds
    v_mfma_f32_16x16x32_bf16 v[20:23], a[84:87], a[60:63], v[20:23]
    ds_read_b128 a[16:19], v161 offset:26624
    s_add_u32 m0, s31, 12288
    s_mov_b32 s40, 229376
    buffer_load_dwordx4 v163, s[12:15], s40 offen sc1 lds
    s_waitcnt lgkmcnt(6)
    v_mfma_f32_16x16x32_bf16 v[24:27], a[96:99], a[56:59], v[24:27]
    ds_read_b128 a[20:23], v161 offset:27648
    s_add_u32 m0, s31, 16384
    s_mov_b32 s40, 233472
    buffer_load_dwordx4 v163, s[12:15], s40 offen sc1 lds
    v_mfma_f32_16x16x32_bf16 v[28:31], a[96:99], a[60:63], v[28:31]
    ds_read_b128 a[32:35], v161 offset:28672
    s_add_u32 m0, s31, 20480
    s_mov_b32 s40, 237568
    buffer_load_dwordx4 v163, s[12:15], s40 offen sc1 lds
    v_mfma_f32_16x16x32_bf16 v[40:43], a[100:103], a[56:59], v[40:43]
    ds_read_b128 a[36:39], v161 offset:29696
    s_add_u32 m0, s31, 24576
    s_mov_b32 s40, 241664
    buffer_load_dwordx4 v163, s[12:15], s40 offen sc1 lds
    v_mfma_f32_16x16x32_bf16 v[44:47], a[100:103], a[60:63], v[44:47]
    ds_read_b128 a[48:51], v161 offset:30720
    s_add_u32 m0, s31, 28672
    s_mov_b32 s40, 245760
    buffer_load_dwordx4 v163, s[12:15], s40 offen sc1 lds
    v_mfma_f32_16x16x32_bf16 v[56:59], a[112:115], a[56:59], v[56:59]
    ds_read_b128 a[52:55], v161 offset:31744
    s_add_u32 m0, s31, 32768
    s_mov_b32 s40, 249856
    buffer_load_dwordx4 v163, s[12:15], s40 offen sc1 lds
    v_mfma_f32_16x16x32_bf16 v[60:63], a[112:115], a[60:63], v[60:63]
    ds_read_b128 a[64:67], v161 offset:32768
    s_add_u32 m0, s31, 36864
    s_mov_b32 s40, 253952
    buffer_load_dwordx4 v163, s[12:15], s40 offen sc1 lds
    s_waitcnt lgkmcnt(9)
    v_mfma_f32_16x16x32_bf16 v[72:75], a[116:119], a[56:59], v[72:75]
    v_mfma_f32_16x16x32_bf16 v[76:79], a[116:119], a[60:63], v[76:79]
    v_mfma_f32_16x16x32_bf16 v[88:91], a[128:131], a[56:59], v[88:91]
    v_mfma_f32_16x16x32_bf16 v[92:95], a[128:131], a[60:63], v[92:95]
    v_mfma_f32_16x16x32_bf16 a[144:147], a[132:135], a[56:59], a[144:147]
    v_mfma_f32_16x16x32_bf16 a[148:151], a[132:135], a[60:63], a[148:151]
    s_waitcnt vmcnt(34)
    s_waitcnt lgkmcnt(6)
    v_mfma_f32_16x16x32_bf16 v[0:3], a[0:3], a[72:75], v[0:3]
    s_waitcnt vmcnt(13)
    v_cmp_gt_u32 vcc, 4, v209
    s_nop 0
    s_cmp_eq_u64 vcc, 0
    s_cbranch_scc1 L_fk_kernel_r24_ok
    s_mov_b32 s43, 0x10000
L_fk_kernel_r24_spin:
    buffer_load_dword v209, v208, s[64:67], 0 offen sc1
    s_waitcnt vmcnt(0)
    v_cmp_gt_u32 vcc, 4, v209
    s_nop 0
    s_cmp_eq_u64 vcc, 0
    s_cbranch_scc1 L_fk_kernel_r24_ok
    s_sleep 1
    s_sub_u32 s43, s43, 1
    s_cmp_lg_u32 s43, 0
    s_cbranch_scc1 L_fk_kernel_r24_spin
L_fk_kernel_r24_ok:
    s_mov_b32 s41, 12288
    buffer_load_dwordx4 a[8:11], v164, s[8:11], s41 offen offset:0 sc1
    buffer_load_dwordx4 a[12:15], v164, s[8:11], s41 offen offset:1024 sc1
    v_mfma_f32_16x16x32_bf16 v[4:7], a[0:3], a[76:79], v[4:7]
    v_mfma_f32_16x16x32_bf16 v[8:11], a[4:7], a[72:75], v[8:11]
    ds_read_b128 a[68:71], v161 offset:33792
    v_mfma_f32_16x16x32_bf16 v[12:15], a[4:7], a[76:79], v[12:15]
    ds_read_b128 a[80:83], v161 offset:34816
    v_mfma_f32_16x16x32_bf16 v[16:19], a[16:19], a[72:75], v[16:19]
    ds_read_b128 a[84:87], v161 offset:35840
    v_mfma_f32_16x16x32_bf16 v[20:23], a[16:19], a[76:79], v[20:23]
    ds_read_b128 a[96:99], v161 offset:36864
    s_waitcnt lgkmcnt(7)
    v_mfma_f32_16x16x32_bf16 v[24:27], a[20:23], a[72:75], v[24:27]
    ds_read_b128 a[100:103], v161 offset:37888
    v_mfma_f32_16x16x32_bf16 v[28:31], a[20:23], a[76:79], v[28:31]
    ds_read_b128 a[112:115], v161 offset:38912
    v_mfma_f32_16x16x32_bf16 v[40:43], a[32:35], a[72:75], v[40:43]
    ds_read_b128 a[116:119], v161 offset:39936
    v_mfma_f32_16x16x32_bf16 v[44:47], a[32:35], a[76:79], v[44:47]
    ds_read_b128 a[128:131], v161 offset:40960
    v_mfma_f32_16x16x32_bf16 v[56:59], a[36:39], a[72:75], v[56:59]
    ds_read_b128 a[132:135], v161 offset:41984
    v_mfma_f32_16x16x32_bf16 v[60:63], a[36:39], a[76:79], v[60:63]
    s_waitcnt lgkmcnt(9)
    v_mfma_f32_16x16x32_bf16 v[72:75], a[48:51], a[72:75], v[72:75]
    v_mfma_f32_16x16x32_bf16 v[76:79], a[48:51], a[76:79], v[76:79]
    v_mfma_f32_16x16x32_bf16 v[88:91], a[52:55], a[72:75], v[88:91]
    v_mfma_f32_16x16x32_bf16 v[92:95], a[52:55], a[76:79], v[92:95]
    v_mfma_f32_16x16x32_bf16 a[144:147], a[64:67], a[72:75], a[144:147]
    v_mfma_f32_16x16x32_bf16 a[148:151], a[64:67], a[76:79], a[148:151]
    s_waitcnt lgkmcnt(6)
    v_mfma_f32_16x16x32_bf16 v[0:3], a[68:71], a[88:91], v[0:3]
    s_mov_b32 s41, 32768
    buffer_load_dwordx4 a[24:27], v164, s[8:11], s41 offen offset:0 sc1
    buffer_load_dwordx4 a[28:31], v164, s[8:11], s41 offen offset:1024 sc1
    v_mfma_f32_16x16x32_bf16 v[4:7], a[68:71], a[92:95], v[4:7]
    v_mfma_f32_16x16x32_bf16 v[8:11], a[80:83], a[88:91], v[8:11]
    ds_read_b128 a[0:3], v161 offset:43008
    v_mfma_f32_16x16x32_bf16 v[12:15], a[80:83], a[92:95], v[12:15]
    ds_read_b128 a[4:7], v161 offset:44032
    v_mfma_f32_16x16x32_bf16 v[16:19], a[84:87], a[88:91], v[16:19]
    ds_read_b128 a[16:19], v161 offset:45056
    v_mfma_f32_16x16x32_bf16 v[20:23], a[84:87], a[92:95], v[20:23]
    ds_read_b128 a[20:23], v161 offset:46080
    s_waitcnt lgkmcnt(7)
    v_mfma_f32_16x16x32_bf16 v[24:27], a[96:99], a[88:91], v[24:27]
    ds_read_b128 a[32:35], v161 offset:47104
    v_mfma_f32_16x16x32_bf16 v[28:31], a[96:99], a[92:95], v[28:31]
    ds_read_b128 a[36:39], v161 offset:48128
    v_mfma_f32_16x16x32_bf16 v[40:43], a[100:103], a[88:91], v[40:43]
    ds_read_b128 a[48:51], v161 offset:49152
    v_mfma_f32_16x16x32_bf16 v[44:47], a[100:103], a[92:95], v[44:47]
    ds_read_b128 a[52:55], v161 offset:50176
    v_mfma_f32_16x16x32_bf16 v[56:59], a[112:115], a[88:91], v[56:59]
    ds_read_b128 a[64:67], v161 offset:51200
    v_mfma_f32_16x16x32_bf16 v[60:63], a[112:115], a[92:95], v[60:63]
    s_waitcnt lgkmcnt(9)
    v_mfma_f32_16x16x32_bf16 v[72:75], a[116:119], a[88:91], v[72:75]
    v_mfma_f32_16x16x32_bf16 v[76:79], a[116:119], a[92:95], v[76:79]
    v_mfma_f32_16x16x32_bf16 v[88:91], a[128:131], a[88:91], v[88:91]
    v_mfma_f32_16x16x32_bf16 v[92:95], a[128:131], a[92:95], v[92:95]
    v_mfma_f32_16x16x32_bf16 a[144:147], a[132:135], a[88:91], a[144:147]
    v_mfma_f32_16x16x32_bf16 a[148:151], a[132:135], a[92:95], a[148:151]
    s_waitcnt lgkmcnt(6)
    v_mfma_f32_16x16x32_bf16 v[0:3], a[0:3], a[104:107], v[0:3]
    s_mov_b32 s41, 49152
    buffer_load_dwordx4 a[40:43], v164, s[8:11], s41 offen offset:0 sc1
    buffer_load_dwordx4 a[44:47], v164, s[8:11], s41 offen offset:1024 sc1
    v_mfma_f32_16x16x32_bf16 v[4:7], a[0:3], a[108:111], v[4:7]
    v_mfma_f32_16x16x32_bf16 v[8:11], a[4:7], a[104:107], v[8:11]
    ds_read_b128 a[68:71], v161 offset:52224
    v_mfma_f32_16x16x32_bf16 v[12:15], a[4:7], a[108:111], v[12:15]
    ds_read_b128 a[80:83], v161 offset:53248
    v_mfma_f32_16x16x32_bf16 v[16:19], a[16:19], a[104:107], v[16:19]
    ds_read_b128 a[84:87], v161 offset:54272
    v_mfma_f32_16x16x32_bf16 v[20:23], a[16:19], a[108:111], v[20:23]
    ds_read_b128 a[96:99], v161 offset:55296
    s_waitcnt lgkmcnt(7)
    v_mfma_f32_16x16x32_bf16 v[24:27], a[20:23], a[104:107], v[24:27]
    ds_read_b128 a[100:103], v161 offset:56320
    v_mfma_f32_16x16x32_bf16 v[28:31], a[20:23], a[108:111], v[28:31]
    ds_read_b128 a[112:115], v161 offset:57344
    v_mfma_f32_16x16x32_bf16 v[40:43], a[32:35], a[104:107], v[40:43]
    ds_read_b128 a[116:119], v161 offset:58368
    v_mfma_f32_16x16x32_bf16 v[44:47], a[32:35], a[108:111], v[44:47]
    ds_read_b128 a[128:131], v161 offset:59392
    v_mfma_f32_16x16x32_bf16 v[56:59], a[36:39], a[104:107], v[56:59]
    ds_read_b128 a[132:135], v161 offset:60416
    v_mfma_f32_16x16x32_bf16 v[60:63], a[36:39], a[108:111], v[60:63]
    s_waitcnt lgkmcnt(9)
    v_mfma_f32_16x16x32_bf16 v[72:75], a[48:51], a[104:107], v[72:75]
    v_mfma_f32_16x16x32_bf16 v[76:79], a[48:51], a[108:111], v[76:79]
    v_mfma_f32_16x16x32_bf16 v[88:91], a[52:55], a[104:107], v[88:91]
    v_mfma_f32_16x16x32_bf16 v[92:95], a[52:55], a[108:111], v[92:95]
    v_mfma_f32_16x16x32_bf16 a[144:147], a[64:67], a[104:107], a[144:147]
    v_mfma_f32_16x16x32_bf16 a[148:151], a[64:67], a[108:111], a[148:151]
    s_waitcnt lgkmcnt(6)
    v_mfma_f32_16x16x32_bf16 v[0:3], a[68:71], a[120:123], v[0:3]
    s_mov_b32 s41, 69632
    buffer_load_dwordx4 a[56:59], v164, s[8:11], s41 offen offset:0 sc1
    buffer_load_dwordx4 a[60:63], v164, s[8:11], s41 offen offset:1024 sc1
    v_mfma_f32_16x16x32_bf16 v[4:7], a[68:71], a[124:127], v[4:7]
    v_mfma_f32_16x16x32_bf16 v[8:11], a[80:83], a[120:123], v[8:11]
    s_barrier
    v_mfma_f32_16x16x32_bf16 v[12:15], a[80:83], a[124:127], v[12:15]
    ds_read_b128 a[0:3], v161 offset:61440
    s_add_u32 m0, s31, 40960
    s_mov_b32 s40, 258048
    buffer_load_dwordx4 v163, s[12:15], s40 offen sc1 lds
    v_mfma_f32_16x16x32_bf16 v[16:19], a[84:87], a[120:123], v[16:19]
    ds_read_b128 a[4:7], v161 offset:62464
    s_add_u32 m0, s31, 45056
    s_mov_b32 s40, 262144
    buffer_load_dwordx4 v163, s[12:15], s40 offen sc1 lds
    v_mfma_f32_16x16x32_bf16 v[20:23], a[84:87], a[124:127], v[20:23]
    ds_read_b128 a[16:19], v161 offset:63488
    s_add_u32 m0, s31, 49152
    s_mov_b32 s40, 266240
    buffer_load_dwordx4 v163, s[12:15], s40 offen sc1 lds
    s_waitcnt lgkmcnt(6)
    v_mfma_f32_16x16x32_bf16 v[24:27], a[96:99], a[120:123], v[24:27]
    ds_read_b128 a[20:23], v161 offset:64512
    s_add_u32 m0, s31, 53248
    s_mov_b32 s40, 270336
    buffer_load_dwordx4 v163, s[12:15], s40 offen sc1 lds
    v_mfma_f32_16x16x32_bf16 v[28:31], a[96:99], a[124:127], v[28:31]
    ds_read_b128 a[32:35], v162 offset:0
    s_add_u32 m0, s31, 57344
    s_mov_b32 s40, 274432
    buffer_load_dwordx4 v163, s[12:15], s40 offen sc1 lds
    v_mfma_f32_16x16x32_bf16 v[40:43], a[100:103], a[120:123], v[40:43]
    ds_read_b128 a[36:39], v162 offset:1024
    s_add_u32 m0, s31, 61440
    s_mov_b32 s40, 278528
    buffer_load_dwordx4 v163, s[12:15], s40 offen sc1 lds
    v_mfma_f32_16x16x32_bf16 v[44:47], a[100:103], a[124:127], v[44:47]
    ds_read_b128 a[48:51], v162 offset:2048
    s_add_u32 m0, s31, 65536
    s_mov_b32 s40, 282624
    buffer_load_dwordx4 v163, s[12:15], s40 offen sc1 lds
    v_mfma_f32_16x16x32_bf16 v[56:59], a[112:115], a[120:123], v[56:59]
    ds_read_b128 a[52:55], v162 offset:3072
    s_add_u32 m0, s31, 69632
    s_mov_b32 s40, 286720
    buffer_load_dwordx4 v163, s[12:15], s40 offen sc1 lds
    v_mfma_f32_16x16x32_bf16 v[60:63], a[112:115], a[124:127], v[60:63]
    ds_read_b128 a[64:67], v162 offset:4096
    s_add_u32 m0, s31, 73728
    s_mov_b32 s40, 290816
    buffer_load_dwordx4 v163, s[12:15], s40 offen sc1 lds
    s_waitcnt lgkmcnt(9)
    v_mfma_f32_16x16x32_bf16 v[72:75], a[116:119], a[120:123], v[72:75]
    v_mfma_f32_16x16x32_bf16 v[76:79], a[116:119], a[124:127], v[76:79]
    v_mfma_f32_16x16x32_bf16 v[88:91], a[128:131], a[120:123], v[88:91]
    v_mfma_f32_16x16x32_bf16 v[92:95], a[128:131], a[124:127], v[92:95]
    v_mfma_f32_16x16x32_bf16 a[144:147], a[132:135], a[120:123], a[144:147]
    v_mfma_f32_16x16x32_bf16 a[148:151], a[132:135], a[124:127], a[148:151]
    s_waitcnt lgkmcnt(6)
    v_mfma_f32_16x16x32_bf16 v[0:3], a[0:3], a[136:139], v[0:3]
    s_mov_b32 s41, 86016
    buffer_load_dwordx4 a[72:75], v164, s[8:11], s41 offen offset:0 sc1
    buffer_load_dwordx4 a[76:79], v164, s[8:11], s41 offen offset:1024 sc1
    v_mfma_f32_16x16x32_bf16 v[4:7], a[0:3], a[140:143], v[4:7]
    v_mfma_f32_16x16x32_bf16 v[8:11], a[4:7], a[136:139], v[8:11]
    ds_read_b128 a[68:71], v162 offset:5120
    v_mfma_f32_16x16x32_bf16 v[12:15], a[4:7], a[140:143], v[12:15]
    ds_read_b128 a[80:83], v162 offset:6144
    v_mfma_f32_16x16x32_bf16 v[16:19], a[16:19], a[136:139], v[16:19]
    ds_read_b128 a[84:87], v162 offset:7168
    v_mfma_f32_16x16x32_bf16 v[20:23], a[16:19], a[140:143], v[20:23]
    ds_read_b128 a[96:99], v162 offset:8192
    s_waitcnt lgkmcnt(7)
    v_mfma_f32_16x16x32_bf16 v[24:27], a[20:23], a[136:139], v[24:27]
    ds_read_b128 a[100:103], v162 offset:9216
    v_mfma_f32_16x16x32_bf16 v[28:31], a[20:23], a[140:143], v[28:31]
    ds_read_b128 a[112:115], v162 offset:10240
    v_mfma_f32_16x16x32_bf16 v[40:43], a[32:35], a[136:139], v[40:43]
    ds_read_b128 a[116:119], v162 offset:11264
    v_mfma_f32_16x16x32_bf16 v[44:47], a[32:35], a[140:143], v[44:47]
    ds_read_b128 a[128:131], v162 offset:12288
    v_mfma_f32_16x16x32_bf16 v[56:59], a[36:39], a[136:139], v[56:59]
    ds_read_b128 a[132:135], v162 offset:13312
    v_mfma_f32_16x16x32_bf16 v[60:63], a[36:39], a[140:143], v[60:63]
    s_waitcnt lgkmcnt(9)
    v_mfma_f32_16x16x32_bf16 v[72:75], a[48:51], a[136:139], v[72:75]
    v_mfma_f32_16x16x32_bf16 v[76:79], a[48:51], a[140:143], v[76:79]
    v_mfma_f32_16x16x32_bf16 v[88:91], a[52:55], a[136:139], v[88:91]
    v_mfma_f32_16x16x32_bf16 v[92:95], a[52:55], a[140:143], v[92:95]
    v_mfma_f32_16x16x32_bf16 a[144:147], a[64:67], a[136:139], a[144:147]
    v_mfma_f32_16x16x32_bf16 a[148:151], a[64:67], a[140:143], a[148:151]
    s_waitcnt lgkmcnt(6)
    v_mfma_f32_16x16x32_bf16 v[0:3], a[68:71], a[152:155], v[0:3]
    s_mov_b32 s41, 106496
    buffer_load_dwordx4 a[88:91], v164, s[8:11], s41 offen offset:0 sc1
    buffer_load_dwordx4 a[92:95], v164, s[8:11], s41 offen offset:1024 sc1
    v_mfma_f32_16x16x32_bf16 v[4:7], a[68:71], a[156:159], v[4:7]
    buffer_load_dword v209, v208, s[64:67], 0 offen sc1
    v_mfma_f32_16x16x32_bf16 v[8:11], a[80:83], a[152:155], v[8:11]
    ds_read_b128 a[0:3], v162 offset:14336
    v_mfma_f32_16x16x32_bf16 v[12:15], a[80:83], a[156:159], v[12:15]
    ds_read_b128 a[4:7], v162 offset:15360
    v_mfma_f32_16x16x32_bf16 v[16:19], a[84:87], a[152:155], v[16:19]
    ds_read_b128 a[16:19], v162 offset:16384
    v_mfma_f32_16x16x32_bf16 v[20:23], a[84:87], a[156:159], v[20:23]
    ds_read_b128 a[20:23], v162 offset:17408
    s_waitcnt lgkmcnt(7)
    v_mfma_f32_16x16x32_bf16 v[24:27], a[96:99], a[152:155], v[24:27]
    ds_read_b128 a[32:35], v162 offset:18432
    v_mfma_f32_16x16x32_bf16 v[28:31], a[96:99], a[156:159], v[28:31]
    ds_read_b128 a[36:39], v162 offset:19456
    v_mfma_f32_16x16x32_bf16 v[40:43], a[100:103], a[152:155], v[40:43]
    ds_read_b128 a[48:51], v162 offset:20480
    v_mfma_f32_16x16x32_bf16 v[44:47], a[100:103], a[156:159], v[44:47]
    ds_read_b128 a[52:55], v162 offset:21504
    v_mfma_f32_16x16x32_bf16 v[56:59], a[112:115], a[152:155], v[56:59]
    ds_read_b128 a[64:67], v162 offset:22528
    v_mfma_f32_16x16x32_bf16 v[60:63], a[112:115], a[156:159], v[60:63]
    s_waitcnt lgkmcnt(9)
    v_mfma_f32_16x16x32_bf16 v[72:75], a[116:119], a[152:155], v[72:75]
    v_mfma_f32_16x16x32_bf16 v[76:79], a[116:119], a[156:159], v[76:79]
    v_mfma_f32_16x16x32_bf16 v[88:91], a[128:131], a[152:155], v[88:91]
    v_mfma_f32_16x16x32_bf16 v[92:95], a[128:131], a[156:159], v[92:95]
    v_mfma_f32_16x16x32_bf16 a[144:147], a[132:135], a[152:155], a[144:147]
    v_mfma_f32_16x16x32_bf16 a[148:151], a[132:135], a[156:159], a[148:151]
    s_waitcnt vmcnt(33)
    s_waitcnt lgkmcnt(6)
    v_mfma_f32_16x16x32_bf16 v[0:3], a[0:3], a[168:171], v[0:3]
    s_mov_b32 s41, 122880
    buffer_load_dwordx4 a[104:107], v164, s[8:11], s41 offen offset:0 sc1
    buffer_load_dwordx4 a[108:111], v164, s[8:11], s41 offen offset:1024 sc1
    v_mfma_f32_16x16x32_bf16 v[4:7], a[0:3], a[172:175], v[4:7]
    v_mfma_f32_16x16x32_bf16 v[8:11], a[4:7], a[168:171], v[8:11]
    ds_read_b128 a[68:71], v162 offset:23552
    v_mfma_f32_16x16x32_bf16 v[12:15], a[4:7], a[172:175], v[12:15]
    ds_read_b128 a[80:83], v162 offset:24576
    v_mfma_f32_16x16x32_bf16 v[16:19], a[16:19], a[168:171], v[16:19]
    ds_read_b128 a[84:87], v162 offset:25600
    v_mfma_f32_16x16x32_bf16 v[20:23], a[16:19], a[172:175], v[20:23]
    ds_read_b128 a[96:99], v162 offset:26624
    s_waitcnt lgkmcnt(7)
    v_mfma_f32_16x16x32_bf16 v[24:27], a[20:23], a[168:171], v[24:27]
    ds_read_b128 a[100:103], v162 offset:27648
    v_mfma_f32_16x16x32_bf16 v[28:31], a[20:23], a[172:175], v[28:31]
    ds_read_b128 a[112:115], v162 offset:28672
    v_mfma_f32_16x16x32_bf16 v[40:43], a[32:35], a[168:171], v[40:43]
    ds_read_b128 a[116:119], v162 offset:29696
    v_mfma_f32_16x16x32_bf16 v[44:47], a[32:35], a[172:175], v[44:47]
    ds_read_b128 a[128:131], v162 offset:30720
    v_mfma_f32_16x16x32_bf16 v[56:59], a[36:39], a[168:171], v[56:59]
    ds_read_b128 a[132:135], v162 offset:31744
    v_mfma_f32_16x16x32_bf16 v[60:63], a[36:39], a[172:175], v[60:63]
    s_waitcnt lgkmcnt(9)
    v_mfma_f32_16x16x32_bf16 v[72:75], a[48:51], a[168:171], v[72:75]
    v_mfma_f32_16x16x32_bf16 v[76:79], a[48:51], a[172:175], v[76:79]
    v_mfma_f32_16x16x32_bf16 v[88:91], a[52:55], a[168:171], v[88:91]
    v_mfma_f32_16x16x32_bf16 v[92:95], a[52:55], a[172:175], v[92:95]
    v_mfma_f32_16x16x32_bf16 a[144:147], a[64:67], a[168:171], a[144:147]
    v_mfma_f32_16x16x32_bf16 a[148:151], a[64:67], a[172:175], a[148:151]
    s_waitcnt vmcnt(33)
    s_waitcnt lgkmcnt(6)
    v_mfma_f32_16x16x32_bf16 v[0:3], a[68:71], a[184:187], v[0:3]
    s_mov_b32 s41, 143360
    buffer_load_dwordx4 a[120:123], v164, s[8:11], s41 offen offset:0 sc1
    buffer_load_dwordx4 a[124:127], v164, s[8:11], s41 offen offset:1024 sc1
    v_mfma_f32_16x16x32_bf16 v[4:7], a[68:71], a[188:191], v[4:7]
    v_mfma_f32_16x16x32_bf16 v[8:11], a[80:83], a[184:187], v[8:11]
    s_waitcnt vmcnt(26)
    s_barrier
    v_mfma_f32_16x16x32_bf16 v[12:15], a[80:83], a[188:191], v[12:15]
    ds_read_b128 a[0:3], v160 offset:4096
    s_add_u32 m0, s31, 90112
    s_mov_b32 s40, 294912
    buffer_load_dwordx4 v163, s[12:15], s40 offen sc1 lds
    v_mfma_f32_16x16x32_bf16 v[16:19], a[84:87], a[184:187], v[16:19]
    ds_read_b128 a[4:7], v160 offset:5120
    s_add_u32 m0, s31, 94208
    s_mov_b32 s40, 299008
    buffer_load_dwordx4 v163, s[12:15], s40 offen sc1 lds
    v_mfma_f32_16x16x32_bf16 v[20:23], a[84:87], a[188:191], v[20:23]
    ds_read_b128 a[16:19], v160 offset:6144
    s_add_u32 m0, s31, 98304
    s_mov_b32 s40, 303104
    buffer_load_dwordx4 v163, s[12:15], s40 offen sc1 lds
    s_waitcnt lgkmcnt(6)
    v_mfma_f32_16x16x32_bf16 v[24:27], a[96:99], a[184:187], v[24:27]
    ds_read_b128 a[20:23], v160 offset:7168
    s_add_u32 m0, s31, 102400
    s_mov_b32 s40, 307200
    buffer_load_dwordx4 v163, s[12:15], s40 offen sc1 lds
    v_mfma_f32_16x16x32_bf16 v[28:31], a[96:99], a[188:191], v[28:31]
    ds_read_b128 a[32:35], v160 offset:8192
    s_add_u32 m0, s31, 106496
    s_mov_b32 s40, 311296
    buffer_load_dwordx4 v163, s[12:15], s40 offen sc1 lds
    v_mfma_f32_16x16x32_bf16 v[40:43], a[100:103], a[184:187], v[40:43]
    ds_read_b128 a[36:39], v160 offset:9216
    s_add_u32 m0, s31, 110592
    s_mov_b32 s40, 315392
    buffer_load_dwordx4 v163, s[12:15], s40 offen sc1 lds
    v_mfma_f32_16x16x32_bf16 v[44:47], a[100:103], a[188:191], v[44:47]
    ds_read_b128 a[48:51], v160 offset:10240
    s_add_u32 m0, s31, 114688
    s_mov_b32 s40, 319488
    buffer_load_dwordx4 v163, s[12:15], s40 offen sc1 lds
    v_mfma_f32_16x16x32_bf16 v[56:59], a[112:115], a[184:187], v[56:59]
    ds_read_b128 a[52:55], v160 offset:11264
    s_add_u32 m0, s31, 118784
    s_mov_b32 s40, 323584
    buffer_load_dwordx4 v163, s[12:15], s40 offen sc1 lds
    v_mfma_f32_16x16x32_bf16 v[60:63], a[112:115], a[188:191], v[60:63]
    ds_read_b128 a[64:67], v160 offset:12288
    s_add_u32 m0, s31, 122880
    s_mov_b32 s40, 327680
    buffer_load_dwordx4 v163, s[12:15], s40 offen sc1 lds
    s_waitcnt lgkmcnt(9)
    v_mfma_f32_16x16x32_bf16 v[72:75], a[116:119], a[184:187], v[72:75]
    v_mfma_f32_16x16x32_bf16 v[76:79], a[116:119], a[188:191], v[76:79]
    v_mfma_f32_16x16x32_bf16 v[88:91], a[128:131], a[184:187], v[88:91]
    v_mfma_f32_16x16x32_bf16 v[92:95], a[128:131], a[188:191], v[92:95]
    v_mfma_f32_16x16x32_bf16 a[144:147], a[132:135], a[184:187], a[144:147]
    v_mfma_f32_16x16x32_bf16 a[148:151], a[132:135], a[188:191], a[148:151]
    s_lshl_b32 s36, s28, 7
    s_lshl_b32 s37, s58, 5
    s_add_u32 s36, s36, s37
    s_mul_i32 s37, s29, 288
    s_lshl_b32 s38, s30, 6
    s_add_u32 s38, s38, s37
    s_mul_i32 s39, s29, 18
    v_add_u32 v168, s36, v167
    v_mul_u32_u24 v169, 1152, v168
    v_add_u32 v170, s38, v169
    v_lshl_add_u32 v176, v166, 4, v170
    v_lshlrev_b32 v170, 6, v168
    v_lshl_add_u32 v180, v166, 4, v170
    v_add_u32 v168, s36, v167
    v_add_u32 v168, 16, v168
    v_mul_u32_u24 v169, 1152, v168
    v_add_u32 v170, s38, v169
    v_lshl_add_u32 v177, v166, 4, v170
    v_lshlrev_b32 v170, 6, v168
    v_lshl_add_u32 v181, v166, 4, v170
    s_lshr_b32 s43, s36, 6
    s_mul_i32 s43, s43, 73728
    s_bfe_u32 s44, s36, 0x20004
    s_lshl_b32 s44, s44, 10
    s_add_u32 s43, s43, s44
    s_lshl_b32 s45, s30, 2
    s_add_u32 s42, s39, s45
    v_add_u32 v168, s42, v166
    v_lshrrev_b32 v169, 2, v168
    v_lshlrev_b32 v169, 12, v169
    v_and_b32 v168, 3, v168
    v_lshl_add_u32 v168, v168, 4, v167
    v_lshl_add_u32 v168, v168, 4, v169
    v_add_u32 v178, s43, v168
    v_add_u32 v179, 1024, v178
    s_and_b32 s44, s30, 1
    s_lshl_b32 s45, s44, 10
    s_add_u32 s45, s45, s43
    s_add_u32 s42, s39, 16
    v_lshrrev_b32 v168, 1, v166
    v_add_u32 v168, s42, v168
    v_lshrrev_b32 v169, 2, v168
    v_lshlrev_b32 v169, 12, v169
    v_and_b32 v168, 3, v168
    v_lshl_add_u32 v168, v168, 4, v167
    v_lshl_add_u32 v168, v168, 4, v169
    v_add_u32 v183, s45, v168
    v_and_b32 v168, 1, v166
    v_lshl_add_u32 v183, v168, 3, v183
    s_lshl_b32 s45, s44, 4
    s_add_u32 s45, s45, s36
    v_add_u32 v168, s45, v167
    v_mul_u32_u24 v168, 1152, v168
    s_add_u32 s45, s37, 256
    v_add_u32 v168, s45, v168
    v_lshl_add_u32 v182, v166, 3, v168
    s_add_u32 s16, s4, 4194304
    s_addc_u32 s17, s5, 0
    s_mov_b32 s18, 2359296
    s_mov_b32 s19, 0x20000
    s_mov_b32 s20, s6
    s_mov_b32 s21, s7
    s_mov_b32 s22, 2359296
    s_mov_b32 s23, 0x20000
    s_add_u32 s24, s4, 8388608
    s_addc_u32 s25, s5, 0
    s_mov_b32 s26, 131072
    s_mov_b32 s27, 0x20000
    s_lshl_b32 s46, s28, 2
    s_add_u32 s46, s46, s29
    s_mul_i32 s47, s46, 147456
    s_add_u32 s47, s47, 54525952
    s_add_u32 s48, s4, s47
    s_addc_u32 s49, s5, 0
    s_mov_b32 s50, 147456
    s_mov_b32 s51, 0x20000
    s_lshl_b32 s47, s46, 6
    s_add_u32 s47, s47, 9969664
    s_add_u32 s52, s4, s47
    s_addc_u32 s53, s5, 0
    s_mov_b32 s54, 64
    s_mov_b32 s55, 0x20000
    s_waitcnt vmcnt(33)
    s_waitcnt lgkmcnt(6)
    v_mfma_f32_16x16x32_bf16 v[0:3], a[0:3], a[8:11], v[0:3]
    s_waitcnt vmcnt(13)
    v_cmp_gt_u32 vcc, 5, v209
    s_nop 0
    s_cmp_eq_u64 vcc, 0
    s_cbranch_scc1 L_fk_kernel_r32_ok
    s_mov_b32 s43, 0x10000
L_fk_kernel_r32_spin:
    buffer_load_dword v209, v208, s[64:67], 0 offen sc1
    s_waitcnt vmcnt(0)
    v_cmp_gt_u32 vcc, 5, v209
    s_nop 0
    s_cmp_eq_u64 vcc, 0
    s_cbranch_scc1 L_fk_kernel_r32_ok
    s_sleep 1
    s_sub_u32 s43, s43, 1
    s_cmp_lg_u32 s43, 0
    s_cbranch_scc1 L_fk_kernel_r32_spin
L_fk_kernel_r32_ok:
    s_mov_b32 s41, 16384
    buffer_load_dwordx4 a[136:139], v164, s[8:11], s41 offen offset:0 sc1
    buffer_load_dwordx4 a[140:143], v164, s[8:11], s41 offen offset:1024 sc1
    v_mfma_f32_16x16x32_bf16 v[4:7], a[0:3], a[12:15], v[4:7]
    v_mfma_f32_16x16x32_bf16 v[8:11], a[4:7], a[8:11], v[8:11]
    ds_read_b128 a[68:71], v160 offset:13312
    v_mfma_f32_16x16x32_bf16 v[12:15], a[4:7], a[12:15], v[12:15]
    ds_read_b128 a[80:83], v160 offset:14336
    v_mfma_f32_16x16x32_bf16 v[16:19], a[16:19], a[8:11], v[16:19]
    ds_read_b128 a[84:87], v160 offset:15360
    v_mfma_f32_16x16x32_bf16 v[20:23], a[16:19], a[12:15], v[20:23]
    ds_read_b128 a[96:99], v160 offset:16384
    s_waitcnt lgkmcnt(7)
    v_mfma_f32_16x16x32_bf16 v[24:27], a[20:23], a[8:11], v[24:27]
    ds_read_b128 a[100:103], v160 offset:17408
    v_mfma_f32_16x16x32_bf16 v[28:31], a[20:23], a[12:15], v[28:31]
    ds_read_b128 a[112:115], v160 offset:18432
    v_mfma_f32_16x16x32_bf16 v[40:43], a[32:35], a[8:11], v[40:43]
    ds_read_b128 a[116:119], v160 offset:19456
    v_mfma_f32_16x16x32_bf16 v[44:47], a[32:35], a[12:15], v[44:47]
    ds_read_b128 a[128:131], v160 offset:20480
    v_mfma_f32_16x16x32_bf16 v[56:59], a[36:39], a[8:11], v[56:59]
    ds_read_b128 a[132:135], v160 offset:21504
    v_mfma_f32_16x16x32_bf16 v[60:63], a[36:39], a[12:15], v[60:63]
    s_waitcnt lgkmcnt(9)
    v_mfma_f32_16x16x32_bf16 v[72:75], a[48:51], a[8:11], v[72:75]
    v_mfma_f32_16x16x32_bf16 v[76:79], a[48:51], a[12:15], v[76:79]
    v_mfma_f32_16x16x32_bf16 v[88:91], a[52:55], a[8:11], v[88:91]
    v_mfma_f32_16x16x32_bf16 v[92:95], a[52:55], a[12:15], v[92:95]
    v_mfma_f32_16x16x32_bf16 a[144:147], a[64:67], a[8:11], a[144:147]
    v_mfma_f32_16x16x32_bf16 a[148:151], a[64:67], a[12:15], a[148:151]
    s_waitcnt lgkmcnt(6)
    v_mfma_f32_16x16x32_bf16 v[0:3], a[68:71], a[24:27], v[0:3]
    s_mov_b32 s41, 53248
    buffer_load_dwordx4 a[152:155], v164, s[8:11], s41 offen offset:0 sc1
    buffer_load_dwordx4 a[156:159], v164, s[8:11], s41 offen offset:1024 sc1
    v_mfma_f32_16x16x32_bf16 v[4:7], a[68:71], a[28:31], v[4:7]
    v_mfma_f32_16x16x32_bf16 v[8:11], a[80:83], a[24:27], v[8:11]
    ds_read_b128 a[0:3], v160 offset:22528
    v_mfma_f32_16x16x32_bf16 v[12:15], a[80:83], a[28:31], v[12:15]
    ds_read_b128 a[4:7], v160 offset:23552
    v_mfma_f32_16x16x32_bf16 v[16:19], a[84:87], a[24:27], v[16:19]
    ds_read_b128 a[16:19], v160 offset:24576
    v_mfma_f32_16x16x32_bf16 v[20:23], a[84:87], a[28:31], v[20:23]
    ds_read_b128 a[20:23], v160 offset:25600
    s_waitcnt lgkmcnt(7)
    v_mfma_f32_16x16x32_bf16 v[24:27], a[96:99], a[24:27], v[24:27]
    ds_read_b128 a[32:35], v160 offset:26624
    v_mfma_f32_16x16x32_bf16 v[28:31], a[96:99], a[28:31], v[28:31]
    ds_read_b128 a[36:39], v160 offset:27648
    v_mfma_f32_16x16x32_bf16 v[40:43], a[100:103], a[24:27], v[40:43]
    ds_read_b128 a[48:51], v160 offset:28672
    v_mfma_f32_16x16x32_bf16 v[44:47], a[100:103], a[28:31], v[44:47]
    ds_read_b128 a[52:55], v160 offset:29696
    v_mfma_f32_16x16x32_bf16 v[56:59], a[112:115], a[24:27], v[56:59]
    ds_read_b128 a[64:67], v160 offset:30720
    v_mfma_f32_16x16x32_bf16 v[60:63], a[112:115], a[28:31], v[60:63]
    s_waitcnt lgkmcnt(9)
    v_mfma_f32_16x16x32_bf16 v[72:75], a[116:119], a[24:27], v[72:75]
    v_mfma_f32_16x16x32_bf16 v[76:79], a[116:119], a[28:31], v[76:79]
    v_mfma_f32_16x16x32_bf16 v[88:91], a[128:131], a[24:27], v[88:91]
    v_mfma_f32_16x16x32_bf16 v[92:95], a[128:131], a[28:31], v[92:95]
    v_mfma_f32_16x16x32_bf16 a[144:147], a[132:135], a[24:27], a[144:147]
    v_mfma_f32_16x16x32_bf16 a[148:151], a[132:135], a[28:31], a[148:151]
    s_waitcnt lgkmcnt(6)
    v_mfma_f32_16x16x32_bf16 v[0:3], a[0:3], a[40:43], v[0:3]
    s_mov_b32 s41, 90112
    buffer_load_dwordx4 a[168:171], v164, s[8:11], s41 offen offset:0 sc1
    buffer_load_dwordx4 a[172:175], v164, s[8:11], s41 offen offset:1024 sc1
    v_mfma_f32_16x16x32_bf16 v[4:7], a[0:3], a[44:47], v[4:7]
    v_mfma_f32_16x16x32_bf16 v[8:11], a[4:7], a[40:43], v[8:11]
    ds_read_b128 a[68:71], v160 offset:31744
    v_mfma_f32_16x16x32_bf16 v[12:15], a[4:7], a[44:47], v[12:15]
    ds_read_b128 a[80:83], v160 offset:32768
    v_mfma_f32_16x16x32_bf16 v[16:19], a[16:19], a[40:43], v[16:19]
    ds_read_b128 a[84:87], v160 offset:33792
    v_mfma_f32_16x16x32_bf16 v[20:23], a[16:19], a[44:47], v[20:23]
    ds_read_b128 a[96:99], v160 offset:34816
    s_waitcnt lgkmcnt(7)
    v_mfma_f32_16x16x32_bf16 v[24:27], a[20:23], a[40:43], v[24:27]
    ds_read_b128 a[100:103], v160 offset:35840
    v_mfma_f32_16x16x32_bf16 v[28:31], a[20:23], a[44:47], v[28:31]
    ds_read_b128 a[112:115], v160 offset:36864
    v_mfma_f32_16x16x32_bf16 v[40:43], a[32:35], a[40:43], v[40:43]
    ds_read_b128 a[116:119], v160 offset:37888
    v_mfma_f32_16x16x32_bf16 v[44:47], a[32:35], a[44:47], v[44:47]
    ds_read_b128 a[128:131], v160 offset:38912
    v_mfma_f32_16x16x32_bf16 v[56:59], a[36:39], a[40:43], v[56:59]
    ds_read_b128 a[132:135], v160 offset:39936
    v_mfma_f32_16x16x32_bf16 v[60:63], a[36:39], a[44:47], v[60:63]
    s_waitcnt lgkmcnt(9)
    v_mfma_f32_16x16x32_bf16 v[72:75], a[48:51], a[40:43], v[72:75]
    v_mfma_f32_16x16x32_bf16 v[76:79], a[48:51], a[44:47], v[76:79]
    v_mfma_f32_16x16x32_bf16 v[88:91], a[52:55], a[40:43], v[88:91]
    v_mfma_f32_16x16x32_bf16 v[92:95], a[52:55], a[44:47], v[92:95]
    v_mfma_f32_16x16x32_bf16 a[144:147], a[64:67], a[40:43], a[144:147]
    v_mfma_f32_16x16x32_bf16 a[148:151], a[64:67], a[44:47], a[148:151]
    s_waitcnt lgkmcnt(6)
    v_mfma_f32_16x16x32_bf16 v[0:3], a[68:71], a[56:59], v[0:3]
    s_mov_b32 s41, 126976
    buffer_load_dwordx4 a[184:187], v164, s[8:11], s41 offen offset:0 sc1
    buffer_load_dwordx4 a[188:191], v164, s[8:11], s41 offen offset:1024 sc1
    v_mfma_f32_16x16x32_bf16 v[4:7], a[68:71], a[60:63], v[4:7]
    v_mfma_f32_16x16x32_bf16 v[8:11], a[80:83], a[56:59], v[8:11]
    s_barrier
    v_mfma_f32_16x16x32_bf16 v[12:15], a[80:83], a[60:63], v[12:15]
    ds_read_b128 a[0:3], v160 offset:40960
    v_mfma_f32_16x16x32_bf16 v[16:19], a[84:87], a[56:59], v[16:19]
    ds_read_b128 a[4:7], v160 offset:41984
    v_mfma_f32_16x16x32_bf16 v[20:23], a[84:87], a[60:63], v[20:23]
    ds_read_b128 a[16:19], v160 offset:43008
    s_waitcnt lgkmcnt(6)
    v_mfma_f32_16x16x32_bf16 v[24:27], a[96:99], a[56:59], v[24:27]
    ds_read_b128 a[20:23], v160 offset:44032
    v_mfma_f32_16x16x32_bf16 v[28:31], a[96:99], a[60:63], v[28:31]
    ds_read_b128 a[32:35], v160 offset:45056
    v_mfma_f32_16x16x32_bf16 v[40:43], a[100:103], a[56:59], v[40:43]
    ds_read_b128 a[36:39], v160 offset:46080
    v_mfma_f32_16x16x32_bf16 v[44:47], a[100:103], a[60:63], v[44:47]
    ds_read_b128 a[48:51], v160 offset:47104
    v_mfma_f32_16x16x32_bf16 v[56:59], a[112:115], a[56:59], v[56:59]
    ds_read_b128 a[52:55], v160 offset:48128
    v_mfma_f32_16x16x32_bf16 v[60:63], a[112:115], a[60:63], v[60:63]
    ds_read_b128 a[64:67], v160 offset:49152
    s_waitcnt lgkmcnt(9)
    v_mfma_f32_16x16x32_bf16 v[72:75], a[116:119], a[56:59], v[72:75]
    v_mfma_f32_16x16x32_bf16 v[76:79], a[116:119], a[60:63], v[76:79]
    v_mfma_f32_16x16x32_bf16 v[88:91], a[128:131], a[56:59], v[88:91]
    v_mfma_f32_16x16x32_bf16 v[92:95], a[128:131], a[60:63], v[92:95]
    v_mfma_f32_16x16x32_bf16 a[144:147], a[132:135], a[56:59], a[144:147]
    v_mfma_f32_16x16x32_bf16 a[148:151], a[132:135], a[60:63], a[148:151]
    s_waitcnt lgkmcnt(6)
    v_mfma_f32_16x16x32_bf16 v[0:3], a[0:3], a[72:75], v[0:3]
    v_mfma_f32_16x16x32_bf16 v[4:7], a[0:3], a[76:79], v[4:7]
    v_mfma_f32_16x16x32_bf16 v[8:11], a[4:7], a[72:75], v[8:11]
    ds_read_b128 a[68:71], v160 offset:50176
    v_mfma_f32_16x16x32_bf16 v[12:15], a[4:7], a[76:79], v[12:15]
    ds_read_b128 a[80:83], v160 offset:51200
    v_mfma_f32_16x16x32_bf16 v[16:19], a[16:19], a[72:75], v[16:19]
    ds_read_b128 a[84:87], v160 offset:52224
    v_mfma_f32_16x16x32_bf16 v[20:23], a[16:19], a[76:79], v[20:23]
    ds_read_b128 a[96:99], v160 offset:53248
    s_waitcnt lgkmcnt(7)
    v_mfma_f32_16x16x32_bf16 v[24:27], a[20:23], a[72:75], v[24:27]
    ds_read_b128 a[100:103], v160 offset:54272
    v_mfma_f32_16x16x32_bf16 v[28:31], a[20:23], a[76:79], v[28:31]
    ds_read_b128 a[112:115], v160 offset:55296
    v_mfma_f32_16x16x32_bf16 v[40:43], a[32:35], a[72:75], v[40:43]
    ds_read_b128 a[116:119], v160 offset:56320
    v_mfma_f32_16x16x32_bf16 v[44:47], a[32:35], a[76:79], v[44:47]
    ds_read_b128 a[128:131], v160 offset:57344
    v_mfma_f32_16x16x32_bf16 v[56:59], a[36:39], a[72:75], v[56:59]
    ds_read_b128 a[132:135], v160 offset:58368
    v_mfma_f32_16x16x32_bf16 v[60:63], a[36:39], a[76:79], v[60:63]
    s_waitcnt lgkmcnt(9)
    v_mfma_f32_16x16x32_bf16 v[72:75], a[48:51], a[72:75], v[72:75]
    v_mfma_f32_16x16x32_bf16 v[76:79], a[48:51], a[76:79], v[76:79]
    v_mfma_f32_16x16x32_bf16 v[88:91], a[52:55], a[72:75], v[88:91]
    v_mfma_f32_16x16x32_bf16 v[92:95], a[52:55], a[76:79], v[92:95]
    v_mfma_f32_16x16x32_bf16 a[144:147], a[64:67], a[72:75], a[144:147]
    v_mfma_f32_16x16x32_bf16 a[148:151], a[64:67], a[76:79], a[148:151]
    s_waitcnt lgkmcnt(6)
    v_mfma_f32_16x16x32_bf16 v[0:3], a[68:71], a[88:91], v[0:3]
    v_mfma_f32_16x16x32_bf16 v[4:7], a[68:71], a[92:95], v[4:7]
    v_mfma_f32_16x16x32_bf16 v[8:11], a[80:83], a[88:91], v[8:11]
    ds_read_b128 a[0:3], v160 offset:59392
    v_mfma_f32_16x16x32_bf16 v[12:15], a[80:83], a[92:95], v[12:15]
    ds_read_b128 a[4:7], v160 offset:60416
    v_mfma_f32_16x16x32_bf16 v[16:19], a[84:87], a[88:91], v[16:19]
    ds_read_b128 a[16:19], v160 offset:61440
    v_mfma_f32_16x16x32_bf16 v[20:23], a[84:87], a[92:95], v[20:23]
    ds_read_b128 a[20:23], v160 offset:62464
    s_waitcnt lgkmcnt(7)
    v_mfma_f32_16x16x32_bf16 v[24:27], a[96:99], a[88:91], v[24:27]
    ds_read_b128 a[32:35], v160 offset:63488
    v_mfma_f32_16x16x32_bf16 v[28:31], a[96:99], a[92:95], v[28:31]
    ds_read_b128 a[36:39], v160 offset:64512
    v_mfma_f32_16x16x32_bf16 v[40:43], a[100:103], a[88:91], v[40:43]
    ds_read_b128 a[48:51], v161 offset:0
    v_mfma_f32_16x16x32_bf16 v[44:47], a[100:103], a[92:95], v[44:47]
    ds_read_b128 a[52:55], v161 offset:1024
    v_mfma_f32_16x16x32_bf16 v[56:59], a[112:115], a[88:91], v[56:59]
    ds_read_b128 a[64:67], v161 offset:2048
    v_mfma_f32_16x16x32_bf16 v[60:63], a[112:115], a[92:95], v[60:63]
    s_waitcnt lgkmcnt(9)
    v_mfma_f32_16x16x32_bf16 v[72:75], a[116:119], a[88:91], v[72:75]
    v_mfma_f32_16x16x32_bf16 v[76:79], a[116:119], a[92:95], v[76:79]
    v_mfma_f32_16x16x32_bf16 v[88:91], a[128:131], a[88:91], v[88:91]
    v_mfma_f32_16x16x32_bf16 v[92:95], a[128:131], a[92:95], v[92:95]
    v_mfma_f32_16x16x32_bf16 a[144:147], a[132:135], a[88:91], a[144:147]
    v_mfma_f32_16x16x32_bf16 a[148:151], a[132:135], a[92:95], a[148:151]
    s_waitcnt vmcnt(19)
    s_waitcnt lgkmcnt(6)
    v_mfma_f32_16x16x32_bf16 v[0:3], a[0:3], a[104:107], v[0:3]
    buffer_load_dwordx4 v[198:201], v180, s[24:27], 0 offen
    buffer_load_dwordx4 v[188:191], v178, s[16:19], 0 offen
    v_mfma_f32_16x16x32_bf16 v[4:7], a[0:3], a[108:111], v[4:7]
    buffer_load_dwordx4 v[202:205], v181, s[24:27], 0 offen
    buffer_load_dwordx4 v[192:195], v179, s[16:19], 0 offen
    v_mfma_f32_16x16x32_bf16 v[8:11], a[4:7], a[104:107], v[8:11]
    ds_read_b128 a[68:71], v161 offset:3072
    buffer_load_dwordx2 v[196:197], v183, s[16:19], 0 offen
    v_mfma_f32_16x16x32_bf16 v[12:15], a[4:7], a[108:111], v[12:15]
    ds_read_b128 a[80:83], v161 offset:4096
    v_mfma_f32_16x16x32_bf16 v[16:19], a[16:19], a[104:107], v[16:19]
    ds_read_b128 a[84:87], v161 offset:5120
    v_mfma_f32_16x16x32_bf16 v[20:23], a[16:19], a[108:111], v[20:23]
    ds_read_b128 a[96:99], v161 offset:6144
    s_waitcnt lgkmcnt(7)
    v_mfma_f32_16x16x32_bf16 v[24:27], a[20:23], a[104:107], v[24:27]
    ds_read_b128 a[100:103], v161 offset:7168
    v_mfma_f32_16x16x32_bf16 v[28:31], a[20:23], a[108:111], v[28:31]
    ds_read_b128 a[112:115], v161 offset:8192
    v_mfma_f32_16x16x32_bf16 v[40:43], a[32:35], a[104:107], v[40:43]
    ds_read_b128 a[116:119], v161 offset:9216
    v_mfma_f32_16x16x32_bf16 v[44:47], a[32:35], a[108:111], v[44:47]
    ds_read_b128 a[128:131], v161 offset:10240
    v_mfma_f32_16x16x32_bf16 v[56:59], a[36:39], a[104:107], v[56:59]
    ds_read_b128 a[132:135], v161 offset:11264
    v_mfma_f32_16x16x32_bf16 v[60:63], a[36:39], a[108:111], v[60:63]
    s_waitcnt lgkmcnt(9)
    v_mfma_f32_16x16x32_bf16 v[72:75], a[48:51], a[104:107], v[72:75]
    v_mfma_f32_16x16x32_bf16 v[76:79], a[48:51], a[108:111], v[76:79]
    v_mfma_f32_16x16x32_bf16 v[88:91], a[52:55], a[104:107], v[88:91]
    v_mfma_f32_16x16x32_bf16 v[92:95], a[52:55], a[108:111], v[92:95]
    v_mfma_f32_16x16x32_bf16 a[144:147], a[64:67], a[104:107], a[144:147]
    v_mfma_f32_16x16x32_bf16 a[148:151], a[64:67], a[108:111], a[148:151]
    s_waitcnt vmcnt(22)
    s_waitcnt lgkmcnt(6)
    v_mfma_f32_16x16x32_bf16 v[0:3], a[68:71], a[120:123], v[0:3]
    v_mfma_f32_16x16x32_bf16 v[4:7], a[68:71], a[124:127], v[4:7]
    v_mfma_f32_16x16x32_bf16 v[8:11], a[80:83], a[120:123], v[8:11]
    s_waitcnt vmcnt(13)
    s_barrier
    v_mfma_f32_16x16x32_bf16 v[12:15], a[80:83], a[124:127], v[12:15]
    ds_read_b128 a[0:3], v161 offset:24576
    v_mfma_f32_16x16x32_bf16 v[16:19], a[84:87], a[120:123], v[16:19]
    ds_read_b128 a[4:7], v161 offset:25600
    v_mfma_f32_16x16x32_bf16 v[20:23], a[84:87], a[124:127], v[20:23]
    ds_read_b128 a[16:19], v161 offset:26624
    s_waitcnt lgkmcnt(6)
    v_mfma_f32_16x16x32_bf16 v[24:27], a[96:99], a[120:123], v[24:27]
    ds_read_b128 a[20:23], v161 offset:27648
    v_mfma_f32_16x16x32_bf16 v[28:31], a[96:99], a[124:127], v[28:31]
    ds_read_b128 a[32:35], v161 offset:28672
    v_mfma_f32_16x16x32_bf16 v[40:43], a[100:103], a[120:123], v[40:43]
    ds_read_b128 a[36:39], v161 offset:29696
    v_mfma_f32_16x16x32_bf16 v[44:47], a[100:103], a[124:127], v[44:47]
    ds_read_b128 a[48:51], v161 offset:30720
    v_mfma_f32_16x16x32_bf16 v[56:59], a[112:115], a[120:123], v[56:59]
    ds_read_b128 a[52:55], v161 offset:31744
    v_mfma_f32_16x16x32_bf16 v[60:63], a[112:115], a[124:127], v[60:63]
    ds_read_b128 a[64:67], v161 offset:32768
    s_waitcnt lgkmcnt(9)
    v_mfma_f32_16x16x32_bf16 v[72:75], a[116:119], a[120:123], v[72:75]
    v_mfma_f32_16x16x32_bf16 v[76:79], a[116:119], a[124:127], v[76:79]
    v_mfma_f32_16x16x32_bf16 v[88:91], a[128:131], a[120:123], v[88:91]
    v_mfma_f32_16x16x32_bf16 v[92:95], a[128:131], a[124:127], v[92:95]
    v_mfma_f32_16x16x32_bf16 a[144:147], a[132:135], a[120:123], a[144:147]
    v_mfma_f32_16x16x32_bf16 a[148:151], a[132:135], a[124:127], a[148:151]
    s_waitcnt vmcnt(11)
    s_waitcnt lgkmcnt(6)
    v_mfma_f32_16x16x32_bf16 v[0:3], a[0:3], a[136:139], v[0:3]
    v_mfma_f32_16x16x32_bf16 v[4:7], a[0:3], a[140:143], v[4:7]
    v_mfma_f32_16x16x32_bf16 v[8:11], a[4:7], a[136:139], v[8:11]
    ds_read_b128 a[68:71], v161 offset:33792
    v_mfma_f32_16x16x32_bf16 v[12:15], a[4:7], a[140:143], v[12:15]
    ds_read_b128 a[80:83], v161 offset:34816
    v_mfma_f32_16x16x32_bf16 v[16:19], a[16:19], a[136:139], v[16:19]
    ds_read_b128 a[84:87], v161 offset:35840
    v_mfma_f32_16x16x32_bf16 v[20:23], a[16:19], a[140:143], v[20:23]
    ds_read_b128 a[96:99], v161 offset:36864
    s_waitcnt lgkmcnt(7)
    v_mfma_f32_16x16x32_bf16 v[24:27], a[20:23], a[136:139], v[24:27]
    ds_read_b128 a[100:103], v161 offset:37888
    v_mfma_f32_16x16x32_bf16 v[28:31], a[20:23], a[140:143], v[28:31]
    ds_read_b128 a[112:115], v161 offset:38912
    v_mfma_f32_16x16x32_bf16 v[40:43], a[32:35], a[136:139], v[40:43]
    ds_read_b128 a[116:119], v161 offset:39936
    v_mfma_f32_16x16x32_bf16 v[44:47], a[32:35], a[140:143], v[44:47]
    ds_read_b128 a[128:131], v161 offset:40960
    v_mfma_f32_16x16x32_bf16 v[56:59], a[36:39], a[136:139], v[56:59]
    ds_read_b128 a[132:135], v161 offset:41984
    v_mfma_f32_16x16x32_bf16 v[60:63], a[36:39], a[140:143], v[60:63]
    s_waitcnt lgkmcnt(9)
    v_mfma_f32_16x16x32_bf16 v[72:75], a[48:51], a[136:139], v[72:75]
    v_mfma_f32_16x16x32_bf16 v[76:79], a[48:51], a[140:143], v[76:79]
    v_mfma_f32_16x16x32_bf16 v[88:91], a[52:55], a[136:139], v[88:91]
    v_mfma_f32_16x16x32_bf16 v[92:95], a[52:55], a[140:143], v[92:95]
    v_mfma_f32_16x16x32_bf16 a[144:147], a[64:67], a[136:139], a[144:147]
    v_mfma_f32_16x16x32_bf16 a[148:151], a[64:67], a[140:143], a[148:151]
    s_waitcnt vmcnt(9)
    s_waitcnt lgkmcnt(6)
    v_mfma_f32_16x16x32_bf16 v[0:3], a[68:71], a[152:155], v[0:3]
    v_mfma_f32_16x16x32_bf16 v[4:7], a[68:71], a[156:159], v[4:7]
    v_mfma_f32_16x16x32_bf16 v[8:11], a[80:83], a[152:155], v[8:11]
    ds_read_b128 a[0:3], v161 offset:43008
    v_mfma_f32_16x16x32_bf16 v[12:15], a[80:83], a[156:159], v[12:15]
    ds_read_b128 a[4:7], v161 offset:44032
    v_mfma_f32_16x16x32_bf16 v[16:19], a[84:87], a[152:155], v[16:19]
    ds_read_b128 a[16:19], v161 offset:45056
    v_mfma_f32_16x16x32_bf16 v[20:23], a[84:87], a[156:159], v[20:23]
    ds_read_b128 a[20:23], v161 offset:46080
    s_waitcnt lgkmcnt(7)
    v_mfma_f32_16x16x32_bf16 v[24:27], a[96:99], a[152:155], v[24:27]
    ds_read_b128 a[32:35], v161 offset:47104
    v_mfma_f32_16x16x32_bf16 v[28:31], a[96:99], a[156:159], v[28:31]
    ds_read_b128 a[36:39], v161 offset:48128
    v_mfma_f32_16x16x32_bf16 v[40:43], a[100:103], a[152:155], v[40:43]
    ds_read_b128 a[48:51], v161 offset:49152
    v_mfma_f32_16x16x32_bf16 v[44:47], a[100:103], a[156:159], v[44:47]
    ds_read_b128 a[52:55], v161 offset:50176
    v_mfma_f32_16x16x32_bf16 v[56:59], a[112:115], a[152:155], v[56:59]
    ds_read_b128 a[64:67], v161 offset:51200
    v_mfma_f32_16x16x32_bf16 v[60:63], a[112:115], a[156:159], v[60:63]
    s_waitcnt lgkmcnt(9)
    v_mfma_f32_16x16x32_bf16 v[72:75], a[116:119], a[152:155], v[72:75]
    v_mfma_f32_16x16x32_bf16 v[76:79], a[116:119], a[156:159], v[76:79]
    v_mfma_f32_16x16x32_bf16 v[88:91], a[128:131], a[152:155], v[88:91]
    v_mfma_f32_16x16x32_bf16 v[92:95], a[128:131], a[156:159], v[92:95]
    v_mfma_f32_16x16x32_bf16 a[144:147], a[132:135], a[152:155], a[144:147]
    v_mfma_f32_16x16x32_bf16 a[148:151], a[132:135], a[156:159], a[148:151]
    s_waitcnt vmcnt(7)
    s_waitcnt lgkmcnt(6)
    v_mfma_f32_16x16x32_bf16 v[0:3], a[0:3], a[168:171], v[0:3]
    v_mfma_f32_16x16x32_bf16 v[4:7], a[0:3], a[172:175], v[4:7]
    v_mfma_f32_16x16x32_bf16 v[8:11], a[4:7], a[168:171], v[8:11]
    ds_read_b128 a[68:71], v161 offset:52224
    v_mfma_f32_16x16x32_bf16 v[12:15], a[4:7], a[172:175], v[12:15]
    ds_read_b128 a[80:83], v161 offset:53248
    v_mfma_f32_16x16x32_bf16 v[16:19], a[16:19], a[168:171], v[16:19]
    ds_read_b128 a[84:87], v161 offset:54272
    v_mfma_f32_16x16x32_bf16 v[20:23], a[16:19], a[172:175], v[20:23]
    ds_read_b128 a[96:99], v161 offset:55296
    s_waitcnt lgkmcnt(7)
    v_mfma_f32_16x16x32_bf16 v[24:27], a[20:23], a[168:171], v[24:27]
    ds_read_b128 a[100:103], v161 offset:56320
    v_mfma_f32_16x16x32_bf16 v[28:31], a[20:23], a[172:175], v[28:31]
    ds_read_b128 a[112:115], v161 offset:57344
    v_mfma_f32_16x16x32_bf16 v[40:43], a[32:35], a[168:171], v[40:43]
    ds_read_b128 a[116:119], v161 offset:58368
    v_mfma_f32_16x16x32_bf16 v[44:47], a[32:35], a[172:175], v[44:47]
    ds_read_b128 a[128:131], v161 offset:59392
    v_mfma_f32_16x16x32_bf16 v[56:59], a[36:39], a[168:171], v[56:59]
    ds_read_b128 a[132:135], v161 offset:60416
    v_mfma_f32_16x16x32_bf16 v[60:63], a[36:39], a[172:175], v[60:63]
    s_waitcnt lgkmcnt(9)
    v_mfma_f32_16x16x32_bf16 v[72:75], a[48:51], a[168:171], v[72:75]
    v_mfma_f32_16x16x32_bf16 v[76:79], a[48:51], a[172:175], v[76:79]
    v_mfma_f32_16x16x32_bf16 v[88:91], a[52:55], a[168:171], v[88:91]
    v_mfma_f32_16x16x32_bf16 v[92:95], a[52:55], a[172:175], v[92:95]
    v_mfma_f32_16x16x32_bf16 a[144:147], a[64:67], a[168:171], a[144:147]
    v_mfma_f32_16x16x32_bf16 a[148:151], a[64:67], a[172:175], a[148:151]
    s_waitcnt vmcnt(5)
    s_waitcnt lgkmcnt(6)
    v_mfma_f32_16x16x32_bf16 v[0:3], a[68:71], a[184:187], v[0:3]
    v_mfma_f32_16x16x32_bf16 v[4:7], a[68:71], a[188:191], v[4:7]
    v_mfma_f32_16x16x32_bf16 v[8:11], a[80:83], a[184:187], v[8:11]
    v_mfma_f32_16x16x32_bf16 v[12:15], a[80:83], a[188:191], v[12:15]
    v_mfma_f32_16x16x32_bf16 v[16:19], a[84:87], a[184:187], v[16:19]
    v_mfma_f32_16x16x32_bf16 v[20:23], a[84:87], a[188:191], v[20:23]
    s_waitcnt lgkmcnt(3)
    v_mfma_f32_16x16x32_bf16 v[24:27], a[96:99], a[184:187], v[24:27]
    v_mfma_f32_16x16x32_bf16 v[28:31], a[96:99], a[188:191], v[28:31]
    v_mfma_f32_16x16x32_bf16 v[40:43], a[100:103], a[184:187], v[40:43]
    v_mfma_f32_16x16x32_bf16 v[44:47], a[100:103], a[188:191], v[44:47]
    v_mfma_f32_16x16x32_bf16 v[56:59], a[112:115], a[184:187], v[56:59]
    v_mfma_f32_16x16x32_bf16 v[60:63], a[112:115], a[188:191], v[60:63]
    s_waitcnt lgkmcnt(0)
    v_mfma_f32_16x16x32_bf16 v[72:75], a[116:119], a[184:187], v[72:75]
    v_mfma_f32_16x16x32_bf16 v[76:79], a[116:119], a[188:191], v[76:79]
    v_mfma_f32_16x16x32_bf16 v[88:91], a[128:131], a[184:187], v[88:91]
    v_mfma_f32_16x16x32_bf16 v[92:95], a[128:131], a[188:191], v[92:95]
    v_mfma_f32_16x16x32_bf16 a[144:147], a[132:135], a[184:187], a[144:147]
    v_mfma_f32_16x16x32_bf16 a[148:151], a[132:135], a[188:191], a[148:151]
    s_waitcnt vmcnt(0)
    s_cmp_eq_u32 s30, s58
    s_cbranch_scc1 L_fk_kernel_own
    s_lshl_b32 s40, s30, 2
    s_add_u32 s40, s40, s58
    s_lshl_b32 s41, s40, 2
    s_mul_i32 s40, s40, 9216
    v_cvt_pk_bf16_f32 v216, v0, v1
    v_cvt_pk_bf16_f32 v217, v2, v3
    v_cvt_pk_bf16_f32 v218, v8, v9
    v_cvt_pk_bf16_f32 v219, v10, v11
    buffer_store_dwordx4 v[216:219], v160, s[48:51], s40 offen offset:0 sc1
    v_cvt_pk_bf16_f32 v220, v4, v5
    v_cvt_pk_bf16_f32 v221, v6, v7
    v_cvt_pk_bf16_f32 v222, v12, v13
    v_cvt_pk_bf16_f32 v223, v14, v15
    buffer_store_dwordx4 v[220:223], v160, s[48:51], s40 offen offset:1024 sc1
    v_cvt_pk_bf16_f32 v224, v16, v17
    v_cvt_pk_bf16_f32 v225, v18, v19
    v_cvt_pk_bf16_f32 v226, v24, v25
    v_cvt_pk_bf16_f32 v227, v26, v27
    buffer_store_dwordx4 v[224:227], v160, s[48:51], s40 offen offset:2048 sc1
    v_cvt_pk_bf16_f32 v228, v20, v21
    v_cvt_pk_bf16_f32 v229, v22, v23
    v_cvt_pk_bf16_f32 v230, v28, v29
    v_cvt_pk_bf16_f32 v231, v30, v31
    buffer_store_dwordx4 v[228:231], v160, s[48:51], s40 offen offset:3072 sc1
    v_cvt_pk_bf16_f32 v232, v40, v41
    v_cvt_pk_bf16_f32 v233, v42, v43
    v_cvt_pk_bf16_f32 v234, v56, v57
    v_cvt_pk_bf16_f32 v235, v58, v59
    s_add_u32 s40, s40, 4096
    buffer_store_dwordx4 v[232:235], v160, s[48:51], s40 offen offset:0 sc1
    v_cvt_pk_bf16_f32 v236, v44, v45
    v_cvt_pk_bf16_f32 v237, v46, v47
    v_cvt_pk_bf16_f32 v238, v60, v61
    v_cvt_pk_bf16_f32 v239, v62, v63
    buffer_store_dwordx4 v[236:239], v160, s[48:51], s40 offen offset:1024 sc1
    v_cvt_pk_bf16_f32 v240, v72, v73
    v_cvt_pk_bf16_f32 v241, v74, v75
    v_cvt_pk_bf16_f32 v242, v88, v89
    v_cvt_pk_bf16_f32 v243, v90, v91
    buffer_store_dwordx4 v[240:243], v160, s[48:51], s40 offen offset:2048 sc1
    v_cvt_pk_bf16_f32 v244, v76, v77
    v_cvt_pk_bf16_f32 v245, v78, v79
    v_cvt_pk_bf16_f32 v246, v92, v93
    v_cvt_pk_bf16_f32 v247, v94, v95
    buffer_store_dwordx4 v[244:247], v160, s[48:51], s40 offen offset:3072 sc1
    v_accvgpr_read_b32 v252, a144
    v_accvgpr_read_b32 v253, a145
    v_accvgpr_read_b32 v254, a146
    v_accvgpr_read_b32 v255, a147
    v_cvt_pk_bf16_f32 v248, v252, v253
    v_cvt_pk_bf16_f32 v249, v254, v255
    v_accvgpr_read_b32 v252, a148
    v_accvgpr_read_b32 v253, a149
    v_accvgpr_read_b32 v254, a150
    v_accvgpr_read_b32 v255, a151
    v_cvt_pk_bf16_f32 v250, v252, v253
    v_cvt_pk_bf16_f32 v251, v254, v255
    s_add_u32 s40, s40, 4096
    buffer_store_dwordx4 v[248:251], v160, s[48:51], s40 offen sc1
    v_add_f32 v198, v198, v200
    v_add_f32 v199, v199, v201
    v_mov_b32 v200, v198
    v_mov_b32 v201, v199
    s_nop 0
    v_permlane16_swap_b32 v198, v200
    v_permlane16_swap_b32 v199, v201
    v_add_f32 v198, v198, v200
    v_add_f32 v199, v199, v201
    v_mov_b32 v200, v198
    v_mov_b32 v201, v199
    s_nop 0
    v_permlane32_swap_b32 v198, v200
    v_permlane32_swap_b32 v199, v201
    v_add_f32 v198, v198, v200
    v_add_f32 v199, v199, v201
    v_mul_f32 v198, 0x3ae38e39, v198
    v_mul_f32 v199, 0x3ae38e39, v199
    v_fma_f32 v199, -v198, v198, v199
    v_max_f32 v199, 0, v199
    v_cvt_pk_bf16_f32 v170, v198, v199
    v_lshlrev_b32 v198, 16, v170
    v_and_b32 v199, 0xffff0000, v170
    v_sub_f32 v171, 0, v198
    v_add_f32 v199, 0x3727c5ac, v199
    v_cvt_pk_bf16_f32 v199, v199, v199
    v_lshlrev_b32 v199, 16, v199
    v_sqrt_f32 v199, v199
    s_nop 0
    v_cvt_pk_bf16_f32 v199, v199, v199
    v_lshlrev_b32 v199, 16, v199
    v_rcp_f32 v168, v199
    v_add_f32 v202, v202, v204
    v_add_f32 v203, v203, v205
    v_mov_b32 v204, v202
    v_mov_b32 v205, v203
    s_nop 0
    v_permlane16_swap_b32 v202, v204
    v_permlane16_swap_b32 v203, v205
    v_add_f32 v202, v202, v204
    v_add_f32 v203, v203, v205
    v_mov_b32 v204, v202
    v_mov_b32 v205, v203
    s_nop 0
    v_permlane32_swap_b32 v202, v204
    v_permlane32_swap_b32 v203, v205
    v_add_f32 v202, v202, v204
    v_add_f32 v203, v203, v205
    v_mul_f32 v202, 0x3ae38e39, v202
    v_mul_f32 v203, 0x3ae38e39, v203
    v_fma_f32 v203, -v202, v202, v203
    v_max_f32 v203, 0, v203
    v_cvt_pk_bf16_f32 v170, v202, v203
    v_lshlrev_b32 v202, 16, v170
    v_and_b32 v203, 0xffff0000, v170
    v_sub_f32 v171, 0, v202
    v_add_f32 v203, 0x3727c5ac, v203
    v_cvt_pk_bf16_f32 v203, v203, v203
    v_lshlrev_b32 v203, 16, v203
    v_sqrt_f32 v203, v203
    s_nop 0
    v_cvt_pk_bf16_f32 v203, v203, v203
    v_lshlrev_b32 v203, 16, v203
    v_rcp_f32 v169, v203
    s_and_b32 s44, s30, 1
    s_cmp_eq_u32 s44, 0
    s_cselect_b64 vcc, -1, 0
    v_cndmask_b32 v170, v169, v168, vcc
    v_and_b32 v172, 3, v165
    v_cmp_ne_u32 s[56:57], s58, v172
    s_lshl_b32 s40, s58, 2
    v_add_u32 v172, s40, v172
    v_lshlrev_b32 v172, 2, v172
    s_lshl_b32 s40, s30, 12
    v_add_u32 v184, s40, v160
    s_lshl_b32 s40, s44, 10
    s_add_u32 s40, s40, 16384
    v_add_u32 v185, s40, v160
    s_lshl_b32 s40, s30, 11
    v_add_u32 v186, s40, v160
    s_lshl_b32 s40, s44, 3
    s_add_u32 s40, s40, 8192
    v_add_u32 v187, s40, v160
    s_add_u32 s40, s58, 1
    s_and_b32 s40, s40, 3
    s_lshl_b32 s42, s58, 2
    s_add_u32 s40, s40, s42
    s_mul_i32 s36, s40, 9216
    s_add_u32 s40, s58, 2
    s_and_b32 s40, s40, 3
    s_lshl_b32 s42, s58, 2
    s_add_u32 s40, s40, s42
    s_mul_i32 s37, s40, 9216
    s_add_u32 s40, s58, 3
    s_and_b32 s40, s40, 3
    s_lshl_b32 s42, s58, 2
    s_add_u32 s40, s40, s42
    s_mul_i32 s38, s40, 9216
    v_mov_b32 v174, 1
    s_waitcnt vmcnt(0)
    buffer_store_dword v174, off, s[52:55], s41 sc1
    s_branch L_fk_kernel_sent
L_fk_kernel_own:
    ds_write_b128 v160, v[0:3] offset:0
    ds_write_b128 v160, v[4:7] offset:1024
    ds_write_b128 v160, v[8:11] offset:2048
    ds_write_b128 v160, v[12:15] offset:3072
    ds_write_b128 v160, v[16:19] offset:4096
    ds_write_b128 v160, v[20:23] offset:5120
    ds_write_b128 v160, v[24:27] offset:6144
    ds_write_b128 v160, v[28:31] offset:7168
    ds_write_b128 v160, v[40:43] offset:8192
    ds_write_b128 v160, v[44:47] offset:9216
    ds_write_b128 v160, v[56:59] offset:10240
    ds_write_b128 v160, v[60:63] offset:11264
    ds_write_b128 v160, v[72:75] offset:12288
    ds_write_b128 v160, v[76:79] offset:13312
    ds_write_b128 v160, v[88:91] offset:14336
    ds_write_b128 v160, v[92:95] offset:15360
    ds_write_b128 v160, a[144:147] offset:16384
    ds_write_b128 v160, a[148:151] offset:17408
    v_add_f32 v198, v198, v200
    v_add_f32 v199, v199, v201
    v_mov_b32 v200, v198
    v_mov_b32 v201, v199
    s_nop 0
    v_permlane16_swap_b32 v198, v200
    v_permlane16_swap_b32 v199, v201
    v_add_f32 v198, v198, v200
    v_add_f32 v199, v199, v201
    v_mov_b32 v200, v198
    v_mov_b32 v201, v199
    s_nop 0
    v_permlane32_swap_b32 v198, v200
    v_permlane32_swap_b32 v199, v201
    v_add_f32 v198, v198, v200
    v_add_f32 v199, v199, v201
    v_mul_f32 v198, 0x3ae38e39, v198
    v_mul_f32 v199, 0x3ae38e39, v199
    v_fma_f32 v199, -v198, v198, v199
    v_max_f32 v199, 0, v199
    v_cvt_pk_bf16_f32 v170, v198, v199
    v_lshlrev_b32 v198, 16, v170
    v_and_b32 v199, 0xffff0000, v170
    v_sub_f32 v171, 0, v198
    v_add_f32 v199, 0x3727c5ac, v199
    v_cvt_pk_bf16_f32 v199, v199, v199
    v_lshlrev_b32 v199, 16, v199
    v_sqrt_f32 v199, v199
    s_nop 0
    v_cvt_pk_bf16_f32 v199, v199, v199
    v_lshlrev_b32 v199, 16, v199
    v_rcp_f32 v168, v199
    v_add_f32 v202, v202, v204
    v_add_f32 v203, v203, v205
    v_mov_b32 v204, v202
    v_mov_b32 v205, v203
    s_nop 0
    v_permlane16_swap_b32 v202, v204
    v_permlane16_swap_b32 v203, v205
    v_add_f32 v202, v202, v204
    v_add_f32 v203, v203, v205
    v_mov_b32 v204, v202
    v_mov_b32 v205, v203
    s_nop 0
    v_permlane32_swap_b32 v202, v204
    v_permlane32_swap_b32 v203, v205
    v_add_f32 v202, v202, v204
    v_add_f32 v203, v203, v205
    v_mul_f32 v202, 0x3ae38e39, v202
    v_mul_f32 v203, 0x3ae38e39, v203
    v_fma_f32 v203, -v202, v202, v203
    v_max_f32 v203, 0, v203
    v_cvt_pk_bf16_f32 v170, v202, v203
    v_lshlrev_b32 v202, 16, v170
    v_and_b32 v203, 0xffff0000, v170
    v_sub_f32 v171, 0, v202
    v_add_f32 v203, 0x3727c5ac, v203
    v_cvt_pk_bf16_f32 v203, v203, v203
    v_lshlrev_b32 v203, 16, v203
    v_sqrt_f32 v203, v203
    s_nop 0
    v_cvt_pk_bf16_f32 v203, v203, v203
    v_lshlrev_b32 v203, 16, v203
    v_rcp_f32 v169, v203
    s_and_b32 s44, s30, 1
    s_cmp_eq_u32 s44, 0
    s_cselect_b64 vcc, -1, 0
    v_cndmask_b32 v170, v169, v168, vcc
    v_and_b32 v172, 3, v165
    v_cmp_ne_u32 s[56:57], s58, v172
    s_lshl_b32 s40, s58, 2
    v_add_u32 v172, s40, v172
    v_lshlrev_b32 v172, 2, v172
    s_lshl_b32 s40, s30, 12
    v_add_u32 v184, s40, v160
    s_lshl_b32 s40, s44, 10
    s_add_u32 s40, s40, 16384
    v_add_u32 v185, s40, v160
    s_lshl_b32 s40, s30, 11
    v_add_u32 v186, s40, v160
    s_lshl_b32 s40, s44, 3
    s_add_u32 s40, s40, 8192
    v_add_u32 v187, s40, v160
    s_add_u32 s40, s58, 1
    s_and_b32 s40, s40, 3
    s_lshl_b32 s42, s58, 2
    s_add_u32 s40, s40, s42
    s_mul_i32 s36, s40, 9216
    s_add_u32 s40, s58, 2
    s_and_b32 s40, s40, 3
    s_lshl_b32 s42, s58, 2
    s_add_u32 s40, s40, s42
    s_mul_i32 s37, s40, 9216
    s_add_u32 s40, s58, 3
    s_and_b32 s40, s40, 3
    s_lshl_b32 s42, s58, 2
    s_add_u32 s40, s40, s42
    s_mul_i32 s38, s40, 9216
    s_waitcnt lgkmcnt(0)
L_fk_kernel_sent:
    s_barrier
    ds_read_b128 v[0:3], v184 offset:0
    ds_read_b128 v[4:7], v184 offset:1024
    ds_read_b128 v[8:11], v184 offset:2048
    ds_read_b128 v[12:15], v184 offset:3072
    ds_read_b128 v[16:19], v185
    s_mov_b32 s43, 0x10000
L_fk_kernel_xspin:
    buffer_load_dword v173, v172, s[52:55], 0 offen sc1
    s_waitcnt vmcnt(0)
    v_cmp_eq_u32 vcc, 0, v173
    s_nop 0
    s_and_b64 vcc, vcc, s[56:57]
    s_cbranch_scc0 L_fk_kernel_xok
    s_sleep 1
    s_sub_u32 s43, s43, 1
    s_cmp_lg_u32 s43, 0
    s_cbranch_scc1 L_fk_kernel_xspin
L_fk_kernel_xok:
    buffer_load_dwordx4 v[24:27], v186, s[48:51], s36 offen offset:0 sc1
    buffer_load_dwordx4 v[28:31], v186, s[48:51], s36 offen offset:1024 sc1
    buffer_load_dwordx2 v[32:33], v187, s[48:51], s36 offen sc1
    buffer_load_dwordx4 v[34:37], v186, s[48:51], s37 offen offset:0 sc1
    buffer_load_dwordx4 v[38:41], v186, s[48:51], s37 offen offset:1024 sc1
    buffer_load_dwordx2 v[42:43], v187, s[48:51], s37 offen sc1
    buffer_load_dwordx4 v[44:47], v186, s[48:51], s38 offen offset:0 sc1
    buffer_load_dwordx4 v[48:51], v186, s[48:51], s38 offen offset:1024 sc1
    buffer_load_dwordx2 v[52:53], v187, s[48:51], s38 offen sc1
    s_waitcnt vmcnt(0) lgkmcnt(0)
    v_lshlrev_b32 v60, 16, v24
    v_and_b32 v61, 0xffff0000, v24
    v_pk_add_f32 v[0:1], v[0:1], v[60:61]
    v_lshlrev_b32 v62, 16, v25
    v_and_b32 v63, 0xffff0000, v25
    v_pk_add_f32 v[2:3], v[2:3], v[62:63]
    v_lshlrev_b32 v64, 16, v26
    v_and_b32 v65, 0xffff0000, v26
    v_pk_add_f32 v[8:9], v[8:9], v[64:65]
    v_lshlrev_b32 v66, 16, v27
    v_and_b32 v67, 0xffff0000, v27
    v_pk_add_f32 v[10:11], v[10:11], v[66:67]
    v_lshlrev_b32 v60, 16, v28
    v_and_b32 v61, 0xffff0000, v28
    v_pk_add_f32 v[4:5], v[4:5], v[60:61]
    v_lshlrev_b32 v62, 16, v29
    v_and_b32 v63, 0xffff0000, v29
    v_pk_add_f32 v[6:7], v[6:7], v[62:63]
    v_lshlrev_b32 v64, 16, v30
    v_and_b32 v65, 0xffff0000, v30
    v_pk_add_f32 v[12:13], v[12:13], v[64:65]
    v_lshlrev_b32 v66, 16, v31
    v_and_b32 v67, 0xffff0000, v31
    v_pk_add_f32 v[14:15], v[14:15], v[66:67]
    v_lshlrev_b32 v60, 16, v32
    v_and_b32 v61, 0xffff0000, v32
    v_pk_add_f32 v[16:17], v[16:17], v[60:61]
    v_lshlrev_b32 v62, 16, v33
    v_and_b32 v63, 0xffff0000, v33
    v_pk_add_f32 v[18:19], v[18:19], v[62:63]
    v_lshlrev_b32 v60, 16, v34
    v_and_b32 v61, 0xffff0000, v34
    v_pk_add_f32 v[0:1], v[0:1], v[60:61]
    v_lshlrev_b32 v62, 16, v35
    v_and_b32 v63, 0xffff0000, v35
    v_pk_add_f32 v[2:3], v[2:3], v[62:63]
    v_lshlrev_b32 v64, 16, v36
    v_and_b32 v65, 0xffff0000, v36
    v_pk_add_f32 v[8:9], v[8:9], v[64:65]
    v_lshlrev_b32 v66, 16, v37
    v_and_b32 v67, 0xffff0000, v37
    v_pk_add_f32 v[10:11], v[10:11], v[66:67]
    v_lshlrev_b32 v60, 16, v38
    v_and_b32 v61, 0xffff0000, v38
    v_pk_add_f32 v[4:5], v[4:5], v[60:61]
    v_lshlrev_b32 v62, 16, v39
    v_and_b32 v63, 0xffff0000, v39
    v_pk_add_f32 v[6:7], v[6:7], v[62:63]
    v_lshlrev_b32 v64, 16, v40
    v_and_b32 v65, 0xffff0000, v40
    v_pk_add_f32 v[12:13], v[12:13], v[64:65]
    v_lshlrev_b32 v66, 16, v41
    v_and_b32 v67, 0xffff0000, v41
    v_pk_add_f32 v[14:15], v[14:15], v[66:67]
    v_lshlrev_b32 v60, 16, v42
    v_and_b32 v61, 0xffff0000, v42
    v_pk_add_f32 v[16:17], v[16:17], v[60:61]
    v_lshlrev_b32 v62, 16, v43
    v_and_b32 v63, 0xffff0000, v43
    v_pk_add_f32 v[18:19], v[18:19], v[62:63]
    v_lshlrev_b32 v60, 16, v44
    v_and_b32 v61, 0xffff0000, v44
    v_pk_add_f32 v[0:1], v[0:1], v[60:61]
    v_lshlrev_b32 v62, 16, v45
    v_and_b32 v63, 0xffff0000, v45
    v_pk_add_f32 v[2:3], v[2:3], v[62:63]
    v_lshlrev_b32 v64, 16, v46
    v_and_b32 v65, 0xffff0000, v46
    v_pk_add_f32 v[8:9], v[8:9], v[64:65]
    v_lshlrev_b32 v66, 16, v47
    v_and_b32 v67, 0xffff0000, v47
    v_pk_add_f32 v[10:11], v[10:11], v[66:67]
    v_lshlrev_b32 v60, 16, v48
    v_and_b32 v61, 0xffff0000, v48
    v_pk_add_f32 v[4:5], v[4:5], v[60:61]
    v_lshlrev_b32 v62, 16, v49
    v_and_b32 v63, 0xffff0000, v49
    v_pk_add_f32 v[6:7], v[6:7], v[62:63]
    v_lshlrev_b32 v64, 16, v50
    v_and_b32 v65, 0xffff0000, v50
    v_pk_add_f32 v[12:13], v[12:13], v[64:65]
    v_lshlrev_b32 v66, 16, v51
    v_and_b32 v67, 0xffff0000, v51
    v_pk_add_f32 v[14:15], v[14:15], v[66:67]
    v_lshlrev_b32 v60, 16, v52
    v_and_b32 v61, 0xffff0000, v52
    v_pk_add_f32 v[16:17], v[16:17], v[60:61]
    v_lshlrev_b32 v62, 16, v53
    v_and_b32 v63, 0xffff0000, v53
    v_pk_add_f32 v[18:19], v[18:19], v[62:63]
    v_pk_mul_f32 v[0:1], v[168:169], v[0:1] op_sel:[0,0] op_sel_hi:[0,1]
    v_lshlrev_b32 v98, 16, v188
    v_cvt_pk_bf16_f32 v96, v0, v1
    v_and_b32 v99, 0xffff0000, v188
    v_lshlrev_b32 v0, 16, v96
    v_and_b32 v1, 0xffff0000, v96
    v_pk_add_f32 v[0:1], v[0:1], v[98:99]
    v_cvt_pk_bf16_f32 v84, v0, v1
    v_pk_mul_f32 v[2:3], v[168:169], v[2:3] op_sel:[0,0] op_sel_hi:[0,1]
    v_lshlrev_b32 v102, 16, v189
    v_cvt_pk_bf16_f32 v100, v2, v3
    v_and_b32 v103, 0xffff0000, v189
    v_lshlrev_b32 v2, 16, v100
    v_and_b32 v3, 0xffff0000, v100
    v_pk_add_f32 v[2:3], v[2:3], v[102:103]
    v_cvt_pk_bf16_f32 v85, v2, v3
    v_pk_mul_f32 v[8:9], v[168:169], v[8:9] op_sel:[0,0] op_sel_hi:[0,1]
    v_lshlrev_b32 v98, 16, v190
    v_cvt_pk_bf16_f32 v96, v8, v9
    v_and_b32 v99, 0xffff0000, v190
    v_lshlrev_b32 v8, 16, v96
    v_and_b32 v9, 0xffff0000, v96
    v_pk_add_f32 v[8:9], v[8:9], v[98:99]
    v_cvt_pk_bf16_f32 v86, v8, v9
    v_pk_mul_f32 v[10:11], v[168:169], v[10:11] op_sel:[0,0] op_sel_hi:[0,1]
    v_lshlrev_b32 v102, 16, v191
    v_cvt_pk_bf16_f32 v100, v10, v11
    v_and_b32 v103, 0xffff0000, v191
    v_lshlrev_b32 v10, 16, v100
    v_and_b32 v11, 0xffff0000, v100
    v_pk_add_f32 v[10:11], v[10:11], v[102:103]
    v_cvt_pk_bf16_f32 v87, v10, v11
    buffer_store_dwordx4 v[84:87], v176, s[20:23], 0 offen
    v_pk_mul_f32 v[4:5], v[168:169], v[4:5] op_sel:[1,0] op_sel_hi:[1,1]
    v_lshlrev_b32 v98, 16, v192
    v_cvt_pk_bf16_f32 v96, v4, v5
    v_and_b32 v99, 0xffff0000, v192
    v_lshlrev_b32 v4, 16, v96
    v_and_b32 v5, 0xffff0000, v96
    v_pk_add_f32 v[4:5], v[4:5], v[98:99]
    v_cvt_pk_bf16_f32 v88, v4, v5
    v_pk_mul_f32 v[6:7], v[168:169], v[6:7] op_sel:[1,0] op_sel_hi:[1,1]
    v_lshlrev_b32 v102, 16, v193
    v_cvt_pk_bf16_f32 v100, v6, v7
    v_and_b32 v103, 0xffff0000, v193
    v_lshlrev_b32 v6, 16, v100
    v_and_b32 v7, 0xffff0000, v100
    v_pk_add_f32 v[6:7], v[6:7], v[102:103]
    v_cvt_pk_bf16_f32 v89, v6, v7
    v_pk_mul_f32 v[12:13], v[168:169], v[12:13] op_sel:[1,0] op_sel_hi:[1,1]
    v_lshlrev_b32 v98, 16, v194
    v_cvt_pk_bf16_f32 v96, v12, v13
    v_and_b32 v99, 0xffff0000, v194
    v_lshlrev_b32 v12, 16, v96
    v_and_b32 v13, 0xffff0000, v96
    v_pk_add_f32 v[12:13], v[12:13], v[98:99]
    v_cvt_pk_bf16_f32 v90, v12, v13
    v_pk_mul_f32 v[14:15], v[168:169], v[14:15] op_sel:[1,0] op_sel_hi:[1,1]
    v_lshlrev_b32 v102, 16, v195
    v_cvt_pk_bf16_f32 v100, v14, v15
    v_and_b32 v103, 0xffff0000, v195
    v_lshlrev_b32 v14, 16, v100
    v_and_b32 v15, 0xffff0000, v100
    v_pk_add_f32 v[14:15], v[14:15], v[102:103]
    v_cvt_pk_bf16_f32 v91, v14, v15
    buffer_store_dwordx4 v[88:91], v177, s[20:23], 0 offen
    v_pk_mul_f32 v[16:17], v[170:171], v[16:17] op_sel:[0,0] op_sel_hi:[0,1]
    v_lshlrev_b32 v98, 16, v196
    v_cvt_pk_bf16_f32 v96, v16, v17
    v_and_b32 v99, 0xffff0000, v196
    v_lshlrev_b32 v16, 16, v96
    v_and_b32 v17, 0xffff0000, v96
    v_pk_add_f32 v[16:17], v[16:17], v[98:99]
    v_cvt_pk_bf16_f32 v92, v16, v17
    v_pk_mul_f32 v[18:19], v[170:171], v[18:19] op_sel:[0,0] op_sel_hi:[0,1]
    v_lshlrev_b32 v102, 16, v197
    v_cvt_pk_bf16_f32 v100, v18, v19
    v_and_b32 v103, 0xffff0000, v197
    v_lshlrev_b32 v18, 16, v100
    v_and_b32 v19, 0xffff0000, v100
    v_pk_add_f32 v[18:19], v[18:19], v[102:103]
    v_cvt_pk_bf16_f32 v93, v18, v19
    buffer_store_dwordx2 v[92:93], v182, s[20:23], 0 offen
L_fk_kernel_end:
    s_endpgm
.section .rodata,"a"
.p2align 6
.amdhsa_kernel fk_kernel
  .amdhsa_next_free_vgpr 512
  .amdhsa_next_free_sgpr 102
  .amdhsa_accum_offset 256
  .amdhsa_group_segment_fixed_size 0
  .amdhsa_kernarg_size 80
  .amdhsa_user_sgpr_count 2
  .amdhsa_user_sgpr_kernarg_segment_ptr 1
  .amdhsa_system_sgpr_workgroup_id_x 1
  .amdhsa_float_denorm_mode_32 3
  .amdhsa_float_denorm_mode_16_64 3
.end_amdhsa_kernel
```
